```python
import torch

def _softmax(x, axis=-1):
    return torch.softmax(x, dim=axis)
def _gelu(x):
    return torch.nn.functional.gelu(x, approximate="tanh")
def _silu(x):
    return torch.nn.functional.silu(x)
def _sigmoid(x):
    return torch.sigmoid(x)
def _layernorm(x, axis=-1, eps=1e-5):
    m = x.mean(dim=axis, keepdim=True)
    v = x.var(dim=axis, keepdim=True, unbiased=False)
    return (x - m) / torch.sqrt(v + eps)
def _scatter_add(tgt, idx, src, axis=0):
    return tgt.clone().index_add_(axis, idx, src)
def _segment_sum(src, seg, n):
    out = torch.zeros((n,) + src.shape[1:], dtype=src.dtype)
    return out.index_add_(0, seg, src)
def _pad(x, pw):
    flat = tuple(v for pair in reversed(pw) for v in pair)
    return torch.nn.functional.pad(x, flat)

kernel_name = 'interleave_layers__spectral_gfnet__mha_block__prompt'

def setup_inputs():

    _w = (lambda a: (lambda t: t.to(torch.bfloat16) if t.is_floating_point() else t)(torch.as_tensor(a)))
    def _A_setup():
        B, S, D = 1, 2048, 640
        Df = D // 2 + 1
        return {
            "x": _w((lambda *s: torch.randn(*s, dtype=torch.bfloat16) * 0.05)(B, S, D)),
            "w_r": _w((lambda *s: torch.randn(*s, dtype=torch.bfloat16) * 1.6)(S, Df) * 0.02),
            "w_i": _w((lambda *s: torch.randn(*s, dtype=torch.bfloat16) * 1.6)(S, Df) * 0.02),
        }
    _A_in = _A_setup()

    def _B_setup():
        B, S, D, H = 1, 2048, 640, 32
        return {
            "x": _w((lambda *s: torch.randn(*s, dtype=torch.bfloat16) * 0.05)(B, S, D)),
            "wqkv": _w((lambda *s: torch.randn(*s, dtype=torch.bfloat16) * 0.05)(D, 3 * D)),
            "wo": _w((lambda *s: torch.randn(*s, dtype=torch.bfloat16) * 0.05)(D, D)),
        }
    _B_in = _B_setup()

    return {
        "A_x": _A_in["x"],
        "A_w_r": _A_in["w_r"],
        "A_w_i": _A_in["w_i"],
        "B_x": _B_in["x"],
        "B_wqkv": _B_in["wqkv"],
        "B_wo": _B_in["wo"],
    }

def reference(A_x, A_w_r, A_w_i, B_x, B_wqkv, B_wo):
    def _A_ref(x, w_r, w_i):
        B, S, D = x.shape
        X = (lambda x, axes=(-2,-1): torch.fft.rfft2(x.float(), dim=axes))(x, axes=(-2, -1))
        W = w_r + 1j * w_i
        X = X * W
        y = (lambda x, s, axes=(-2,-1): torch.fft.irfft2(x, s=s, dim=axes).to(torch.bfloat16))(X, (S, D), axes=(-2, -1))
        return y

    def _B_ref(x, wqkv, wo):
        B, S, D = x.shape
        H = 32
        Dh = D // H
        qkv = (lambda x, *d: x.permute(*d))((x @ wqkv).reshape(B, S, 3, H, Dh), 2, 0, 3, 1, 4)
        q, k, v = qkv[0], qkv[1], qkv[2]
        scores = torch.einsum("bhqd,bhkd->bhqk", q, k) * (Dh ** -0.5)
        p = _softmax(scores, axis=-1)
        o = torch.einsum("bhqk,bhkd->bhqd", p, v)
        return (lambda x, *d: x.permute(*d))(o, 0, 2, 1, 3).reshape(B, S, D) @ wo

    x = A_x
    x = x + _A_ref(_layernorm(x, axis=-1), A_w_r, A_w_i)
    x = x + _B_ref(_layernorm(x, axis=-1), B_wqkv, B_wo)
    x = x + _A_ref(_layernorm(x, axis=-1), A_w_r, A_w_i)
    x = x + _B_ref(_layernorm(x, axis=-1), B_wqkv, B_wo)
    return x
```

```asm
; @launch grid=(256,1,1) block=(512,1,1) lds=163840
.amdgcn_target "amdgcn-amd-amdhsa--gfx950"
.text
.globl interleave_layers__spectral_gfnet__mha_block__prompt_kernel
.p2align 8
.type interleave_layers__spectral_gfnet__mha_block__prompt_kernel,@function
interleave_layers__spectral_gfnet__mha_block__prompt_kernel:
    s_cmp_ge_u32 s2, 256
    s_cbranch_scc1 L_end
    s_load_dwordx2 s[8:9], s[0:1], 0
    s_load_dwordx2 s[12:13], s[0:1], 8
    s_load_dwordx2 s[16:17], s[0:1], 16
    s_load_dwordx2 s[20:21], s[0:1], 32
    s_load_dwordx2 s[24:25], s[0:1], 40
    s_load_dwordx2 s[28:29], s[0:1], 48
    s_load_dwordx2 s[32:33], s[0:1], 56
    s_load_dwordx2 s[4:5], s[0:1], 64
    s_getpc_b64 s[92:93]
L_pc:
    s_lshr_b32 s3, s2, 3
    v_lshl_add_u32 v1, v0, 5, s3
    v_lshlrev_b32 v1, 7, v1
    v_mov_b32 v3, s93
    v_add_co_u32 v2, vcc, s92, v1
    s_nop 1
    v_addc_co_u32 v3, vcc, 0, v3, vcc
    v_cmp_gt_u32 vcc, L_hot_end-L_pc, v1
    s_and_saveexec_b64 s[94:95], vcc
    s_cbranch_execz L_nopf
    global_load_dword v240, v[2:3], off
L_nopf:
    s_mov_b64 exec, s[94:95]
    v_readfirstlane_b32 s36, v0
    v_and_b32 v0, 63, v0
    s_mov_b32 s45, s2
    s_lshr_b32 s36, s36, 6
    s_and_b32 s98, s36, 3
    s_and_b32 s37, s2, 7
    s_lshr_b32 s88, s2, 3
    s_lshl_b32 s52, s2, 2
    s_add_u32 s39, s88, s52
    s_and_b32 s39, s39, 7
    s_lshr_b32 s52, s88, 3
    s_lshl_b32 s41, s37, 2
    s_add_u32 s41, s41, s52
    s_mov_b32 s42, 0
    s_mov_b32 s75, 1
    s_mov_b32 s6, 268435456
    s_mov_b32 s7, 0x00020000
    s_mov_b32 s10, 2621440
    s_mov_b32 s11, 0x00020000
    s_cmp_ge_u32 s36, 4
    s_cbranch_scc1 L_p0hi_1
    v_lshrrev_b32 v8, 3, v0
    v_add_u32 v8, 0, v8
    v_and_b32 v9, 1, v8
    v_lshlrev_b32 v12, 10, v9
    v_bfe_u32 v9, v8, 1, 2
    v_lshl_add_u32 v12, v9, 5, v12
    v_bfe_u32 v9, v8, 3, 1
    s_lshl_b32 s52, s37, 7
    s_and_b32 s53, s41, 3
    s_lshl_b32 s53, s53, 3
    s_add_u32 s52, s52, s53
    s_lshl_b32 s53, s98, 1
    s_add_u32 s52, s52, s53
    v_add3_u32 v12, s52, v12, v9
    v_lshrrev_b32 v8, 3, v0
    v_add_u32 v8, 8, v8
    v_and_b32 v9, 1, v8
    v_lshlrev_b32 v13, 10, v9
    v_bfe_u32 v9, v8, 1, 2
    v_lshl_add_u32 v13, v9, 5, v13
    v_bfe_u32 v9, v8, 3, 1
    s_lshl_b32 s52, s37, 7
    s_and_b32 s53, s41, 3
    s_lshl_b32 s53, s53, 3
    s_add_u32 s52, s52, s53
    s_lshl_b32 s53, s98, 1
    s_add_u32 s52, s52, s53
    v_add3_u32 v13, s52, v13, v9
    v_lshrrev_b32 v8, 3, v0
    v_and_b32 v8, 6, v8
    v_xor_b32 v8, v8, v0
    v_and_b32 v8, 7, v8
    v_lshlrev_b32 v8, 4, v8
    s_movk_i32 s52, 1280
    v_mad_u32_u24 v12, v12, s52, v8
    v_mad_u32_u24 v13, v13, s52, v8
    s_waitcnt lgkmcnt(0)
    s_mul_i32 s52, s98, 20480
    s_add_u32 s52, s52, 51200
    s_mov_b32 s53, s39
    s_mov_b32 s55, 5
L_xd_3:
    s_lshl_b32 s54, s53, 11
    s_add_u32 m0, s54, s52
    s_lshl_b32 s54, s53, 7
    buffer_load_dwordx4 v12, s[8:11], s54 offen lds
    s_add_u32 m0, m0, 1024
    s_add_u32 s53, s53, 1
    buffer_load_dwordx4 v13, s[8:11], s54 offen lds
    s_cmp_eq_u32 s53, 10
    s_cselect_b32 s53, 0, s53
    s_lshl_b32 s54, s53, 11
    s_add_u32 m0, s54, s52
    s_lshl_b32 s54, s53, 7
    buffer_load_dwordx4 v12, s[8:11], s54 offen lds
    s_add_u32 m0, m0, 1024
    s_add_u32 s53, s53, 1
    buffer_load_dwordx4 v13, s[8:11], s54 offen lds
    s_cmp_eq_u32 s53, 10
    s_cselect_b32 s53, 0, s53
    s_sub_u32 s55, s55, 1
    s_cmp_lg_u32 s55, 0
    s_cbranch_scc1 L_xd_3
    s_branch L_rows
L_p0hi_1:
    v_lshlrev_b32 v1, 4, v0
    s_cmp_lg_u32 s36, 4
    s_cbranch_scc1 L_p0z_2
    s_cmp_ge_u32 s45, 27
    s_cbranch_scc1 L_p0z_2
    v_mov_b32 v40, 0
    v_mov_b32 v41, 0
    v_mov_b32 v42, 0
    v_mov_b32 v43, 0
    s_lshl_b32 s52, s45, 13
    s_add_u32 s53, s52, 4096
    s_setprio 3
    s_waitcnt lgkmcnt(0)
    buffer_store_dwordx4 v[40:43], v1, s[4:7], s52 offen offset:0 sc1
    buffer_store_dwordx4 v[40:43], v1, s[4:7], s52 offen offset:1024 sc1
    buffer_store_dwordx4 v[40:43], v1, s[4:7], s52 offen offset:2048 sc1
    buffer_store_dwordx4 v[40:43], v1, s[4:7], s52 offen offset:3072 sc1
    buffer_store_dwordx4 v[40:43], v1, s[4:7], s53 offen offset:0 sc1
    buffer_store_dwordx4 v[40:43], v1, s[4:7], s53 offen offset:1024 sc1
    buffer_store_dwordx4 v[40:43], v1, s[4:7], s53 offen offset:2048 sc1
    buffer_store_dwordx4 v[40:43], v1, s[4:7], s53 offen offset:3072 sc1
L_p0z_2:
    s_setprio 1
    v_lshrrev_b32 v2, 4, v0
    v_lshlrev_b32 v2, 3, v2
    v_cvt_f32_u32 v2, v2
    v_bfe_u32 v3, v0, 1, 3
    v_and_b32 v4, 1, v0
    v_cvt_f32_u32 v4, v4
    v_mul_f32 v4, 0x3e800000, v4
    s_mul_i32 s61, s39, 40
    s_lshl_b32 s52, s36, 3
    s_add_u32 s52, s52, s61
    s_sub_u32 s52, s52, 31
    v_add_u32 v5, s52, v3
    v_cvt_f32_u32 v5, v5
    v_mul_f32 v5, 0x3acccccd, v5
    v_fma_f32 v8, v2, v5, v4
    v_mul_f32 v6, 0x42000000, v5
    v_cos_f32 v6, v6
    s_lshl_b32 s52, s36, 10
    s_sub_u32 s52, s52, 4096
    v_add_u32 v28, s52, v1
    v_fmamk_f32 v16, v5, 0x42000000, v8
    v_fmamk_f32 v17, v5, 0x42040000, v8
    v_fmamk_f32 v18, v5, 0x42080000, v8
    v_fmamk_f32 v19, v5, 0x420c0000, v8
    v_fmamk_f32 v20, v5, 0x42100000, v8
    v_fmamk_f32 v21, v5, 0x42140000, v8
    v_fmamk_f32 v22, v5, 0x42180000, v8
    v_fmamk_f32 v23, v5, 0x421c0000, v8
    v_fmamk_f32 v9, v5, 0x3f800000, v8
    v_fmamk_f32 v10, v5, 0x40000000, v8
    v_fmamk_f32 v11, v5, 0x40400000, v8
    v_fmamk_f32 v12, v5, 0x40800000, v8
    v_fmamk_f32 v13, v5, 0x40a00000, v8
    v_fmamk_f32 v14, v5, 0x40c00000, v8
    v_fmamk_f32 v15, v5, 0x40e00000, v8
    v_add_f32 v6, v6, v6
    v_mov_b32 v7, v6
    v_cos_f32 v8, v8
    v_cos_f32 v9, v9
    v_cos_f32 v10, v10
    v_cos_f32 v11, v11
    v_cos_f32 v12, v12
    v_cos_f32 v13, v13
    v_cos_f32 v14, v14
    v_cos_f32 v15, v15
    v_cos_f32 v16, v16
    v_cos_f32 v17, v17
    v_cos_f32 v18, v18
    v_cos_f32 v19, v19
    v_cos_f32 v20, v20
    v_cos_f32 v21, v21
    v_cos_f32 v22, v22
    v_cos_f32 v23, v23
    v_cvt_pk_bf16_f32 v24, v8, v9
    v_cvt_pk_bf16_f32 v25, v10, v11
    v_cvt_pk_bf16_f32 v26, v12, v13
    v_cvt_pk_bf16_f32 v27, v14, v15
    ds_write_b128 v28, v[24:27] offset:0
    v_cvt_pk_bf16_f32 v32, v16, v17
    v_cvt_pk_bf16_f32 v33, v18, v19
    v_cvt_pk_bf16_f32 v34, v20, v21
    v_cvt_pk_bf16_f32 v35, v22, v23
    ds_write_b128 v28, v[32:35] offset:5120
    v_pk_fma_f32 v[8:9], v[6:7], v[16:17], v[8:9] neg_lo:[0,0,1] neg_hi:[0,0,1]
    v_pk_fma_f32 v[10:11], v[6:7], v[18:19], v[10:11] neg_lo:[0,0,1] neg_hi:[0,0,1]
    v_pk_fma_f32 v[12:13], v[6:7], v[20:21], v[12:13] neg_lo:[0,0,1] neg_hi:[0,0,1]
    v_pk_fma_f32 v[14:15], v[6:7], v[22:23], v[14:15] neg_lo:[0,0,1] neg_hi:[0,0,1]
    v_cvt_pk_bf16_f32 v24, v8, v9
    v_cvt_pk_bf16_f32 v25, v10, v11
    v_cvt_pk_bf16_f32 v26, v12, v13
    v_cvt_pk_bf16_f32 v27, v14, v15
    ds_write_b128 v28, v[24:27] offset:10240
    v_pk_fma_f32 v[16:17], v[6:7], v[8:9], v[16:17] neg_lo:[0,0,1] neg_hi:[0,0,1]
    v_pk_fma_f32 v[18:19], v[6:7], v[10:11], v[18:19] neg_lo:[0,0,1] neg_hi:[0,0,1]
    v_pk_fma_f32 v[20:21], v[6:7], v[12:13], v[20:21] neg_lo:[0,0,1] neg_hi:[0,0,1]
    v_pk_fma_f32 v[22:23], v[6:7], v[14:15], v[22:23] neg_lo:[0,0,1] neg_hi:[0,0,1]
    v_cvt_pk_bf16_f32 v32, v16, v17
    v_cvt_pk_bf16_f32 v33, v18, v19
    v_cvt_pk_bf16_f32 v34, v20, v21
    v_cvt_pk_bf16_f32 v35, v22, v23
    ds_write_b128 v28, v[32:35] offset:15360
    v_pk_fma_f32 v[8:9], v[6:7], v[16:17], v[8:9] neg_lo:[0,0,1] neg_hi:[0,0,1]
    v_pk_fma_f32 v[10:11], v[6:7], v[18:19], v[10:11] neg_lo:[0,0,1] neg_hi:[0,0,1]
    v_pk_fma_f32 v[12:13], v[6:7], v[20:21], v[12:13] neg_lo:[0,0,1] neg_hi:[0,0,1]
    v_pk_fma_f32 v[14:15], v[6:7], v[22:23], v[14:15] neg_lo:[0,0,1] neg_hi:[0,0,1]
    v_cvt_pk_bf16_f32 v24, v8, v9
    v_cvt_pk_bf16_f32 v25, v10, v11
    v_cvt_pk_bf16_f32 v26, v12, v13
    v_cvt_pk_bf16_f32 v27, v14, v15
    ds_write_b128 v28, v[24:27] offset:20480
    v_pk_fma_f32 v[16:17], v[6:7], v[8:9], v[16:17] neg_lo:[0,0,1] neg_hi:[0,0,1]
    v_pk_fma_f32 v[18:19], v[6:7], v[10:11], v[18:19] neg_lo:[0,0,1] neg_hi:[0,0,1]
    v_pk_fma_f32 v[20:21], v[6:7], v[12:13], v[20:21] neg_lo:[0,0,1] neg_hi:[0,0,1]
    v_pk_fma_f32 v[22:23], v[6:7], v[14:15], v[22:23] neg_lo:[0,0,1] neg_hi:[0,0,1]
    v_cvt_pk_bf16_f32 v32, v16, v17
    v_cvt_pk_bf16_f32 v33, v18, v19
    v_cvt_pk_bf16_f32 v34, v20, v21
    v_cvt_pk_bf16_f32 v35, v22, v23
    ds_write_b128 v28, v[32:35] offset:25600
    v_pk_fma_f32 v[8:9], v[6:7], v[16:17], v[8:9] neg_lo:[0,0,1] neg_hi:[0,0,1]
    v_pk_fma_f32 v[10:11], v[6:7], v[18:19], v[10:11] neg_lo:[0,0,1] neg_hi:[0,0,1]
    v_pk_fma_f32 v[12:13], v[6:7], v[20:21], v[12:13] neg_lo:[0,0,1] neg_hi:[0,0,1]
    v_pk_fma_f32 v[14:15], v[6:7], v[22:23], v[14:15] neg_lo:[0,0,1] neg_hi:[0,0,1]
    v_cvt_pk_bf16_f32 v24, v8, v9
    v_cvt_pk_bf16_f32 v25, v10, v11
    v_cvt_pk_bf16_f32 v26, v12, v13
    v_cvt_pk_bf16_f32 v27, v14, v15
    ds_write_b128 v28, v[24:27] offset:30720
    v_pk_fma_f32 v[16:17], v[6:7], v[8:9], v[16:17] neg_lo:[0,0,1] neg_hi:[0,0,1]
    v_pk_fma_f32 v[18:19], v[6:7], v[10:11], v[18:19] neg_lo:[0,0,1] neg_hi:[0,0,1]
    v_pk_fma_f32 v[20:21], v[6:7], v[12:13], v[20:21] neg_lo:[0,0,1] neg_hi:[0,0,1]
    v_pk_fma_f32 v[22:23], v[6:7], v[14:15], v[22:23] neg_lo:[0,0,1] neg_hi:[0,0,1]
    v_cvt_pk_bf16_f32 v32, v16, v17
    v_cvt_pk_bf16_f32 v33, v18, v19
    v_cvt_pk_bf16_f32 v34, v20, v21
    v_cvt_pk_bf16_f32 v35, v22, v23
    ds_write_b128 v28, v[32:35] offset:35840
    v_pk_fma_f32 v[8:9], v[6:7], v[16:17], v[8:9] neg_lo:[0,0,1] neg_hi:[0,0,1]
    v_pk_fma_f32 v[10:11], v[6:7], v[18:19], v[10:11] neg_lo:[0,0,1] neg_hi:[0,0,1]
    v_pk_fma_f32 v[12:13], v[6:7], v[20:21], v[12:13] neg_lo:[0,0,1] neg_hi:[0,0,1]
    v_pk_fma_f32 v[14:15], v[6:7], v[22:23], v[14:15] neg_lo:[0,0,1] neg_hi:[0,0,1]
    v_cvt_pk_bf16_f32 v24, v8, v9
    v_cvt_pk_bf16_f32 v25, v10, v11
    v_cvt_pk_bf16_f32 v26, v12, v13
    v_cvt_pk_bf16_f32 v27, v14, v15
    ds_write_b128 v28, v[24:27] offset:40960
    v_pk_fma_f32 v[16:17], v[6:7], v[8:9], v[16:17] neg_lo:[0,0,1] neg_hi:[0,0,1]
    v_pk_fma_f32 v[18:19], v[6:7], v[10:11], v[18:19] neg_lo:[0,0,1] neg_hi:[0,0,1]
    v_pk_fma_f32 v[20:21], v[6:7], v[12:13], v[20:21] neg_lo:[0,0,1] neg_hi:[0,0,1]
    v_pk_fma_f32 v[22:23], v[6:7], v[14:15], v[22:23] neg_lo:[0,0,1] neg_hi:[0,0,1]
    v_cvt_pk_bf16_f32 v32, v16, v17
    v_cvt_pk_bf16_f32 v33, v18, v19
    v_cvt_pk_bf16_f32 v34, v20, v21
    v_cvt_pk_bf16_f32 v35, v22, v23
    ds_write_b128 v28, v[32:35] offset:46080
    s_cmp_lg_u32 s36, 4
    s_cbranch_scc1 L_zz_4
    s_cmp_ge_u32 s45, 27
    s_cbranch_scc1 L_zz_4
    s_waitcnt vmcnt(0) lgkmcnt(0)
    s_atomic_add s75, s[32:33], 0
L_zz_4:
    s_add_u32 s52, s61, 33
    v_add_u32 v5, s52, v3
    v_cvt_f32_u32 v5, v5
    v_mul_f32 v5, 0x3acccccd, v5
    s_cmp_eq_u32 s39, 7
    s_cselect_b32 s52, 14, 99
    v_and_b32 v6, 15, v0
    v_mov_b32 v7, 0x3e000000
    v_cmp_le_u32 vcc, s52, v6
    s_nop 1
    v_cndmask_b32 v4, v4, v7, vcc
    v_cmp_ge_u32 vcc, s52, v6
    s_nop 1
    v_cndmask_b32 v5, 0, v5, vcc
    s_sub_u32 s52, s36, 4
    s_lshl_b32 s53, s52, 5
    v_cvt_f32_u32 v6, s53
    v_add_f32 v6, v6, v2
    v_fma_f32 v6, v6, v5, v4
    s_mul_i32 s52, s52, 5120
    v_add_u32 v28, s52, v1
    v_fmamk_f32 v8, v5, 0x00000000, v6
    v_fmamk_f32 v9, v5, 0x3f800000, v6
    v_fmamk_f32 v10, v5, 0x40000000, v6
    v_fmamk_f32 v11, v5, 0x40400000, v6
    v_fmamk_f32 v12, v5, 0x40800000, v6
    v_fmamk_f32 v13, v5, 0x40a00000, v6
    v_fmamk_f32 v14, v5, 0x40c00000, v6
    v_fmamk_f32 v15, v5, 0x40e00000, v6
    v_cos_f32 v8, v8
    v_cos_f32 v9, v9
    v_cos_f32 v10, v10
    v_cos_f32 v11, v11
    v_cos_f32 v12, v12
    v_cos_f32 v13, v13
    v_cos_f32 v14, v14
    v_cos_f32 v15, v15
    v_cvt_pk_bf16_f32 v24, v8, v9
    v_cvt_pk_bf16_f32 v25, v10, v11
    v_cvt_pk_bf16_f32 v26, v12, v13
    v_cvt_pk_bf16_f32 v27, v14, v15
    ds_write_b128 v28, v[24:27] offset:4096
    v_fmamk_f32 v8, v5, 0x43000000, v6
    v_fmamk_f32 v9, v5, 0x43010000, v6
    v_fmamk_f32 v10, v5, 0x43020000, v6
    v_fmamk_f32 v11, v5, 0x43030000, v6
    v_fmamk_f32 v12, v5, 0x43040000, v6
    v_fmamk_f32 v13, v5, 0x43050000, v6
    v_fmamk_f32 v14, v5, 0x43060000, v6
    v_fmamk_f32 v15, v5, 0x43070000, v6
    v_cos_f32 v8, v8
    v_cos_f32 v9, v9
    v_cos_f32 v10, v10
    v_cos_f32 v11, v11
    v_cos_f32 v12, v12
    v_cos_f32 v13, v13
    v_cos_f32 v14, v14
    v_cos_f32 v15, v15
    v_cvt_pk_bf16_f32 v32, v8, v9
    v_cvt_pk_bf16_f32 v33, v10, v11
    v_cvt_pk_bf16_f32 v34, v12, v13
    v_cvt_pk_bf16_f32 v35, v14, v15
    ds_write_b128 v28, v[32:35] offset:24576
    s_cmp_ge_u32 s36, 6
    s_cbranch_scc1 L_fde_5
    v_fmamk_f32 v8, v5, 0x43800000, v6
    v_fmamk_f32 v9, v5, 0x43808000, v6
    v_fmamk_f32 v10, v5, 0x43810000, v6
    v_fmamk_f32 v11, v5, 0x43818000, v6
    v_fmamk_f32 v12, v5, 0x43820000, v6
    v_fmamk_f32 v13, v5, 0x43828000, v6
    v_fmamk_f32 v14, v5, 0x43830000, v6
    v_fmamk_f32 v15, v5, 0x43838000, v6
    v_cos_f32 v8, v8
    v_cos_f32 v9, v9
    v_cos_f32 v10, v10
    v_cos_f32 v11, v11
    v_cos_f32 v12, v12
    v_cos_f32 v13, v13
    v_cos_f32 v14, v14
    v_cos_f32 v15, v15
    v_cvt_pk_bf16_f32 v24, v8, v9
    v_cvt_pk_bf16_f32 v25, v10, v11
    v_cvt_pk_bf16_f32 v26, v12, v13
    v_cvt_pk_bf16_f32 v27, v14, v15
    ds_write_b128 v28, v[24:27] offset:45056
L_fde_5:
    s_and_b32 s40, s88, 24
    s_add_u32 s40, s40, s37
    s_mul_i32 s43, s37, 20
    s_add_u32 s43, s43, s88
    s_lshr_b32 s89, s37, 1
    s_add_u32 s89, s89, 8
    s_cmp_ge_u32 s88, 24
    s_cselect_b32 s89, s37, s89
    s_and_b32 s90, s37, 1
    s_lshl_b32 s90, s90, 2
    s_and_b32 s52, s88, 3
    s_add_u32 s90, s90, s52
    s_lshr_b32 s38, s37, 1
    s_lshl_b32 s38, s38, 3
    s_lshr_b32 s52, s88, 2
    s_add_u32 s38, s38, s52
    s_bfe_u32 s3, s88, 0x10003
    s_and_b32 s52, s37, 6
    s_or_b32 s3, s3, s52
    s_lshr_b32 s52, s88, 4
    s_lshl_b32 s52, s52, 3
    s_or_b32 s3, s3, s52
    s_and_b32 s52, s37, 1
    s_lshl_b32 s52, s52, 4
    s_or_b32 s3, s3, s52
    s_mov_b32 s74, 51200
    s_mov_b32 s44, 0
    s_mov_b32 s46, 262144
    s_mov_b32 s47, 5505024
    s_mov_b32 s48, 98304
    s_mov_b32 s49, 18317312
    s_mov_b32 s50, 29851648
    s_mov_b32 s14, 1314816
    s_mov_b32 s15, 0x00020000
    s_mov_b32 s18, 1314816
    s_mov_b32 s19, 0x00020000
    s_mov_b32 s22, 2457600
    s_mov_b32 s23, 0x00020000
    s_mov_b32 s26, 819200
    s_mov_b32 s27, 0x00020000
    s_mov_b32 s30, 2621440
    s_mov_b32 s31, 0x00020000
    s_mov_b32 s34, 256
    s_mov_b32 s35, 0x00020000
    s_waitcnt lgkmcnt(0)
    s_cmp_eq_u32 s36, 5
    s_cbranch_scc1 L_p05_8
    s_mov_b32 s91, 0
L_c0:
    s_cmp_ge_u32 s88, 20
    s_cbranch_scc1 L_nc_10
    s_cmp_lg_u32 s91, 1
    s_cbranch_scc1 L_cf_11
    v_mov_b64 v[128:129], v[176:177]
    v_mov_b64 v[130:131], v[178:179]
    v_mov_b64 v[132:133], v[180:181]
    v_mov_b64 v[134:135], v[182:183]
    v_mov_b64 v[144:145], v[184:185]
    v_mov_b64 v[146:147], v[186:187]
    v_mov_b64 v[148:149], v[188:189]
    v_mov_b64 v[150:151], v[190:191]
L_cf_11:
    s_and_b32 s52, s36, 1
    v_and_b32 v252, 31, v0
    v_lshrrev_b32 v253, 5, v0
    v_lshlrev_b32 v253, 2, v253
    v_cvt_f32_u32 v254, v252
    v_lshl_add_u32 v252, v252, 1, s52
    v_cvt_f32_u32 v252, v252
    v_cvt_f32_u32 v195, v253
    v_mul_f32 v252, 0x3c800000, v252
    v_mul_f32 v253, v252, v195
    v_fmamk_f32 v196, v252, 0x00000000, v253
    v_fmamk_f32 v197, v252, 0x3f800000, v253
    v_cos_f32 v198, v196
    v_cos_f32 v199, v197
    v_sin_f32 v196, v196
    v_sin_f32 v197, v197
    v_cvt_pk_bf16_f32 v8, v198, v199
    v_cvt_pk_bf16_f32 v16, v196, v197
    v_xor_b32 v24, 0x80008000, v16
    v_fmamk_f32 v196, v252, 0x40000000, v253
    v_fmamk_f32 v197, v252, 0x40400000, v253
    v_cos_f32 v198, v196
    v_cos_f32 v199, v197
    v_sin_f32 v196, v196
    v_sin_f32 v197, v197
    v_cvt_pk_bf16_f32 v9, v198, v199
    v_cvt_pk_bf16_f32 v17, v196, v197
    v_xor_b32 v25, 0x80008000, v17
    v_fmamk_f32 v196, v252, 0x41000000, v253
    v_fmamk_f32 v197, v252, 0x41100000, v253
    v_cos_f32 v198, v196
    v_cos_f32 v199, v197
    v_sin_f32 v196, v196
    v_sin_f32 v197, v197
    v_cvt_pk_bf16_f32 v10, v198, v199
    v_cvt_pk_bf16_f32 v18, v196, v197
    v_xor_b32 v26, 0x80008000, v18
    v_fmamk_f32 v196, v252, 0x41200000, v253
    v_fmamk_f32 v197, v252, 0x41300000, v253
    v_cos_f32 v198, v196
    v_cos_f32 v199, v197
    v_sin_f32 v196, v196
    v_sin_f32 v197, v197
    v_cvt_pk_bf16_f32 v11, v198, v199
    v_cvt_pk_bf16_f32 v19, v196, v197
    v_xor_b32 v27, 0x80008000, v19
    v_fmamk_f32 v196, v252, 0x41800000, v253
    v_fmamk_f32 v197, v252, 0x41880000, v253
    v_cos_f32 v198, v196
    v_cos_f32 v199, v197
    v_sin_f32 v196, v196
    v_sin_f32 v197, v197
    v_cvt_pk_bf16_f32 v12, v198, v199
    v_cvt_pk_bf16_f32 v20, v196, v197
    v_xor_b32 v28, 0x80008000, v20
    v_fmamk_f32 v196, v252, 0x41900000, v253
    v_fmamk_f32 v197, v252, 0x41980000, v253
    v_cos_f32 v198, v196
    v_cos_f32 v199, v197
    v_sin_f32 v196, v196
    v_sin_f32 v197, v197
    v_cvt_pk_bf16_f32 v13, v198, v199
    v_cvt_pk_bf16_f32 v21, v196, v197
    v_xor_b32 v29, 0x80008000, v21
    v_fmamk_f32 v196, v252, 0x41c00000, v253
    v_fmamk_f32 v197, v252, 0x41c80000, v253
    v_cos_f32 v198, v196
    v_cos_f32 v199, v197
    v_sin_f32 v196, v196
    v_sin_f32 v197, v197
    v_cvt_pk_bf16_f32 v14, v198, v199
    v_cvt_pk_bf16_f32 v22, v196, v197
    v_xor_b32 v30, 0x80008000, v22
    v_fmamk_f32 v196, v252, 0x41d00000, v253
    v_fmamk_f32 v197, v252, 0x41d80000, v253
    v_cos_f32 v198, v196
    v_cos_f32 v199, v197
    v_sin_f32 v196, v196
    v_sin_f32 v197, v197
    v_cvt_pk_bf16_f32 v15, v198, v199
    v_cvt_pk_bf16_f32 v23, v196, v197
    v_xor_b32 v31, 0x80008000, v23
L_nc_10:
    s_cmp_eq_u32 s91, 1
    s_cbranch_scc1 L_c0_ret
    s_cmp_eq_u32 s91, 2
    s_cbranch_scc1 L_c1
    s_and_b32 s52, s3, 1
    s_bfe_u32 s53, s3, 0x10001
    s_bfe_u32 s54, s3, 0x10002
    s_lshr_b32 s55, s3, 3
    s_lshl_b32 s56, s53, 10
    s_lshl_b32 s57, s54, 8
    s_add_u32 s56, s56, s57
    s_lshl_b32 s57, s55, 4
    s_add_u32 s56, s56, s57
    s_add_u32 s56, s56, s52
    s_mul_i32 s56, s56, 642
    s_mul_i32 s57, s39, 80
    s_add_u32 s56, s56, s57
    s_lshl_b32 s52, s52, 1
    s_add_u32 s60, s56, s52
    v_and_b32 v6, 7, v0
    v_mul_u32_u24 v6, 1284, v6
    v_lshrrev_b32 v2, 3, v0
    v_lshl_add_u32 v6, v2, 4, v6
    s_waitcnt lgkmcnt(0)
    s_barrier
    s_setprio 3
    s_cmp_lg_u32 s36, 4
    s_cbranch_scc1 L_p06_9
    buffer_load_dword v194, off, s[32:35], 0 sc1
    s_setprio 0
    s_branch L_epi_hi
L_p06_9:
    s_mov_b32 exec_hi, 0xffff
    s_cmp_eq_u32 s36, 7
    s_cbranch_scc1 L_w7_6
    s_add_u32 s57, s60, 0
    buffer_load_dwordx4 v[152:155], v6, s[12:15], s57 offen
    s_add_u32 s57, s60, 41088
    buffer_load_dwordx4 v[156:159], v6, s[12:15], s57 offen
    s_add_u32 s57, s60, 82176
    buffer_load_dwordx4 v[160:163], v6, s[12:15], s57 offen
    s_add_u32 s57, s60, 123264
    buffer_load_dwordx4 v[164:167], v6, s[12:15], s57 offen
    s_add_u32 s57, s60, 328704
    buffer_load_dwordx4 v[168:171], v6, s[12:15], s57 offen
    s_add_u32 s57, s60, 369792
    buffer_load_dwordx4 v[172:175], v6, s[12:15], s57 offen
    s_add_u32 s57, s60, 410880
    buffer_load_dwordx4 v[176:179], v6, s[12:15], s57 offen
    s_add_u32 s57, s60, 451968
    buffer_load_dwordx4 v[180:183], v6, s[12:15], s57 offen
    s_mov_b64 exec, -1
    s_setprio 0
    s_branch L_epi_hi
L_w7_6:
    s_add_u32 s57, s60, 0
    buffer_load_dwordx4 v[152:155], v6, s[16:19], s57 offen
    s_add_u32 s57, s60, 41088
    buffer_load_dwordx4 v[156:159], v6, s[16:19], s57 offen
    s_add_u32 s57, s60, 82176
    buffer_load_dwordx4 v[160:163], v6, s[16:19], s57 offen
    s_add_u32 s57, s60, 123264
    buffer_load_dwordx4 v[164:167], v6, s[16:19], s57 offen
    s_add_u32 s57, s60, 328704
    buffer_load_dwordx4 v[168:171], v6, s[16:19], s57 offen
    s_add_u32 s57, s60, 369792
    buffer_load_dwordx4 v[172:175], v6, s[16:19], s57 offen
    s_add_u32 s57, s60, 410880
    buffer_load_dwordx4 v[176:179], v6, s[16:19], s57 offen
    s_add_u32 s57, s60, 451968
    buffer_load_dwordx4 v[180:183], v6, s[16:19], s57 offen
    s_mov_b64 exec, -1
    s_setprio 0
    s_branch L_epi_hi
L_p05_8:
    s_cmp_lt_u32 s40, 30
    s_cbranch_scc1 L_p5b_14
    s_waitcnt lgkmcnt(0)
    s_barrier
    s_setprio 0
    s_branch L_epi_hi
L_p5b_14:
    v_lshrrev_b32 v2, 3, v0
    v_mul_u32_u24 v3, 3840, v2
    v_bfe_u32 v2, v0, 4, 1
    v_lshlrev_b32 v2, 1, v2
    v_and_b32 v4, 7, v0
    v_xor_b32 v2, v2, v4
    v_lshl_add_u32 v4, v2, 4, v3
    v_xor_b32 v5, 64, v4
    s_lshl_b32 s61, s40, 7
    s_mul_i32 s56, s39, 3
    s_lshr_b32 s56, s56, 3
    s_add_u32 s56, s56, 5
    s_mov_b32 s57, 5
    s_mov_b32 s58, 8
    s_mov_b32 s51, 0
L_wq_12:
    s_cmp_lg_u32 s51, 3
    s_cbranch_scc1 L_wn_13
    s_mul_i32 s56, s39, 5
    s_lshr_b32 s56, s56, 3
    s_mov_b32 s57, 0
    s_mov_b32 s58, 5
    s_waitcnt lgkmcnt(0)
    s_barrier
    s_setprio 2
L_wn_13:
    s_mul_i32 s53, s56, 307200
    s_mul_i32 s54, s56, 10240
    s_add_u32 m0, s54, 81920
    s_add_u32 s53, s53, s61
    s_add_u32 s56, s56, 1
    s_cmp_eq_u32 s56, s58
    s_cselect_b32 s56, s57, s56
    buffer_load_dwordx4 v4, s[20:23], s53 offen lds
    s_add_u32 m0, m0, 1024
    s_add_u32 s53, s53, 30720
    buffer_load_dwordx4 v5, s[20:23], s53 offen lds
    s_add_u32 m0, m0, 1024
    s_add_u32 s53, s53, 30720
    buffer_load_dwordx4 v4, s[20:23], s53 offen lds
    s_add_u32 m0, m0, 1024
    s_add_u32 s53, s53, 30720
    buffer_load_dwordx4 v5, s[20:23], s53 offen lds
    s_add_u32 m0, m0, 1024
    s_add_u32 s53, s53, 30720
    buffer_load_dwordx4 v4, s[20:23], s53 offen lds
    s_add_u32 m0, m0, 1024
    s_add_u32 s53, s53, 30720
    buffer_load_dwordx4 v5, s[20:23], s53 offen lds
    s_add_u32 m0, m0, 1024
    s_add_u32 s53, s53, 30720
    buffer_load_dwordx4 v4, s[20:23], s53 offen lds
    s_add_u32 m0, m0, 1024
    s_add_u32 s53, s53, 30720
    buffer_load_dwordx4 v5, s[20:23], s53 offen lds
    s_add_u32 m0, m0, 1024
    s_add_u32 s53, s53, 30720
    buffer_load_dwordx4 v4, s[20:23], s53 offen lds
    s_add_u32 m0, m0, 1024
    s_add_u32 s53, s53, 30720
    buffer_load_dwordx4 v5, s[20:23], s53 offen lds
    s_add_u32 s51, s51, 1
    s_cmp_lt_u32 s51, 8
    s_cbranch_scc1 L_wq_12
    s_setprio 0
    s_branch L_epi_hi
L_rows:
    s_and_b32 s40, s88, 24
    s_add_u32 s40, s40, s37
    s_mul_i32 s43, s37, 20
    s_add_u32 s43, s43, s88
    s_lshr_b32 s89, s37, 1
    s_add_u32 s89, s89, 8
    s_cmp_ge_u32 s88, 24
    s_cselect_b32 s89, s37, s89
    s_and_b32 s90, s37, 1
    s_lshl_b32 s90, s90, 2
    s_and_b32 s52, s88, 3
    s_add_u32 s90, s90, s52
    s_lshr_b32 s38, s37, 1
    s_lshl_b32 s38, s38, 3
    s_lshr_b32 s52, s88, 2
    s_add_u32 s38, s38, s52
    s_bfe_u32 s3, s88, 0x10003
    s_and_b32 s52, s37, 6
    s_or_b32 s3, s3, s52
    s_lshr_b32 s52, s88, 4
    s_lshl_b32 s52, s52, 3
    s_or_b32 s3, s3, s52
    s_and_b32 s52, s37, 1
    s_lshl_b32 s52, s52, 4
    s_or_b32 s3, s3, s52
    s_mov_b32 s74, 51200
    s_mov_b32 s44, 0
    s_mov_b32 s46, 262144
    s_mov_b32 s47, 5505024
    s_mov_b32 s48, 98304
    s_mov_b32 s49, 18317312
    s_mov_b32 s50, 29851648
    s_mov_b32 s14, 1314816
    s_mov_b32 s15, 0x00020000
    s_mov_b32 s18, 1314816
    s_mov_b32 s19, 0x00020000
    s_mov_b32 s22, 2457600
    s_mov_b32 s23, 0x00020000
    s_mov_b32 s26, 819200
    s_mov_b32 s27, 0x00020000
    s_mov_b32 s30, 2621440
    s_mov_b32 s31, 0x00020000
    s_mov_b32 s34, 256
    s_mov_b32 s35, 0x00020000
L_m7:
    s_lshr_b32 s52, s36, 1
    s_lshl_b32 s52, s52, 4
    v_and_b32 v1, 15, v0
    v_add_u32 v1, s52, v1
    v_cvt_f32_u32 v1, v1
    v_and_b32 v2, 32, v0
    v_bfe_u32 v3, v0, 4, 1
    v_lshl_add_u32 v2, v3, 3, v2
    v_cvt_f32_u32 v2, v2
    v_mul_f32 v5, 0x3d000000, v1
    v_mul_f32 v7, 0x3c800000, v1
    v_mul_f32 v6, v7, v2
    v_fmamk_f32 v8, v5, 0x00000000, v6
    v_fmamk_f32 v9, v5, 0x3f800000, v6
    v_cos_f32 v10, v8
    v_cos_f32 v11, v9
    v_sin_f32 v8, v8
    v_sin_f32 v9, v9
    v_mul_f32 v10, 0x3a000000, v10
    v_mul_f32 v11, 0x3a000000, v11
    v_mul_f32 v8, 0x3a000000, v8
    v_mul_f32 v9, 0x3a000000, v9
    v_cvt_pk_bf16_f32 v156, v10, v11
    v_cvt_pk_bf16_f32 v160, v8, v9
    v_xor_b32 v164, 0x80008000, v160
    v_fmamk_f32 v8, v5, 0x40000000, v6
    v_fmamk_f32 v9, v5, 0x40400000, v6
    v_cos_f32 v10, v8
    v_cos_f32 v11, v9
    v_sin_f32 v8, v8
    v_sin_f32 v9, v9
    v_mul_f32 v10, 0x3a000000, v10
    v_mul_f32 v11, 0x3a000000, v11
    v_mul_f32 v8, 0x3a000000, v8
    v_mul_f32 v9, 0x3a000000, v9
    v_cvt_pk_bf16_f32 v157, v10, v11
    v_cvt_pk_bf16_f32 v161, v8, v9
    v_xor_b32 v165, 0x80008000, v161
    v_fmamk_f32 v8, v5, 0x41000000, v6
    v_fmamk_f32 v9, v5, 0x41100000, v6
    v_cos_f32 v10, v8
    v_cos_f32 v11, v9
    v_sin_f32 v8, v8
    v_sin_f32 v9, v9
    v_mul_f32 v10, 0x3a000000, v10
    v_mul_f32 v11, 0x3a000000, v11
    v_mul_f32 v8, 0x3a000000, v8
    v_mul_f32 v9, 0x3a000000, v9
    v_cvt_pk_bf16_f32 v158, v10, v11
    v_cvt_pk_bf16_f32 v162, v8, v9
    v_xor_b32 v166, 0x80008000, v162
    v_fmamk_f32 v8, v5, 0x41200000, v6
    v_fmamk_f32 v9, v5, 0x41300000, v6
    v_cos_f32 v10, v8
    v_cos_f32 v11, v9
    v_sin_f32 v8, v8
    v_sin_f32 v9, v9
    v_mul_f32 v10, 0x3a000000, v10
    v_mul_f32 v11, 0x3a000000, v11
    v_mul_f32 v8, 0x3a000000, v8
    v_mul_f32 v9, 0x3a000000, v9
    v_cvt_pk_bf16_f32 v159, v10, v11
    v_cvt_pk_bf16_f32 v163, v8, v9
    v_xor_b32 v167, 0x80008000, v163
    v_add_f32 v6, v6, v7
    v_fmamk_f32 v8, v5, 0x00000000, v6
    v_fmamk_f32 v9, v5, 0x3f800000, v6
    v_cos_f32 v10, v8
    v_cos_f32 v11, v9
    v_sin_f32 v8, v8
    v_sin_f32 v9, v9
    v_mul_f32 v10, 0x3a000000, v10
    v_mul_f32 v11, 0x3a000000, v11
    v_mul_f32 v8, 0x3a000000, v8
    v_mul_f32 v9, 0x3a000000, v9
    v_cvt_pk_bf16_f32 v168, v10, v11
    v_cvt_pk_bf16_f32 v172, v8, v9
    v_xor_b32 v196, 0x80008000, v172
    v_fmamk_f32 v8, v5, 0x40000000, v6
    v_fmamk_f32 v9, v5, 0x40400000, v6
    v_cos_f32 v10, v8
    v_cos_f32 v11, v9
    v_sin_f32 v8, v8
    v_sin_f32 v9, v9
    v_mul_f32 v10, 0x3a000000, v10
    v_mul_f32 v11, 0x3a000000, v11
    v_mul_f32 v8, 0x3a000000, v8
    v_mul_f32 v9, 0x3a000000, v9
    v_cvt_pk_bf16_f32 v169, v10, v11
    v_cvt_pk_bf16_f32 v173, v8, v9
    v_xor_b32 v197, 0x80008000, v173
    v_fmamk_f32 v8, v5, 0x41000000, v6
    v_fmamk_f32 v9, v5, 0x41100000, v6
    v_cos_f32 v10, v8
    v_cos_f32 v11, v9
    v_sin_f32 v8, v8
    v_sin_f32 v9, v9
    v_mul_f32 v10, 0x3a000000, v10
    v_mul_f32 v11, 0x3a000000, v11
    v_mul_f32 v8, 0x3a000000, v8
    v_mul_f32 v9, 0x3a000000, v9
    v_cvt_pk_bf16_f32 v170, v10, v11
    v_cvt_pk_bf16_f32 v174, v8, v9
    v_xor_b32 v198, 0x80008000, v174
    v_fmamk_f32 v8, v5, 0x41200000, v6
    v_fmamk_f32 v9, v5, 0x41300000, v6
    v_cos_f32 v10, v8
    v_cos_f32 v11, v9
    v_sin_f32 v8, v8
    v_sin_f32 v9, v9
    v_mul_f32 v10, 0x3a000000, v10
    v_mul_f32 v11, 0x3a000000, v11
    v_mul_f32 v8, 0x3a000000, v8
    v_mul_f32 v9, 0x3a000000, v9
    v_cvt_pk_bf16_f32 v171, v10, v11
    v_cvt_pk_bf16_f32 v175, v8, v9
    v_xor_b32 v199, 0x80008000, v175
    s_cmp_lg_u32 s42, 0
    s_cbranch_scc1 L_tpoll
    v_lshlrev_b32 v1, 4, v0
    v_and_b32 v2, 15, v0
    v_lshlrev_b32 v2, 7, v2
    v_lshrrev_b32 v3, 4, v0
    v_and_b32 v4, 6, v0
    v_xor_b32 v3, v3, v4
    v_lshl_add_u32 v2, v3, 4, v2
    s_mul_i32 s52, s98, 20480
    s_add_u32 s52, s52, 51200
    v_add_u32 v2, s52, v2
    v_xor_b32 v3, 64, v2
    s_waitcnt vmcnt(0)
    ds_read_b128 v[16:19], v2 offset:0
    ds_read_b128 v[20:23], v3 offset:0
    ds_read_b128 v[24:27], v2 offset:2048
    ds_read_b128 v[28:31], v3 offset:2048
    ds_read_b128 v[32:35], v2 offset:4096
    ds_read_b128 v[36:39], v3 offset:4096
    ds_read_b128 v[40:43], v2 offset:6144
    ds_read_b128 v[44:47], v3 offset:6144
    ds_read_b128 v[48:51], v2 offset:8192
    ds_read_b128 v[52:55], v3 offset:8192
    ds_read_b128 v[56:59], v2 offset:10240
    ds_read_b128 v[60:63], v3 offset:10240
    ds_read_b128 v[64:67], v2 offset:12288
    ds_read_b128 v[68:71], v3 offset:12288
    ds_read_b128 v[72:75], v2 offset:14336
    ds_read_b128 v[76:79], v3 offset:14336
    ds_read_b128 v[80:83], v2 offset:16384
    ds_read_b128 v[84:87], v3 offset:16384
    ds_read_b128 v[88:91], v2 offset:18432
    ds_read_b128 v[92:95], v3 offset:18432
    s_setprio 2
    s_waitcnt lgkmcnt(0)
    s_barrier
    ds_read_b128 v[116:119], v1 offset:0
    ds_read_b128 v[120:123], v1 offset:1024
    ds_read_b128 v[124:127], v1 offset:2048
    ds_read_b128 v[128:131], v1 offset:3072
    ds_read_b128 v[132:135], v1 offset:4096
    s_waitcnt lgkmcnt(0)
    v_mfma_f32_16x16x32_bf16 v[176:179], v[16:19], v[116:119], 0
    ds_read_b128 v[136:139], v1 offset:5120
    ds_read_b128 v[140:143], v1 offset:6144
    v_mfma_f32_16x16x32_bf16 v[96:99], v[56:59], v[116:119], 0
    ds_read_b128 v[144:147], v1 offset:7168
    ds_read_b128 v[148:151], v1 offset:8192
    v_mfma_f32_16x16x32_bf16 v[180:183], v[16:19], v[120:123], 0
    ds_read_b128 v[152:155], v1 offset:9216
    v_mfma_f32_16x16x32_bf16 v[100:103], v[56:59], v[120:123], 0
    v_mfma_f32_16x16x32_bf16 v[184:187], v[16:19], v[124:127], 0
    v_mfma_f32_16x16x32_bf16 v[104:107], v[56:59], v[124:127], 0
    v_mfma_f32_16x16x32_bf16 v[188:191], v[16:19], v[128:131], 0
    v_mfma_f32_16x16x32_bf16 v[108:111], v[56:59], v[128:131], 0
    v_mfma_f32_16x16x32_bf16 v[192:195], v[16:19], v[132:135], 0
    v_mfma_f32_16x16x32_bf16 v[112:115], v[56:59], v[132:135], 0
    s_waitcnt lgkmcnt(0)
    v_mfma_f32_16x16x32_bf16 v[176:179], v[20:23], v[136:139], v[176:179]
    ds_read_b128 v[116:119], v1 offset:10240
    ds_read_b128 v[120:123], v1 offset:11264
    v_mfma_f32_16x16x32_bf16 v[96:99], v[60:63], v[136:139], v[96:99]
    ds_read_b128 v[124:127], v1 offset:12288
    ds_read_b128 v[128:131], v1 offset:13312
    v_mfma_f32_16x16x32_bf16 v[180:183], v[20:23], v[140:143], v[180:183]
    ds_read_b128 v[132:135], v1 offset:14336
    v_mfma_f32_16x16x32_bf16 v[100:103], v[60:63], v[140:143], v[100:103]
    v_mfma_f32_16x16x32_bf16 v[184:187], v[20:23], v[144:147], v[184:187]
    v_mfma_f32_16x16x32_bf16 v[104:107], v[60:63], v[144:147], v[104:107]
    v_mfma_f32_16x16x32_bf16 v[188:191], v[20:23], v[148:151], v[188:191]
    v_mfma_f32_16x16x32_bf16 v[108:111], v[60:63], v[148:151], v[108:111]
    v_mfma_f32_16x16x32_bf16 v[192:195], v[20:23], v[152:155], v[192:195]
    v_mfma_f32_16x16x32_bf16 v[112:115], v[60:63], v[152:155], v[112:115]
    s_waitcnt lgkmcnt(0)
    v_mfma_f32_16x16x32_bf16 v[176:179], v[24:27], v[116:119], v[176:179]
    ds_read_b128 v[136:139], v1 offset:15360
    ds_read_b128 v[140:143], v1 offset:16384
    v_mfma_f32_16x16x32_bf16 v[96:99], v[64:67], v[116:119], v[96:99]
    ds_read_b128 v[144:147], v1 offset:17408
    ds_read_b128 v[148:151], v1 offset:18432
    v_mfma_f32_16x16x32_bf16 v[180:183], v[24:27], v[120:123], v[180:183]
    ds_read_b128 v[152:155], v1 offset:19456
    v_mfma_f32_16x16x32_bf16 v[100:103], v[64:67], v[120:123], v[100:103]
    v_mfma_f32_16x16x32_bf16 v[184:187], v[24:27], v[124:127], v[184:187]
    v_mfma_f32_16x16x32_bf16 v[104:107], v[64:67], v[124:127], v[104:107]
    v_mfma_f32_16x16x32_bf16 v[188:191], v[24:27], v[128:131], v[188:191]
    v_mfma_f32_16x16x32_bf16 v[108:111], v[64:67], v[128:131], v[108:111]
    v_mfma_f32_16x16x32_bf16 v[192:195], v[24:27], v[132:135], v[192:195]
    v_mfma_f32_16x16x32_bf16 v[112:115], v[64:67], v[132:135], v[112:115]
    s_waitcnt lgkmcnt(0)
    v_mfma_f32_16x16x32_bf16 v[176:179], v[28:31], v[136:139], v[176:179]
    ds_read_b128 v[116:119], v1 offset:20480
    ds_read_b128 v[120:123], v1 offset:21504
    v_mfma_f32_16x16x32_bf16 v[96:99], v[68:71], v[136:139], v[96:99]
    ds_read_b128 v[124:127], v1 offset:22528
    ds_read_b128 v[128:131], v1 offset:23552
    v_mfma_f32_16x16x32_bf16 v[180:183], v[28:31], v[140:143], v[180:183]
    ds_read_b128 v[132:135], v1 offset:24576
    v_mfma_f32_16x16x32_bf16 v[100:103], v[68:71], v[140:143], v[100:103]
    v_mfma_f32_16x16x32_bf16 v[184:187], v[28:31], v[144:147], v[184:187]
    v_mfma_f32_16x16x32_bf16 v[104:107], v[68:71], v[144:147], v[104:107]
    v_mfma_f32_16x16x32_bf16 v[188:191], v[28:31], v[148:151], v[188:191]
    v_mfma_f32_16x16x32_bf16 v[108:111], v[68:71], v[148:151], v[108:111]
    v_mfma_f32_16x16x32_bf16 v[192:195], v[28:31], v[152:155], v[192:195]
    v_mfma_f32_16x16x32_bf16 v[112:115], v[68:71], v[152:155], v[112:115]
    s_waitcnt lgkmcnt(0)
    v_mfma_f32_16x16x32_bf16 v[176:179], v[32:35], v[116:119], v[176:179]
    ds_read_b128 v[136:139], v1 offset:25600
    ds_read_b128 v[140:143], v1 offset:26624
    v_mfma_f32_16x16x32_bf16 v[96:99], v[72:75], v[116:119], v[96:99]
    ds_read_b128 v[144:147], v1 offset:27648
    ds_read_b128 v[148:151], v1 offset:28672
    v_mfma_f32_16x16x32_bf16 v[180:183], v[32:35], v[120:123], v[180:183]
    ds_read_b128 v[152:155], v1 offset:29696
    v_mfma_f32_16x16x32_bf16 v[100:103], v[72:75], v[120:123], v[100:103]
    v_mfma_f32_16x16x32_bf16 v[184:187], v[32:35], v[124:127], v[184:187]
    v_mfma_f32_16x16x32_bf16 v[104:107], v[72:75], v[124:127], v[104:107]
    v_mfma_f32_16x16x32_bf16 v[188:191], v[32:35], v[128:131], v[188:191]
    v_mfma_f32_16x16x32_bf16 v[108:111], v[72:75], v[128:131], v[108:111]
    v_mfma_f32_16x16x32_bf16 v[192:195], v[32:35], v[132:135], v[192:195]
    v_mfma_f32_16x16x32_bf16 v[112:115], v[72:75], v[132:135], v[112:115]
    s_waitcnt lgkmcnt(0)
    v_mfma_f32_16x16x32_bf16 v[176:179], v[36:39], v[136:139], v[176:179]
    ds_read_b128 v[116:119], v1 offset:30720
    ds_read_b128 v[120:123], v1 offset:31744
    v_mfma_f32_16x16x32_bf16 v[96:99], v[76:79], v[136:139], v[96:99]
    ds_read_b128 v[124:127], v1 offset:32768
    ds_read_b128 v[128:131], v1 offset:33792
    v_mfma_f32_16x16x32_bf16 v[180:183], v[36:39], v[140:143], v[180:183]
    ds_read_b128 v[132:135], v1 offset:34816
    v_mfma_f32_16x16x32_bf16 v[100:103], v[76:79], v[140:143], v[100:103]
    v_mfma_f32_16x16x32_bf16 v[184:187], v[36:39], v[144:147], v[184:187]
    v_mfma_f32_16x16x32_bf16 v[104:107], v[76:79], v[144:147], v[104:107]
    v_mfma_f32_16x16x32_bf16 v[188:191], v[36:39], v[148:151], v[188:191]
    v_mfma_f32_16x16x32_bf16 v[108:111], v[76:79], v[148:151], v[108:111]
    v_mfma_f32_16x16x32_bf16 v[192:195], v[36:39], v[152:155], v[192:195]
    v_mfma_f32_16x16x32_bf16 v[112:115], v[76:79], v[152:155], v[112:115]
    s_waitcnt lgkmcnt(0)
    v_mfma_f32_16x16x32_bf16 v[176:179], v[40:43], v[116:119], v[176:179]
    ds_read_b128 v[136:139], v1 offset:35840
    ds_read_b128 v[140:143], v1 offset:36864
    v_mfma_f32_16x16x32_bf16 v[96:99], v[80:83], v[116:119], v[96:99]
    ds_read_b128 v[144:147], v1 offset:37888
    ds_read_b128 v[148:151], v1 offset:38912
    v_mfma_f32_16x16x32_bf16 v[180:183], v[40:43], v[120:123], v[180:183]
    ds_read_b128 v[152:155], v1 offset:39936
    v_mfma_f32_16x16x32_bf16 v[100:103], v[80:83], v[120:123], v[100:103]
    v_mfma_f32_16x16x32_bf16 v[184:187], v[40:43], v[124:127], v[184:187]
    v_mfma_f32_16x16x32_bf16 v[104:107], v[80:83], v[124:127], v[104:107]
    v_mfma_f32_16x16x32_bf16 v[188:191], v[40:43], v[128:131], v[188:191]
    v_mfma_f32_16x16x32_bf16 v[108:111], v[80:83], v[128:131], v[108:111]
    v_mfma_f32_16x16x32_bf16 v[192:195], v[40:43], v[132:135], v[192:195]
    v_mfma_f32_16x16x32_bf16 v[112:115], v[80:83], v[132:135], v[112:115]
    s_waitcnt lgkmcnt(0)
    v_mfma_f32_16x16x32_bf16 v[176:179], v[44:47], v[136:139], v[176:179]
    ds_read_b128 v[116:119], v1 offset:40960
    ds_read_b128 v[120:123], v1 offset:41984
    v_mfma_f32_16x16x32_bf16 v[96:99], v[84:87], v[136:139], v[96:99]
    ds_read_b128 v[124:127], v1 offset:43008
    ds_read_b128 v[128:131], v1 offset:44032
    v_mfma_f32_16x16x32_bf16 v[180:183], v[44:47], v[140:143], v[180:183]
    ds_read_b128 v[132:135], v1 offset:45056
    v_mfma_f32_16x16x32_bf16 v[100:103], v[84:87], v[140:143], v[100:103]
    v_mfma_f32_16x16x32_bf16 v[184:187], v[44:47], v[144:147], v[184:187]
    v_mfma_f32_16x16x32_bf16 v[104:107], v[84:87], v[144:147], v[104:107]
    v_mfma_f32_16x16x32_bf16 v[188:191], v[44:47], v[148:151], v[188:191]
    v_mfma_f32_16x16x32_bf16 v[108:111], v[84:87], v[148:151], v[108:111]
    v_mfma_f32_16x16x32_bf16 v[192:195], v[44:47], v[152:155], v[192:195]
    v_mfma_f32_16x16x32_bf16 v[112:115], v[84:87], v[152:155], v[112:115]
    s_waitcnt lgkmcnt(0)
    v_mfma_f32_16x16x32_bf16 v[176:179], v[48:51], v[116:119], v[176:179]
    ds_read_b128 v[136:139], v1 offset:46080
    ds_read_b128 v[140:143], v1 offset:47104
    v_mfma_f32_16x16x32_bf16 v[96:99], v[88:91], v[116:119], v[96:99]
    ds_read_b128 v[144:147], v1 offset:48128
    ds_read_b128 v[148:151], v1 offset:49152
    v_mfma_f32_16x16x32_bf16 v[180:183], v[48:51], v[120:123], v[180:183]
    ds_read_b128 v[152:155], v1 offset:50176
    v_mfma_f32_16x16x32_bf16 v[100:103], v[88:91], v[120:123], v[100:103]
    v_mfma_f32_16x16x32_bf16 v[184:187], v[48:51], v[124:127], v[184:187]
    v_mfma_f32_16x16x32_bf16 v[104:107], v[88:91], v[124:127], v[104:107]
    v_mfma_f32_16x16x32_bf16 v[188:191], v[48:51], v[128:131], v[188:191]
    v_mfma_f32_16x16x32_bf16 v[108:111], v[88:91], v[128:131], v[108:111]
    v_mfma_f32_16x16x32_bf16 v[192:195], v[48:51], v[132:135], v[192:195]
    v_mfma_f32_16x16x32_bf16 v[112:115], v[88:91], v[132:135], v[112:115]
    s_waitcnt lgkmcnt(0)
    v_mfma_f32_16x16x32_bf16 v[176:179], v[52:55], v[136:139], v[176:179]
    v_mfma_f32_16x16x32_bf16 v[96:99], v[92:95], v[136:139], v[96:99]
    v_mfma_f32_16x16x32_bf16 v[180:183], v[52:55], v[140:143], v[180:183]
    v_mfma_f32_16x16x32_bf16 v[100:103], v[92:95], v[140:143], v[100:103]
    v_mfma_f32_16x16x32_bf16 v[184:187], v[52:55], v[144:147], v[184:187]
    v_mfma_f32_16x16x32_bf16 v[104:107], v[92:95], v[144:147], v[104:107]
    v_mfma_f32_16x16x32_bf16 v[188:191], v[52:55], v[148:151], v[188:191]
    v_mfma_f32_16x16x32_bf16 v[108:111], v[92:95], v[148:151], v[108:111]
    v_mfma_f32_16x16x32_bf16 v[192:195], v[52:55], v[152:155], v[192:195]
    v_mfma_f32_16x16x32_bf16 v[112:115], v[92:95], v[152:155], v[112:115]
    v_and_b32 v2, 2, v0
    v_lshlrev_b32 v2, 30, v2
    v_xor_b32 v2, 0xbd64f92e, v2
    v_mov_b32 v3, 0x3d64f92e
    v_mul_f32 v176, v3, v176
    v_mul_f32 v177, v3, v177
    v_mul_f32 v178, v3, v178
    v_mul_f32 v179, v3, v179
    v_mul_f32 v180, v3, v180
    v_mul_f32 v181, v3, v181
    v_mul_f32 v182, v3, v182
    v_mul_f32 v183, v3, v183
    v_mul_f32 v184, v3, v184
    v_mul_f32 v185, v3, v185
    v_mul_f32 v186, v3, v186
    v_mul_f32 v187, v3, v187
    v_mul_f32 v188, v3, v188
    v_mul_f32 v189, v3, v189
    v_mul_f32 v190, v3, v190
    v_mul_f32 v191, v3, v191
    v_mul_f32 v192, v3, v192
    v_mul_f32 v193, v3, v193
    v_mul_f32 v194, v3, v194
    v_mul_f32 v195, v3, v195
    v_fmac_f32 v176, v2, v96
    v_fmac_f32 v177, v2, v97
    v_fmac_f32 v178, v2, v98
    v_fmac_f32 v179, v2, v99
    v_fmac_f32 v180, v2, v100
    v_fmac_f32 v181, v2, v101
    v_fmac_f32 v182, v2, v102
    v_fmac_f32 v183, v2, v103
    v_fmac_f32 v184, v2, v104
    v_fmac_f32 v185, v2, v105
    v_fmac_f32 v186, v2, v106
    v_fmac_f32 v187, v2, v107
    v_fmac_f32 v188, v2, v108
    v_fmac_f32 v189, v2, v109
    v_fmac_f32 v190, v2, v110
    v_fmac_f32 v191, v2, v111
    v_fmac_f32 v192, v2, v112
    v_fmac_f32 v193, v2, v113
    v_fmac_f32 v194, v2, v114
    v_fmac_f32 v195, v2, v115
L_epi_lo:
    v_and_b32 v2, 15, v0
    v_mul_u32_u24 v2, 144, v2
    v_lshrrev_b32 v3, 4, v0
    v_lshl_add_u32 v2, v3, 3, v2
    s_lshl_b32 s52, s98, 5
    s_add_u32 s52, s52, s74
    v_add_u32 v2, s52, v2
    v_cvt_pk_bf16_f32 v4, v176, v177
    v_cvt_pk_bf16_f32 v5, v178, v179
    ds_write_b64 v2, v[4:5] offset:0
    v_cvt_pk_bf16_f32 v6, v180, v181
    v_cvt_pk_bf16_f32 v7, v182, v183
    ds_write_b64 v2, v[6:7] offset:2304
    v_cvt_pk_bf16_f32 v8, v184, v185
    v_cvt_pk_bf16_f32 v9, v186, v187
    ds_write_b64 v2, v[8:9] offset:4608
    v_cvt_pk_bf16_f32 v10, v188, v189
    v_cvt_pk_bf16_f32 v11, v190, v191
    ds_write_b64 v2, v[10:11] offset:6912
    v_cvt_pk_bf16_f32 v12, v192, v193
    v_cvt_pk_bf16_f32 v13, v194, v195
    ds_write_b64 v2, v[12:13] offset:9216
    v_and_b32 v2, 15, v0
    s_cmp_eq_u32 s39, 7
    s_cselect_b32 s52, 15, 99
    v_cmp_ne_u32 vcc, s52, v2
    v_mul_f32 v16, v176, v176
    v_mul_f32 v17, v177, v177
    v_mul_f32 v18, v178, v178
    v_mul_f32 v19, v179, v179
    v_cndmask_b32 v192, 0, v192, vcc
    v_cndmask_b32 v193, 0, v193, vcc
    v_cndmask_b32 v194, 0, v194, vcc
    v_cndmask_b32 v195, 0, v195, vcc
    v_fmac_f32 v16, v180, v180
    v_fmac_f32 v17, v181, v181
    v_fmac_f32 v18, v182, v182
    v_fmac_f32 v19, v183, v183
    v_fmac_f32 v16, v184, v184
    v_fmac_f32 v17, v185, v185
    v_fmac_f32 v18, v186, v186
    v_fmac_f32 v19, v187, v187
    v_fmac_f32 v16, v188, v188
    v_fmac_f32 v17, v189, v189
    v_fmac_f32 v18, v190, v190
    v_fmac_f32 v19, v191, v191
    v_fmac_f32 v16, v192, v192
    v_fmac_f32 v17, v193, v193
    v_fmac_f32 v18, v194, v194
    v_fmac_f32 v19, v195, v195
    v_add_f32_dpp v16, v16, v16 row_ror:8 row_mask:0xf bank_mask:0xf
    v_add_f32_dpp v17, v17, v17 row_ror:8 row_mask:0xf bank_mask:0xf
    v_add_f32_dpp v18, v18, v18 row_ror:8 row_mask:0xf bank_mask:0xf
    v_add_f32_dpp v19, v19, v19 row_ror:8 row_mask:0xf bank_mask:0xf
    v_add_f32_dpp v16, v16, v16 row_ror:4 row_mask:0xf bank_mask:0xf
    v_add_f32_dpp v17, v17, v17 row_ror:4 row_mask:0xf bank_mask:0xf
    v_add_f32_dpp v18, v18, v18 row_ror:4 row_mask:0xf bank_mask:0xf
    v_add_f32_dpp v19, v19, v19 row_ror:4 row_mask:0xf bank_mask:0xf
    v_add_f32_dpp v16, v16, v16 row_ror:2 row_mask:0xf bank_mask:0xf
    v_add_f32_dpp v17, v17, v17 row_ror:2 row_mask:0xf bank_mask:0xf
    v_add_f32_dpp v18, v18, v18 row_ror:2 row_mask:0xf bank_mask:0xf
    v_add_f32_dpp v19, v19, v19 row_ror:2 row_mask:0xf bank_mask:0xf
    v_add_f32_dpp v16, v16, v16 row_ror:1 row_mask:0xf bank_mask:0xf
    v_add_f32_dpp v17, v17, v17 row_ror:1 row_mask:0xf bank_mask:0xf
    v_add_f32_dpp v18, v18, v18 row_ror:1 row_mask:0xf bank_mask:0xf
    v_add_f32_dpp v19, v19, v19 row_ror:1 row_mask:0xf bank_mask:0xf
    v_and_b32 v3, 48, v0
    s_lshl_b32 s52, s36, 6
    s_add_u32 s52, s52, s74
    v_add_u32 v3, s52, v3
    ds_write_b128 v3, v[16:19] offset:11520
    v_mov_b32 v2, s74
    v_mov_b32 v3, 0
    ds_write_b32 v2, v3 offset:11776
    s_setprio 0
    s_waitcnt lgkmcnt(0)
    s_barrier
    s_cmp_eq_u32 s42, 0
    s_cbranch_scc1 L_ew_15
    s_barrier
    s_cmp_lt_u32 s88, 20
    s_cbranch_scc1 L_m7
    s_branch L_unstash
L_ew_15:
    s_mul_i32 s52, s40, 26
    s_lshr_b32 s52, s52, 8
    s_mul_i32 s57, s52, 10
    s_sub_u32 s57, s40, s57
    s_lshl_b32 s57, s57, 2
    s_add_u32 s57, s57, s36
    s_lshl_b32 s57, s57, 4
    s_mul_i32 s58, s52, 5
    s_sub_u32 s58, s58, 5
    s_mov_b32 s55, 0x3d64f92e
    s_cmp_lt_u32 s40, 10
    s_cselect_b32 s55, 0x3c93bb63, s55
    s_cselect_b32 s58, 10, s58
    s_lshr_b32 s52, s57, 2
    v_bfe_u32 v2, v0, 2, 2
    v_add_u32 v2, s52, v2
    v_mul_u32_u24 v3, 205, v2
    v_lshrrev_b32 v3, 10, v3
    v_mul_u32_u24 v204, 102400, v3
    v_mul_u32_u24 v3, 5, v3
    v_sub_u32 v2, v2, v3
    v_add_u32 v2, s58, v2
    v_lshrrev_b32 v3, 2, v2
    v_mul_u32_u24 v3, 20480, v3
    v_and_b32 v2, 3, v2
    v_lshl_add_u32 v3, v2, 8, v3
    v_and_b32 v4, 3, v0
    v_lshl_add_u32 v3, v4, 4, v3
    v_add_u32 v3, v3, v204
    v_sub_u32 v2, 0, v2
    v_lshrrev_b32 v4, 4, v0
    v_xor_b32 v4, v4, v2
    v_and_b32 v4, 3, v4
    v_lshl_add_u32 v204, v4, 6, v3
    s_and_b32 s53, s39, 1
    s_lshl_b32 s52, s53, 1
    v_lshrrev_b32 v4, 5, v0
    v_add_u32 v4, s52, v4
    v_xor_b32 v4, v4, v2
    v_and_b32 v4, 3, v4
    v_lshl_add_u32 v205, v4, 6, v3
    s_lshr_b32 s52, s39, 1
    s_mul_i32 s52, s52, 5120
    s_add_u32 s52, s52, 13402112
    s_lshl_b32 s62, s53, 11
    s_add_u32 s62, s62, s52
    s_add_u32 s63, s62, 1024
    s_add_u32 s64, s52, 4096
    s_cmp_eq_u32 s39, 7
    s_cselect_b32 s52, 48, 99
    v_cmp_gt_u32 vcc, s52, v0
    v_mov_b32 v200, s55
    v_mov_b32 v201, s55
    v_mov_b32 v202, s55
    v_cndmask_b32 v203, 0, v200, vcc
    v_lshlrev_b32 v1, 4, v0
    v_bfe_u32 v2, v0, 2, 2
    v_lshrrev_b32 v3, 4, v0
    v_lshl_add_u32 v4, v3, 3, v2
    v_lshlrev_b32 v4, 7, v4
    v_bfe_u32 v5, v0, 3, 2
    v_xor_b32 v5, s36, v5
    v_lshl_add_u32 v4, v5, 5, v4
    v_and_b32 v5, 3, v0
    v_lshl_add_u32 v4, v5, 3, v4
    v_add_u32 v206, 81920, v4
    v_add_u32 v207, 122880, v4
    s_barrier
    s_branch L_post_lo
L_epi_hi:
    s_cmp_lg_u32 s42, 0
    s_cbranch_scc1 L_c1
    s_cmp_lg_u32 s36, 4
    s_cbranch_scc1 L_eo_17
L_c1:
    s_cmp_ge_u32 s88, 20
    s_cbranch_scc1 L_nc_19
    s_and_b32 s52, s36, 1
    v_and_b32 v252, 31, v0
    v_lshrrev_b32 v253, 5, v0
    v_lshlrev_b32 v253, 2, v253
    v_cvt_f32_u32 v254, v252
    v_lshl_add_u32 v252, v252, 1, s52
    v_cvt_f32_u32 v252, v252
    v_cvt_f32_u32 v195, v253
    v_mul_f32 v252, 0x3a000000, v252
    v_mul_f32 v253, v252, v195
    v_fmamk_f32 v72, v252, 0x00000000, v253
    v_fmamk_f32 v73, v252, 0x3f800000, v253
    v_fmamk_f32 v74, v252, 0x40000000, v253
    v_fmamk_f32 v75, v252, 0x40400000, v253
    v_fmamk_f32 v76, v252, 0x41000000, v253
    v_fmamk_f32 v77, v252, 0x41100000, v253
    v_fmamk_f32 v78, v252, 0x41200000, v253
    v_fmamk_f32 v79, v252, 0x41300000, v253
    v_fmamk_f32 v80, v252, 0x41800000, v253
    v_fmamk_f32 v81, v252, 0x41880000, v253
    v_fmamk_f32 v82, v252, 0x41900000, v253
    v_fmamk_f32 v83, v252, 0x41980000, v253
    v_fmamk_f32 v84, v252, 0x41c00000, v253
    v_fmamk_f32 v85, v252, 0x41c80000, v253
    v_fmamk_f32 v86, v252, 0x41d00000, v253
    v_fmamk_f32 v87, v252, 0x41d80000, v253
    v_cos_f32 v56, v72
    v_sin_f32 v72, v72
    v_cos_f32 v57, v73
    v_sin_f32 v73, v73
    v_cos_f32 v58, v74
    v_sin_f32 v74, v74
    v_cos_f32 v59, v75
    v_sin_f32 v75, v75
    v_cos_f32 v60, v76
    v_sin_f32 v76, v76
    v_cos_f32 v61, v77
    v_sin_f32 v77, v77
    v_cos_f32 v62, v78
    v_sin_f32 v78, v78
    v_cos_f32 v63, v79
    v_sin_f32 v79, v79
    v_cos_f32 v64, v80
    v_sin_f32 v80, v80
    v_cos_f32 v65, v81
    v_sin_f32 v81, v81
    v_cos_f32 v66, v82
    v_sin_f32 v82, v82
    v_cos_f32 v67, v83
    v_sin_f32 v83, v83
    v_cos_f32 v68, v84
    v_sin_f32 v84, v84
    v_cos_f32 v69, v85
    v_sin_f32 v85, v85
    v_cos_f32 v70, v86
    v_sin_f32 v86, v86
    v_cos_f32 v71, v87
    v_sin_f32 v87, v87
    v_mul_f32 v252, 0x3d000000, v254
    v_mul_f32 v253, v252, v195
    v_fmamk_f32 v196, v252, 0x00000000, v253
    v_fmamk_f32 v197, v252, 0x3f800000, v253
    v_cos_f32 v198, v196
    v_cos_f32 v199, v197
    v_sin_f32 v196, v196
    v_sin_f32 v197, v197
    v_cvt_pk_bf16_f32 v32, v198, v199
    v_cvt_pk_bf16_f32 v40, v196, v197
    v_xor_b32 v48, 0x80008000, v40
    v_fmamk_f32 v196, v252, 0x40000000, v253
    v_fmamk_f32 v197, v252, 0x40400000, v253
    v_cos_f32 v198, v196
    v_cos_f32 v199, v197
    v_sin_f32 v196, v196
    v_sin_f32 v197, v197
    v_cvt_pk_bf16_f32 v33, v198, v199
    v_cvt_pk_bf16_f32 v41, v196, v197
    v_xor_b32 v49, 0x80008000, v41
    v_fmamk_f32 v196, v252, 0x41000000, v253
    v_fmamk_f32 v197, v252, 0x41100000, v253
    v_cos_f32 v198, v196
    v_cos_f32 v199, v197
    v_sin_f32 v196, v196
    v_sin_f32 v197, v197
    v_cvt_pk_bf16_f32 v34, v198, v199
    v_cvt_pk_bf16_f32 v42, v196, v197
    v_xor_b32 v50, 0x80008000, v42
    v_fmamk_f32 v196, v252, 0x41200000, v253
    v_fmamk_f32 v197, v252, 0x41300000, v253
    v_cos_f32 v198, v196
    v_cos_f32 v199, v197
    v_sin_f32 v196, v196
    v_sin_f32 v197, v197
    v_cvt_pk_bf16_f32 v35, v198, v199
    v_cvt_pk_bf16_f32 v43, v196, v197
    v_xor_b32 v51, 0x80008000, v43
    v_fmamk_f32 v196, v252, 0x41800000, v253
    v_fmamk_f32 v197, v252, 0x41880000, v253
    v_cos_f32 v198, v196
    v_cos_f32 v199, v197
    v_sin_f32 v196, v196
    v_sin_f32 v197, v197
    v_cvt_pk_bf16_f32 v36, v198, v199
    v_cvt_pk_bf16_f32 v44, v196, v197
    v_xor_b32 v52, 0x80008000, v44
    v_fmamk_f32 v196, v252, 0x41900000, v253
    v_fmamk_f32 v197, v252, 0x41980000, v253
    v_cos_f32 v198, v196
    v_cos_f32 v199, v197
    v_sin_f32 v196, v196
    v_sin_f32 v197, v197
    v_cvt_pk_bf16_f32 v37, v198, v199
    v_cvt_pk_bf16_f32 v45, v196, v197
    v_xor_b32 v53, 0x80008000, v45
    v_fmamk_f32 v196, v252, 0x41c00000, v253
    v_fmamk_f32 v197, v252, 0x41c80000, v253
    v_cos_f32 v198, v196
    v_cos_f32 v199, v197
    v_sin_f32 v196, v196
    v_sin_f32 v197, v197
    v_cvt_pk_bf16_f32 v38, v198, v199
    v_cvt_pk_bf16_f32 v46, v196, v197
    v_xor_b32 v54, 0x80008000, v46
    v_fmamk_f32 v196, v252, 0x41d00000, v253
    v_fmamk_f32 v197, v252, 0x41d80000, v253
    v_cos_f32 v198, v196
    v_cos_f32 v199, v197
    v_sin_f32 v196, v196
    v_sin_f32 v197, v197
    v_cvt_pk_bf16_f32 v39, v198, v199
    v_cvt_pk_bf16_f32 v47, v196, v197
    v_xor_b32 v55, 0x80008000, v47
L_nc_19:
    s_cmp_lg_u32 s42, 0
    s_cbranch_scc1 L_c2
L_c2_ret:
    s_cmp_eq_u32 s36, 4
    s_cbranch_scc1 L_ec_16
    s_cmp_eq_u32 s42, 0
    s_cbranch_scc1 L_post_hi
    s_barrier
    s_cmp_lg_u32 s36, 5
    s_cbranch_scc1 L_ow_21
    s_lshl_b32 s53, s39, 5
    s_add_u32 s53, s53, s41
    s_lshl_b32 s53, s53, 5
    s_add_u32 s53, s53, s42
    s_lshl_b32 s53, s53, 2
    s_add_u32 s53, s53, 32768
    s_atomic_add s75, s[4:5], s53
L_ow_21:
    s_barrier
    s_branch L_unstash
L_eo_17:
    s_cmp_eq_u32 s36, 5
    s_cbranch_scc1 L_enf_18
    s_and_b32 s52, s3, 1
    s_cselect_b32 s58, -1, 0xffffff00
    s_cselect_b32 s59, 0, 0xff00
    s_or_b32 s59, s59, 0xff
    s_mul_i32 s56, s52, 12288
    s_and_b32 s52, s36, 1
    s_lshl_b32 s52, s52, 11
    s_add_u32 s56, s56, s52
    s_bfe_u32 s52, s3, 0x10001
    s_lshl_b32 s52, s52, 10
    s_add_u32 s56, s56, s52
    s_bfe_u32 s52, s3, 0x10002
    s_lshl_b32 s52, s52, 9
    s_add_u32 s56, s56, s52
    s_lshr_b32 s52, s3, 3
    s_lshl_b32 s52, s52, 7
    s_add_u32 s56, s56, s52
    s_mul_i32 s52, s39, 327680
    s_add_u32 s56, s56, s52
    s_add_u32 s56, s56, 10772480
    v_and_b32 v2, 7, v0
    v_lshlrev_b32 v2, 4, v2
    v_lshrrev_b32 v3, 3, v0
    v_lshl_add_u32 v2, v3, 16, v2
    s_mov_b32 s54, 0x05040100
    s_mov_b32 s55, 0x07060302
    s_waitcnt vmcnt(0)
    v_perm_b32 v200, v156, v152, s54
    v_perm_b32 v201, v164, v160, s54
    v_perm_b32 v202, v172, v168, s54
    v_perm_b32 v203, v180, v176, s54
    v_perm_b32 v204, v156, v152, s55
    v_perm_b32 v205, v164, v160, s55
    v_perm_b32 v206, v172, v168, s55
    v_perm_b32 v207, v180, v176, s55
    v_perm_b32 v208, v157, v153, s54
    v_perm_b32 v209, v165, v161, s54
    v_perm_b32 v210, v173, v169, s54
    v_perm_b32 v211, v181, v177, s54
    v_perm_b32 v212, v157, v153, s55
    v_perm_b32 v213, v165, v161, s55
    v_perm_b32 v214, v173, v169, s55
    v_perm_b32 v215, v181, v177, s55
    v_perm_b32 v216, v158, v154, s54
    v_perm_b32 v217, v166, v162, s54
    v_perm_b32 v218, v174, v170, s54
    v_perm_b32 v219, v182, v178, s54
    v_perm_b32 v220, v158, v154, s55
    v_perm_b32 v221, v166, v162, s55
    v_perm_b32 v222, v174, v170, s55
    v_perm_b32 v223, v182, v178, s55
    v_perm_b32 v224, v159, v155, s54
    v_perm_b32 v225, v167, v163, s54
    v_perm_b32 v226, v175, v171, s54
    v_perm_b32 v227, v183, v179, s54
    v_perm_b32 v228, v159, v155, s55
    v_perm_b32 v229, v167, v163, s55
    v_perm_b32 v230, v175, v171, s55
    v_perm_b32 v231, v183, v179, s55
    s_mov_b32 exec_lo, s58
    s_mov_b32 exec_hi, s59
    s_add_u32 s57, s56, 0
    buffer_store_dwordx4 v[200:203], v2, s[4:7], s57 offen sc1
    s_mov_b32 exec_lo, -1
    s_mov_b32 exec_hi, 0xff
    s_add_u32 s57, s56, 8192
    buffer_store_dwordx4 v[204:207], v2, s[4:7], s57 offen sc1
    s_add_u32 s57, s56, 16384
    buffer_store_dwordx4 v[208:211], v2, s[4:7], s57 offen sc1
    s_add_u32 s57, s56, 24576
    buffer_store_dwordx4 v[212:215], v2, s[4:7], s57 offen sc1
    s_add_u32 s57, s56, 32768
    buffer_store_dwordx4 v[216:219], v2, s[4:7], s57 offen sc1
    s_add_u32 s57, s56, 40960
    buffer_store_dwordx4 v[220:223], v2, s[4:7], s57 offen sc1
    s_add_u32 s57, s56, 49152
    buffer_store_dwordx4 v[224:227], v2, s[4:7], s57 offen sc1
    s_add_u32 s57, s56, 57344
    buffer_store_dwordx4 v[228:231], v2, s[4:7], s57 offen sc1
    s_mov_b64 exec, -1
L_enf_18:
    s_barrier
    s_waitcnt vmcnt(0)
    s_barrier
    s_mov_b32 s91, 2
    s_cmp_eq_u32 s36, 5
    s_cbranch_scc1 L_c0
    s_branch L_c1
L_ec_16:
    s_cmp_lg_u32 s42, 0
    s_cbranch_scc1 L_zd_22
    v_mov_b32 v3, 0
    s_waitcnt vmcnt(0)
    v_cmp_gt_u32 vcc, 27, v194
    s_nop 0
    s_cbranch_vccz L_zd_22
    s_mov_b32 s52, s44
L_poll_23:
    buffer_load_dword v2, v3, s[32:35], 0 offen sc1
    s_add_u32 s52, s52, 1
    s_cmp_ge_u32 s52, 65536
    s_cselect_b32 s44, 65536, s44
    s_waitcnt vmcnt(0)
    s_cbranch_scc1 L_pd_24
    v_cmp_gt_u32 vcc, 27, v2
    s_nop 0
    s_cbranch_vccnz L_poll_23
L_pd_24:
L_zd_22:
    v_lshrrev_b32 v2, 3, v0
    v_and_b32 v3, 7, v0
    v_lshlrev_b32 v5, 12, v2
    v_lshl_add_u32 v5, v3, 4, v5
    s_mul_i32 s56, s39, 327680
    s_lshl_b32 s57, s41, 7
    s_add_u32 s56, s56, s57
    s_add_u32 s56, s56, s46
    v_mul_u32_u24 v4, 144, v2
    v_lshl_add_u32 v4, v3, 4, v4
    v_add_u32 v4, s74, v4
    v_lshlrev_b32 v6, 2, v0
    v_add_u32 v6, s74, v6
    s_lshl_b32 s57, s41, 9
    s_add_u32 s57, s57, s48
    s_setprio 3
    s_barrier
    ds_read_b32 v7, v6 offset:11520
    ds_read_b128 v[152:155], v4 offset:0
    ds_read_b128 v[156:159], v4 offset:1152
    ds_read_b128 v[160:163], v4 offset:2304
    ds_read_b128 v[164:167], v4 offset:3456
    ds_read_b128 v[168:171], v4 offset:4608
    ds_read_b128 v[172:175], v4 offset:5760
    ds_read_b128 v[176:179], v4 offset:6912
    ds_read_b128 v[180:183], v4 offset:8064
    ds_read_b128 v[184:187], v4 offset:9216
    ds_read_b128 v[188:191], v4 offset:10368
    v_lshlrev_b32 v6, 3, v0
    s_waitcnt lgkmcnt(10)
    v_cmp_nge_f32 vcc, 0x4c800000, v7
    v_mov_b32 v195, 1
    s_cbranch_vccnz L_big_put
L_big_ret:
    v_mul_f32 v193, 4.0, v7
    v_floor_f32 v193, v193
    v_fmac_f32 v7, 0xbe800000, v193
    v_mul_f32 v7, 0x4a800000, v7
    v_add_f32 v7, 0.5, v7
    v_cvt_u32_f32 v193, v193
    v_cvt_u32_f32 v192, v7
    v_min_u32 v192, 0x000fffff, v192
    v_lshl_or_b32 v192, v192, 12, v195
    buffer_atomic_add_x2 v[192:193], v6, s[4:7], s57 offen sc1
    s_waitcnt lgkmcnt(9)
    buffer_store_dwordx4 v[152:155], v5, s[4:7], s56 offen sc1
    s_add_u32 s56, s56, 32768
    s_waitcnt lgkmcnt(8)
    buffer_store_dwordx4 v[156:159], v5, s[4:7], s56 offen sc1
    s_add_u32 s56, s56, 32768
    s_waitcnt lgkmcnt(7)
    buffer_store_dwordx4 v[160:163], v5, s[4:7], s56 offen sc1
    s_add_u32 s56, s56, 32768
    s_waitcnt lgkmcnt(6)
    buffer_store_dwordx4 v[164:167], v5, s[4:7], s56 offen sc1
    s_add_u32 s56, s56, 32768
    s_waitcnt lgkmcnt(5)
    buffer_store_dwordx4 v[168:171], v5, s[4:7], s56 offen sc1
    s_add_u32 s56, s56, 32768
    s_waitcnt lgkmcnt(4)
    buffer_store_dwordx4 v[172:175], v5, s[4:7], s56 offen sc1
    s_add_u32 s56, s56, 32768
    s_waitcnt lgkmcnt(3)
    buffer_store_dwordx4 v[176:179], v5, s[4:7], s56 offen sc1
    s_add_u32 s56, s56, 32768
    s_waitcnt lgkmcnt(2)
    buffer_store_dwordx4 v[180:183], v5, s[4:7], s56 offen sc1
    s_add_u32 s56, s56, 32768
    s_waitcnt lgkmcnt(1)
    buffer_store_dwordx4 v[184:187], v5, s[4:7], s56 offen sc1
    s_add_u32 s56, s56, 32768
    s_waitcnt lgkmcnt(0)
    buffer_store_dwordx4 v[188:191], v5, s[4:7], s56 offen sc1
    s_barrier
    s_cmp_lg_u32 s42, 0
    s_cbranch_scc1 L_unstash
    s_setprio 0
    s_waitcnt vmcnt(0)
    s_lshl_b32 s53, s39, 5
    s_add_u32 s53, s53, s41
    s_lshl_b32 s53, s53, 5
    s_add_u32 s53, s53, s42
    s_lshl_b32 s53, s53, 2
    s_add_u32 s53, s53, 32768
    s_atomic_add s75, s[4:5], s53
    s_branch L_post_hi
L_unstash:
    s_cmp_lt_u32 s36, 4
    s_cbranch_scc1 L_un_lo
    s_setprio 2
L_un_lo:
    v_lshlrev_b32 v2, 4, v0
    s_mul_i32 s52, s36, 5120
    s_add_u32 s52, s52, 61440
    v_add_u32 v3, s52, v2
    s_lshl_b32 s52, s36, 10
    v_add_u32 v2, s52, v2
    ds_write_b128 v3, v[232:235] offset:0
    ds_write_b128 v3, v[236:239] offset:1024
    ds_write_b128 v3, v[240:243] offset:2048
    ds_write_b128 v3, v[244:247] offset:3072
    ds_write_b128 v3, v[248:251] offset:4096
    ds_write_b128 v2, v[200:203] offset:0
    ds_write_b128 v2, v[204:207] offset:8192
    ds_write_b128 v2, v[208:211] offset:16384
    ds_write_b128 v2, v[212:215] offset:24576
    ds_write_b128 v2, v[216:219] offset:32768
    ds_write_b128 v2, v[220:223] offset:40960
    ds_write_b128 v2, v[224:227] offset:49152
    s_cmp_ge_u32 s36, 4
    s_cbranch_scc1 L_us_25
    ds_write_b128 v2, v[228:231] offset:57344
L_us_25:
    s_cmp_lt_u32 s36, 4
    s_cbranch_scc1 L_post_lo
    s_branch L_post_hi
L_post_lo:
    s_cmp_eq_u32 s42, 0
    s_cbranch_scc1 L_p0_26
    s_cmp_lt_u32 s88, 20
    s_cbranch_scc1 L_un_ret
    s_branch L_b1
L_p0_26:
    s_cmp_ge_u32 s40, 30
    s_cbranch_scc1 L_auxw
    ds_read_b64_tr_b16 v[16:17], v206 offset:0
    ds_read_b64_tr_b16 v[18:19], v206 offset:512
    ds_read_b64_tr_b16 v[20:21], v207 offset:0
    ds_read_b64_tr_b16 v[22:23], v207 offset:512
    ds_read_b128 v[116:119], v1 offset:0
    ds_read_b128 v[120:123], v1 offset:1024
    ds_read_b128 v[124:127], v1 offset:2048
    ds_read_b128 v[128:131], v1 offset:3072
    ds_read_b128 v[132:135], v1 offset:4096
    s_waitcnt lgkmcnt(0)
    v_mfma_f32_16x16x32_bf16 v[176:179], v[116:119], v[16:19], 0
    ds_read_b64_tr_b16 v[24:25], v206 offset:4096
    ds_read_b64_tr_b16 v[26:27], v206 offset:4608
    v_mfma_f32_16x16x32_bf16 v[96:99], v[116:119], v[20:23], 0
    ds_read_b64_tr_b16 v[28:29], v207 offset:4096
    ds_read_b64_tr_b16 v[30:31], v207 offset:4608
    v_mfma_f32_16x16x32_bf16 v[180:183], v[120:123], v[16:19], 0
    ds_read_b128 v[136:139], v1 offset:5120
    ds_read_b128 v[140:143], v1 offset:6144
    v_mfma_f32_16x16x32_bf16 v[100:103], v[120:123], v[20:23], 0
    ds_read_b128 v[144:147], v1 offset:7168
    ds_read_b128 v[148:151], v1 offset:8192
    v_mfma_f32_16x16x32_bf16 v[184:187], v[124:127], v[16:19], 0
    ds_read_b128 v[152:155], v1 offset:9216
    v_mfma_f32_16x16x32_bf16 v[104:107], v[124:127], v[20:23], 0
    v_mfma_f32_16x16x32_bf16 v[188:191], v[128:131], v[16:19], 0
    v_mfma_f32_16x16x32_bf16 v[108:111], v[128:131], v[20:23], 0
    v_mfma_f32_16x16x32_bf16 v[192:195], v[132:135], v[16:19], 0
    v_mfma_f32_16x16x32_bf16 v[112:115], v[132:135], v[20:23], 0
    s_waitcnt lgkmcnt(0)
    v_mfma_f32_16x16x32_bf16 v[176:179], v[136:139], v[24:27], v[176:179]
    ds_read_b64_tr_b16 v[16:17], v206 offset:8192
    ds_read_b64_tr_b16 v[18:19], v206 offset:8704
    v_mfma_f32_16x16x32_bf16 v[96:99], v[136:139], v[28:31], v[96:99]
    ds_read_b64_tr_b16 v[20:21], v207 offset:8192
    ds_read_b64_tr_b16 v[22:23], v207 offset:8704
    v_mfma_f32_16x16x32_bf16 v[180:183], v[140:143], v[24:27], v[180:183]
    ds_read_b128 v[116:119], v1 offset:10240
    ds_read_b128 v[120:123], v1 offset:11264
    v_mfma_f32_16x16x32_bf16 v[100:103], v[140:143], v[28:31], v[100:103]
    ds_read_b128 v[124:127], v1 offset:12288
    ds_read_b128 v[128:131], v1 offset:13312
    v_mfma_f32_16x16x32_bf16 v[184:187], v[144:147], v[24:27], v[184:187]
    ds_read_b128 v[132:135], v1 offset:14336
    v_mfma_f32_16x16x32_bf16 v[104:107], v[144:147], v[28:31], v[104:107]
    v_mfma_f32_16x16x32_bf16 v[188:191], v[148:151], v[24:27], v[188:191]
    v_mfma_f32_16x16x32_bf16 v[108:111], v[148:151], v[28:31], v[108:111]
    v_mfma_f32_16x16x32_bf16 v[192:195], v[152:155], v[24:27], v[192:195]
    v_mfma_f32_16x16x32_bf16 v[112:115], v[152:155], v[28:31], v[112:115]
    s_waitcnt lgkmcnt(0)
    v_mfma_f32_16x16x32_bf16 v[176:179], v[116:119], v[16:19], v[176:179]
    ds_read_b64_tr_b16 v[24:25], v206 offset:12288
    ds_read_b64_tr_b16 v[26:27], v206 offset:12800
    v_mfma_f32_16x16x32_bf16 v[96:99], v[116:119], v[20:23], v[96:99]
    ds_read_b64_tr_b16 v[28:29], v207 offset:12288
    ds_read_b64_tr_b16 v[30:31], v207 offset:12800
    v_mfma_f32_16x16x32_bf16 v[180:183], v[120:123], v[16:19], v[180:183]
    ds_read_b128 v[136:139], v1 offset:15360
    ds_read_b128 v[140:143], v1 offset:16384
    v_mfma_f32_16x16x32_bf16 v[100:103], v[120:123], v[20:23], v[100:103]
    ds_read_b128 v[144:147], v1 offset:17408
    ds_read_b128 v[148:151], v1 offset:18432
    v_mfma_f32_16x16x32_bf16 v[184:187], v[124:127], v[16:19], v[184:187]
    ds_read_b128 v[152:155], v1 offset:19456
    v_mfma_f32_16x16x32_bf16 v[104:107], v[124:127], v[20:23], v[104:107]
    v_mfma_f32_16x16x32_bf16 v[188:191], v[128:131], v[16:19], v[188:191]
    v_mfma_f32_16x16x32_bf16 v[108:111], v[128:131], v[20:23], v[108:111]
    v_mfma_f32_16x16x32_bf16 v[192:195], v[132:135], v[16:19], v[192:195]
    v_mfma_f32_16x16x32_bf16 v[112:115], v[132:135], v[20:23], v[112:115]
    s_waitcnt lgkmcnt(0)
    v_mfma_f32_16x16x32_bf16 v[176:179], v[136:139], v[24:27], v[176:179]
    ds_read_b64_tr_b16 v[16:17], v206 offset:16384
    ds_read_b64_tr_b16 v[18:19], v206 offset:16896
    v_mfma_f32_16x16x32_bf16 v[96:99], v[136:139], v[28:31], v[96:99]
    ds_read_b64_tr_b16 v[20:21], v207 offset:16384
    ds_read_b64_tr_b16 v[22:23], v207 offset:16896
    v_mfma_f32_16x16x32_bf16 v[180:183], v[140:143], v[24:27], v[180:183]
    ds_read_b128 v[116:119], v1 offset:20480
    ds_read_b128 v[120:123], v1 offset:21504
    v_mfma_f32_16x16x32_bf16 v[100:103], v[140:143], v[28:31], v[100:103]
    ds_read_b128 v[124:127], v1 offset:22528
    ds_read_b128 v[128:131], v1 offset:23552
    v_mfma_f32_16x16x32_bf16 v[184:187], v[144:147], v[24:27], v[184:187]
    ds_read_b128 v[132:135], v1 offset:24576
    v_mfma_f32_16x16x32_bf16 v[104:107], v[144:147], v[28:31], v[104:107]
    v_mfma_f32_16x16x32_bf16 v[188:191], v[148:151], v[24:27], v[188:191]
    v_mfma_f32_16x16x32_bf16 v[108:111], v[148:151], v[28:31], v[108:111]
    v_mfma_f32_16x16x32_bf16 v[192:195], v[152:155], v[24:27], v[192:195]
    v_mfma_f32_16x16x32_bf16 v[112:115], v[152:155], v[28:31], v[112:115]
    s_cmp_ge_u32 s88, 20
    s_cbranch_scc1 L_mk_30
    s_and_b32 s52, s36, 1
    s_lshr_b32 s53, s36, 1
    s_mul_i32 s53, s53, 1318912
    s_mul_i32 s52, s52, 164864
    s_add_u32 s53, s53, s52
    s_lshl_b32 s52, s43, 8
    s_add_u32 s53, s53, s52
    s_add_u32 s57, s53, 5505024
    s_add_u32 s58, s57, 41216
    v_lshrrev_b32 v3, 4, v0
    v_bfe_u32 v4, v0, 3, 1
    v_lshl_add_u32 v3, v3, 2, v4
    v_mul_u32_u24 v3, 82432, v3
    v_and_b32 v4, 7, v0
    v_lshl_add_u32 v3, v4, 4, v3
    v_mov_b32 v4, 0x7f817f81
    v_mov_b32 v5, 0x7f817f81
    v_mov_b32 v6, 0x7f817f81
    v_mov_b32 v7, 0x7f817f81
    buffer_store_dwordx4 v[4:7], v3, s[4:7], s57 offen offset:0 sc1
    buffer_store_dwordx4 v[4:7], v3, s[4:7], s57 offen offset:128 sc1
    buffer_store_dwordx4 v[4:7], v3, s[4:7], s58 offen offset:0 sc1
    buffer_store_dwordx4 v[4:7], v3, s[4:7], s58 offen offset:128 sc1
L_mk_30:
    s_waitcnt lgkmcnt(0)
    v_mfma_f32_16x16x32_bf16 v[176:179], v[116:119], v[16:19], v[176:179]
    ds_read_b64_tr_b16 v[24:25], v206 offset:20480
    ds_read_b64_tr_b16 v[26:27], v206 offset:20992
    v_mfma_f32_16x16x32_bf16 v[96:99], v[116:119], v[20:23], v[96:99]
    ds_read_b64_tr_b16 v[28:29], v207 offset:20480
    ds_read_b64_tr_b16 v[30:31], v207 offset:20992
    v_mfma_f32_16x16x32_bf16 v[180:183], v[120:123], v[16:19], v[180:183]
    ds_read_b128 v[136:139], v1 offset:25600
    ds_read_b128 v[140:143], v1 offset:26624
    v_mfma_f32_16x16x32_bf16 v[100:103], v[120:123], v[20:23], v[100:103]
    ds_read_b128 v[144:147], v1 offset:27648
    ds_read_b128 v[148:151], v1 offset:28672
    v_mfma_f32_16x16x32_bf16 v[184:187], v[124:127], v[16:19], v[184:187]
    ds_read_b128 v[152:155], v1 offset:29696
    v_mfma_f32_16x16x32_bf16 v[104:107], v[124:127], v[20:23], v[104:107]
    v_mfma_f32_16x16x32_bf16 v[188:191], v[128:131], v[16:19], v[188:191]
    v_mfma_f32_16x16x32_bf16 v[108:111], v[128:131], v[20:23], v[108:111]
    v_mfma_f32_16x16x32_bf16 v[192:195], v[132:135], v[16:19], v[192:195]
    v_mfma_f32_16x16x32_bf16 v[112:115], v[132:135], v[20:23], v[112:115]
    s_waitcnt lgkmcnt(0)
    v_mfma_f32_16x16x32_bf16 v[176:179], v[136:139], v[24:27], v[176:179]
    ds_read_b64_tr_b16 v[16:17], v206 offset:24576
    ds_read_b64_tr_b16 v[18:19], v206 offset:25088
    v_mfma_f32_16x16x32_bf16 v[96:99], v[136:139], v[28:31], v[96:99]
    ds_read_b64_tr_b16 v[20:21], v207 offset:24576
    ds_read_b64_tr_b16 v[22:23], v207 offset:25088
    v_mfma_f32_16x16x32_bf16 v[180:183], v[140:143], v[24:27], v[180:183]
    ds_read_b128 v[116:119], v1 offset:30720
    ds_read_b128 v[120:123], v1 offset:31744
    v_mfma_f32_16x16x32_bf16 v[100:103], v[140:143], v[28:31], v[100:103]
    ds_read_b128 v[124:127], v1 offset:32768
    ds_read_b128 v[128:131], v1 offset:33792
    v_mfma_f32_16x16x32_bf16 v[184:187], v[144:147], v[24:27], v[184:187]
    ds_read_b128 v[132:135], v1 offset:34816
    v_mfma_f32_16x16x32_bf16 v[104:107], v[144:147], v[28:31], v[104:107]
    v_mfma_f32_16x16x32_bf16 v[188:191], v[148:151], v[24:27], v[188:191]
    v_mfma_f32_16x16x32_bf16 v[108:111], v[148:151], v[28:31], v[108:111]
    v_mfma_f32_16x16x32_bf16 v[192:195], v[152:155], v[24:27], v[192:195]
    v_mfma_f32_16x16x32_bf16 v[112:115], v[152:155], v[28:31], v[112:115]
    s_waitcnt lgkmcnt(0)
    v_mfma_f32_16x16x32_bf16 v[176:179], v[116:119], v[16:19], v[176:179]
    ds_read_b64_tr_b16 v[24:25], v206 offset:28672
    ds_read_b64_tr_b16 v[26:27], v206 offset:29184
    v_mfma_f32_16x16x32_bf16 v[96:99], v[116:119], v[20:23], v[96:99]
    ds_read_b64_tr_b16 v[28:29], v207 offset:28672
    ds_read_b64_tr_b16 v[30:31], v207 offset:29184
    v_mfma_f32_16x16x32_bf16 v[180:183], v[120:123], v[16:19], v[180:183]
    ds_read_b128 v[136:139], v1 offset:35840
    ds_read_b128 v[140:143], v1 offset:36864
    v_mfma_f32_16x16x32_bf16 v[100:103], v[120:123], v[20:23], v[100:103]
    ds_read_b128 v[144:147], v1 offset:37888
    ds_read_b128 v[148:151], v1 offset:38912
    v_mfma_f32_16x16x32_bf16 v[184:187], v[124:127], v[16:19], v[184:187]
    ds_read_b128 v[152:155], v1 offset:39936
    v_mfma_f32_16x16x32_bf16 v[104:107], v[124:127], v[20:23], v[104:107]
    v_mfma_f32_16x16x32_bf16 v[188:191], v[128:131], v[16:19], v[188:191]
    v_mfma_f32_16x16x32_bf16 v[108:111], v[128:131], v[20:23], v[108:111]
    v_mfma_f32_16x16x32_bf16 v[192:195], v[132:135], v[16:19], v[192:195]
    v_mfma_f32_16x16x32_bf16 v[112:115], v[132:135], v[20:23], v[112:115]
    s_waitcnt lgkmcnt(0)
    v_mfma_f32_16x16x32_bf16 v[176:179], v[136:139], v[24:27], v[176:179]
    ds_read_b64_tr_b16 v[16:17], v206 offset:32768
    ds_read_b64_tr_b16 v[18:19], v206 offset:33280
    v_mfma_f32_16x16x32_bf16 v[96:99], v[136:139], v[28:31], v[96:99]
    ds_read_b64_tr_b16 v[20:21], v207 offset:32768
    ds_read_b64_tr_b16 v[22:23], v207 offset:33280
    v_mfma_f32_16x16x32_bf16 v[180:183], v[140:143], v[24:27], v[180:183]
    ds_read_b128 v[116:119], v1 offset:40960
    ds_read_b128 v[120:123], v1 offset:41984
    v_mfma_f32_16x16x32_bf16 v[100:103], v[140:143], v[28:31], v[100:103]
    ds_read_b128 v[124:127], v1 offset:43008
    ds_read_b128 v[128:131], v1 offset:44032
    v_mfma_f32_16x16x32_bf16 v[184:187], v[144:147], v[24:27], v[184:187]
    ds_read_b128 v[132:135], v1 offset:45056
    v_mfma_f32_16x16x32_bf16 v[104:107], v[144:147], v[28:31], v[104:107]
    v_mfma_f32_16x16x32_bf16 v[188:191], v[148:151], v[24:27], v[188:191]
    v_mfma_f32_16x16x32_bf16 v[108:111], v[148:151], v[28:31], v[108:111]
    v_mfma_f32_16x16x32_bf16 v[192:195], v[152:155], v[24:27], v[192:195]
    v_mfma_f32_16x16x32_bf16 v[112:115], v[152:155], v[28:31], v[112:115]
    s_waitcnt lgkmcnt(0)
    v_mfma_f32_16x16x32_bf16 v[176:179], v[116:119], v[16:19], v[176:179]
    ds_read_b64_tr_b16 v[24:25], v206 offset:36864
    ds_read_b64_tr_b16 v[26:27], v206 offset:37376
    v_mfma_f32_16x16x32_bf16 v[96:99], v[116:119], v[20:23], v[96:99]
    ds_read_b64_tr_b16 v[28:29], v207 offset:36864
    ds_read_b64_tr_b16 v[30:31], v207 offset:37376
    v_mfma_f32_16x16x32_bf16 v[180:183], v[120:123], v[16:19], v[180:183]
    ds_read_b128 v[136:139], v1 offset:46080
    ds_read_b128 v[140:143], v1 offset:47104
    v_mfma_f32_16x16x32_bf16 v[100:103], v[120:123], v[20:23], v[100:103]
    ds_read_b128 v[144:147], v1 offset:48128
    ds_read_b128 v[148:151], v1 offset:49152
    v_mfma_f32_16x16x32_bf16 v[184:187], v[124:127], v[16:19], v[184:187]
    ds_read_b128 v[152:155], v1 offset:50176
    v_mfma_f32_16x16x32_bf16 v[104:107], v[124:127], v[20:23], v[104:107]
    v_mfma_f32_16x16x32_bf16 v[188:191], v[128:131], v[16:19], v[188:191]
    v_mfma_f32_16x16x32_bf16 v[108:111], v[128:131], v[20:23], v[108:111]
    v_mfma_f32_16x16x32_bf16 v[192:195], v[132:135], v[16:19], v[192:195]
    v_mfma_f32_16x16x32_bf16 v[112:115], v[132:135], v[20:23], v[112:115]
    s_waitcnt lgkmcnt(0)
    v_mfma_f32_16x16x32_bf16 v[176:179], v[136:139], v[24:27], v[176:179]
    v_mfma_f32_16x16x32_bf16 v[96:99], v[136:139], v[28:31], v[96:99]
    v_mfma_f32_16x16x32_bf16 v[180:183], v[140:143], v[24:27], v[180:183]
    v_mfma_f32_16x16x32_bf16 v[100:103], v[140:143], v[28:31], v[100:103]
    v_mfma_f32_16x16x32_bf16 v[184:187], v[144:147], v[24:27], v[184:187]
    v_mfma_f32_16x16x32_bf16 v[104:107], v[144:147], v[28:31], v[104:107]
    v_mfma_f32_16x16x32_bf16 v[188:191], v[148:151], v[24:27], v[188:191]
    v_mfma_f32_16x16x32_bf16 v[108:111], v[148:151], v[28:31], v[108:111]
    v_mfma_f32_16x16x32_bf16 v[192:195], v[152:155], v[24:27], v[192:195]
    v_mfma_f32_16x16x32_bf16 v[112:115], v[152:155], v[28:31], v[112:115]
    v_pk_add_f32 v[176:177], v[176:177], v[96:97] neg_lo:[0,1] neg_hi:[0,1]
    v_pk_add_f32 v[178:179], v[178:179], v[98:99]
    v_pk_add_f32 v[180:181], v[180:181], v[100:101] neg_lo:[0,1] neg_hi:[0,1]
    v_pk_add_f32 v[182:183], v[182:183], v[102:103]
    v_pk_add_f32 v[184:185], v[184:185], v[104:105] neg_lo:[0,1] neg_hi:[0,1]
    v_pk_add_f32 v[186:187], v[186:187], v[106:107]
    v_pk_add_f32 v[188:189], v[188:189], v[108:109] neg_lo:[0,1] neg_hi:[0,1]
    v_pk_add_f32 v[190:191], v[190:191], v[110:111]
    v_pk_add_f32 v[192:193], v[192:193], v[112:113] neg_lo:[0,1] neg_hi:[0,1]
    v_pk_add_f32 v[194:195], v[194:195], v[114:115]
    v_pk_mul_f32 v[176:177], v[176:177], v[200:201]
    v_pk_mul_f32 v[178:179], v[178:179], v[200:201]
    v_pk_mul_f32 v[180:181], v[180:181], v[200:201]
    v_pk_mul_f32 v[182:183], v[182:183], v[200:201]
    v_pk_mul_f32 v[184:185], v[184:185], v[200:201]
    v_pk_mul_f32 v[186:187], v[186:187], v[200:201]
    v_pk_mul_f32 v[188:189], v[188:189], v[200:201]
    v_pk_mul_f32 v[190:191], v[190:191], v[200:201]
    v_pk_mul_f32 v[192:193], v[192:193], v[200:201]
    v_pk_mul_f32 v[194:195], v[194:195], v[202:203]
    v_cvt_pk_bf16_f32 v40, v192, v193
    v_cvt_pk_bf16_f32 v41, v194, v195
    v_mov_b64 v[42:43], v[40:41]
    v_cvt_pk_bf16_f32 v32, v176, v177
    v_cvt_pk_bf16_f32 v33, v178, v179
    v_cvt_pk_bf16_f32 v34, v180, v181
    v_cvt_pk_bf16_f32 v35, v182, v183
    v_cvt_pk_bf16_f32 v36, v184, v185
    v_cvt_pk_bf16_f32 v37, v186, v187
    v_cvt_pk_bf16_f32 v38, v188, v189
    v_cvt_pk_bf16_f32 v39, v190, v191
    v_permlane16_swap_b32 v40, v42
    v_permlane16_swap_b32 v41, v43
    buffer_store_dwordx4 v[32:35], v204, s[4:7], s62 offen sc1
    buffer_store_dwordx4 v[36:39], v204, s[4:7], s63 offen sc1
    s_mov_b32 exec_lo, 0xffff
    s_mov_b32 exec_hi, 0xffff
    buffer_store_dwordx4 v[40:43], v205, s[4:7], s64 offen sc1
    s_mov_b64 exec, -1
    s_cmp_lt_u32 s88, 20
    s_cbranch_scc1 L_b1
    s_waitcnt vmcnt(0)
    v_mov_b32 v2, 62976
    v_mov_b32 v3, 1
    s_mov_b64 exec, 1
    ds_add_rtn_u32 v3, v2, v3 offset:0
    s_waitcnt lgkmcnt(0)
    v_readfirstlane_b32 s52, v3
    s_mov_b64 exec, -1
    s_cmp_lg_u32 s52, 3
    s_cbranch_scc1 L_sg_33
    s_lshl_b32 s53, s39, 5
    s_add_u32 s53, s53, s41
    s_lshl_b32 s53, s53, 5
    s_add_u32 s53, s53, s42
    s_lshl_b32 s53, s53, 2
    s_add_u32 s53, s53, 155648
    s_atomic_add s75, s[4:5], s53
L_sg_33:
L_auxw:
    s_cmp_lg_u32 s36, 1
    s_cbranch_scc1 L_ow_34
    v_bfe_u32 v4, v0, 3, 1
    v_mul_u32_u24 v4, 19, v4
    s_mul_i32 s53, s38, 20
    v_add_u32 v4, s53, v4
    v_lshrrev_b32 v4, 6, v4
    v_lshrrev_b32 v5, 4, v0
    v_mad_u32_u24 v4, v5, 10, v4
    v_and_b32 v5, 7, v4
    v_lshrrev_b32 v4, 3, v4
    v_lshl_add_u32 v4, v5, 2, v4
    v_and_b32 v5, 7, v0
    v_lshl_add_u32 v4, v5, 5, v4
    v_lshlrev_b32 v5, 7, v4
    s_mov_b32 s54, 155648
    s_mov_b32 exec_hi, 0xffff
    s_mov_b32 s52, s44
L_poll_35:
    buffer_load_dword v4, v5, s[4:7], s54 offen sc1
    s_add_u32 s52, s52, 1
    s_cmp_ge_u32 s52, 65536
    s_cselect_b32 s44, 65536, s44
    s_waitcnt vmcnt(0)
    s_cbranch_scc1 L_pd_36
    v_cmp_gt_u32 vcc, 1, v4
    s_nop 0
    s_cbranch_vccnz L_poll_35
L_pd_36:
    s_mov_b64 exec, -1
L_ow_34:
    s_branch L_b1
L_post_hi:
    s_cmp_lt_u32 s88, 20
    s_cbranch_scc1 L_pf_31
    s_cmp_lg_u32 s42, 0
    s_cbranch_scc1 L_b1
    s_cmp_lt_u32 s89, 10
    s_cbranch_scc1 L_pw_32
    s_mul_i32 s52, s39, 40
    s_add_u32 s52, s52, 1
    v_lshrrev_b32 v2, 4, v0
    v_lshl_add_u32 v2, v2, 1, s52
    v_cvt_f32_u32 v2, v2
    s_cmp_eq_u32 s39, 7
    s_cselect_b32 s52, 48, 99
    v_cmp_gt_u32 vcc, s52, v0
    v_add_f32 v48, 0x00000000, v2
    v_mul_f32 v48, 0x3acccccd, v48
    v_add_f32 v49, 0x3f800000, v2
    v_mul_f32 v49, 0x3acccccd, v49
    v_add_f32 v50, 0x41000000, v2
    v_mul_f32 v50, 0x3acccccd, v50
    v_add_f32 v51, 0x41100000, v2
    v_mul_f32 v51, 0x3acccccd, v51
    v_add_f32 v52, 0x41800000, v2
    v_mul_f32 v52, 0x3acccccd, v52
    v_add_f32 v53, 0x41880000, v2
    v_mul_f32 v53, 0x3acccccd, v53
    v_add_f32 v54, 0x41c00000, v2
    v_mul_f32 v54, 0x3acccccd, v54
    v_add_f32 v55, 0x41c80000, v2
    v_mul_f32 v55, 0x3acccccd, v55
    v_add_f32 v56, 0x42000000, v2
    v_mul_f32 v56, 0x3acccccd, v56
    v_add_f32 v57, 0x42040000, v2
    v_mul_f32 v57, 0x3acccccd, v57
    v_mov_b32 v3, 0x3e000000
    v_mov_b32 v4, 0x3e800000
    v_cndmask_b32 v58, 0, v57, vcc
    v_cndmask_b32 v60, v3, v4, vcc
    v_mov_b32 v4, 0
    v_cndmask_b32 v59, v3, v4, vcc
    s_sub_u32 s58, s89, 10
    s_mul_i32 s58, s58, 320
    s_add_u32 s59, s58, 320
    s_lshl_b32 s52, s98, 4
    s_add_u32 s58, s58, s52
L_fdt_37:
    v_and_b32 v2, 15, v0
    v_add_u32 v2, s58, v2
    v_cvt_f32_u32 v2, v2
    v_fmaak_f32 v96, v2, v48, 0x00000000
    v_fmaak_f32 v97, v2, v48, 0x3e800000
    v_fmaak_f32 v98, v2, v49, 0x00000000
    v_fmaak_f32 v99, v2, v49, 0x3e800000
    v_fmaak_f32 v100, v2, v50, 0x00000000
    v_fmaak_f32 v101, v2, v50, 0x3e800000
    v_fmaak_f32 v102, v2, v51, 0x00000000
    v_fmaak_f32 v103, v2, v51, 0x3e800000
    v_fmaak_f32 v104, v2, v52, 0x00000000
    v_fmaak_f32 v105, v2, v52, 0x3e800000
    v_fmaak_f32 v106, v2, v53, 0x00000000
    v_fmaak_f32 v107, v2, v53, 0x3e800000
    v_fmaak_f32 v108, v2, v54, 0x00000000
    v_fmaak_f32 v109, v2, v54, 0x3e800000
    v_fmaak_f32 v110, v2, v55, 0x00000000
    v_fmaak_f32 v111, v2, v55, 0x3e800000
    v_fmaak_f32 v112, v2, v56, 0x00000000
    v_fmaak_f32 v113, v2, v56, 0x3e800000
    v_fma_f32 v114, v2, v57, v59
    v_fma_f32 v115, v2, v58, v60
    v_fract_f32 v96, v96
    v_fract_f32 v97, v97
    v_fract_f32 v98, v98
    v_fract_f32 v99, v99
    v_fract_f32 v100, v100
    v_fract_f32 v101, v101
    v_fract_f32 v102, v102
    v_fract_f32 v103, v103
    v_fract_f32 v104, v104
    v_fract_f32 v105, v105
    v_fract_f32 v106, v106
    v_fract_f32 v107, v107
    v_fract_f32 v108, v108
    v_fract_f32 v109, v109
    v_fract_f32 v110, v110
    v_fract_f32 v111, v111
    v_fract_f32 v112, v112
    v_fract_f32 v113, v113
    v_fract_f32 v114, v114
    v_fract_f32 v115, v115
    v_cos_f32 v96, v96
    v_cos_f32 v97, v97
    v_cos_f32 v98, v98
    v_cos_f32 v99, v99
    v_cos_f32 v100, v100
    v_cos_f32 v101, v101
    v_cos_f32 v102, v102
    v_cos_f32 v103, v103
    v_cos_f32 v104, v104
    v_cos_f32 v105, v105
    v_cos_f32 v106, v106
    v_cos_f32 v107, v107
    v_cos_f32 v108, v108
    v_cos_f32 v109, v109
    v_cos_f32 v110, v110
    v_cos_f32 v111, v111
    v_cos_f32 v112, v112
    v_cos_f32 v113, v113
    v_cos_f32 v114, v114
    v_cos_f32 v115, v115
    v_mul_f32 v96, 0x3d64f92e, v96
    v_mul_f32 v97, 0x3d64f92e, v97
    v_mul_f32 v98, 0x3d64f92e, v98
    v_mul_f32 v99, 0x3d64f92e, v99
    v_mul_f32 v100, 0x3d64f92e, v100
    v_mul_f32 v101, 0x3d64f92e, v101
    v_mul_f32 v102, 0x3d64f92e, v102
    v_mul_f32 v103, 0x3d64f92e, v103
    v_mul_f32 v104, 0x3d64f92e, v104
    v_mul_f32 v105, 0x3d64f92e, v105
    v_mul_f32 v106, 0x3d64f92e, v106
    v_mul_f32 v107, 0x3d64f92e, v107
    v_mul_f32 v108, 0x3d64f92e, v108
    v_mul_f32 v109, 0x3d64f92e, v109
    v_mul_f32 v110, 0x3d64f92e, v110
    v_mul_f32 v111, 0x3d64f92e, v111
    v_mul_f32 v112, 0x3d64f92e, v112
    v_mul_f32 v113, 0x3d64f92e, v113
    v_mul_f32 v114, 0x3d64f92e, v114
    v_mul_f32 v115, 0x3d64f92e, v115
    s_lshr_b32 s52, s58, 2
    v_bfe_u32 v2, v0, 2, 2
    v_add_u32 v2, s52, v2
    v_mul_u32_u24 v3, 205, v2
    v_lshrrev_b32 v3, 10, v3
    v_mul_u32_u24 v204, 102400, v3
    v_mul_u32_u24 v3, 5, v3
    v_sub_u32 v2, v2, v3
    v_add_u32 v2, 15, v2
    v_lshrrev_b32 v3, 2, v2
    v_mul_u32_u24 v3, 20480, v3
    v_and_b32 v2, 3, v2
    v_lshl_add_u32 v3, v2, 8, v3
    v_and_b32 v4, 3, v0
    v_lshl_add_u32 v3, v4, 4, v3
    v_add_u32 v3, v3, v204
    v_sub_u32 v2, 0, v2
    v_lshrrev_b32 v4, 4, v0
    v_xor_b32 v4, v4, v2
    v_and_b32 v4, 3, v4
    v_lshl_add_u32 v204, v4, 6, v3
    s_and_b32 s53, s39, 1
    s_lshl_b32 s52, s53, 1
    v_lshrrev_b32 v4, 5, v0
    v_add_u32 v4, s52, v4
    v_xor_b32 v4, v4, v2
    v_and_b32 v4, 3, v4
    v_lshl_add_u32 v205, v4, 6, v3
    s_lshr_b32 s52, s39, 1
    s_mul_i32 s52, s52, 5120
    s_add_u32 s52, s52, 13402112
    s_lshl_b32 s62, s53, 11
    s_add_u32 s62, s62, s52
    s_add_u32 s63, s62, 1024
    s_add_u32 s64, s52, 4096
    v_cvt_pk_bf16_f32 v40, v112, v113
    v_cvt_pk_bf16_f32 v41, v114, v115
    v_mov_b64 v[42:43], v[40:41]
    v_cvt_pk_bf16_f32 v32, v96, v97
    v_cvt_pk_bf16_f32 v33, v98, v99
    v_cvt_pk_bf16_f32 v34, v100, v101
    v_cvt_pk_bf16_f32 v35, v102, v103
    v_cvt_pk_bf16_f32 v36, v104, v105
    v_cvt_pk_bf16_f32 v37, v106, v107
    v_cvt_pk_bf16_f32 v38, v108, v109
    v_cvt_pk_bf16_f32 v39, v110, v111
    v_permlane16_swap_b32 v40, v42
    v_permlane16_swap_b32 v41, v43
    buffer_store_dwordx4 v[32:35], v204, s[4:7], s62 offen sc1
    buffer_store_dwordx4 v[36:39], v204, s[4:7], s63 offen sc1
    s_mov_b32 exec_lo, 0xffff
    s_mov_b32 exec_hi, 0xffff
    buffer_store_dwordx4 v[40:43], v205, s[4:7], s64 offen sc1
    s_mov_b64 exec, -1
    s_add_u32 s58, s58, 64
    s_cmp_lt_u32 s58, s59
    s_cbranch_scc1 L_fdt_37
    s_branch L_b1
L_pw_32:
    s_lshl_b32 s54, s89, 2
    s_add_u32 s54, s54, s98
    s_lshl_b32 s54, s54, 4
    v_lshrrev_b32 v8, 3, v0
    v_add_u32 v8, 0, v8
    v_add_u32 v8, s54, v8
    v_lshrrev_b32 v9, 4, v8
    v_lshl_add_u32 v12, v9, 2, v8
    v_subrev_u32 v9, 512, v8
    v_lshrrev_b32 v10, 2, v9
    v_lshl_add_u32 v9, v10, 4, v9
    v_add_u32 v9, 16, v9
    v_cmp_le_u32 vcc, 512, v8
    s_nop 1
    v_cndmask_b32 v12, v12, v9, vcc
    v_lshrrev_b32 v8, 3, v0
    v_add_u32 v8, 8, v8
    v_add_u32 v8, s54, v8
    v_lshrrev_b32 v9, 4, v8
    v_lshl_add_u32 v13, v9, 2, v8
    v_subrev_u32 v9, 512, v8
    v_lshrrev_b32 v10, 2, v9
    v_lshl_add_u32 v9, v10, 4, v9
    v_add_u32 v9, 16, v9
    v_cmp_le_u32 vcc, 512, v8
    s_nop 1
    v_cndmask_b32 v13, v13, v9, vcc
    v_lshrrev_b32 v8, 3, v0
    v_and_b32 v8, 6, v8
    v_xor_b32 v8, v8, v0
    v_and_b32 v8, 7, v8
    v_lshlrev_b32 v8, 4, v8
    s_movk_i32 s52, 1280
    v_mad_u32_u24 v12, v12, s52, v8
    v_mad_u32_u24 v13, v13, s52, v8
    buffer_load_dwordx4 v[16:19], v12, s[24:27], 0 offen offset:0
    buffer_load_dwordx4 v[20:23], v13, s[24:27], 0 offen offset:0
    buffer_load_dwordx4 v[24:27], v12, s[24:27], 0 offen offset:128
    buffer_load_dwordx4 v[28:31], v13, s[24:27], 0 offen offset:128
    buffer_load_dwordx4 v[32:35], v12, s[24:27], 0 offen offset:256
    buffer_load_dwordx4 v[36:39], v13, s[24:27], 0 offen offset:256
    buffer_load_dwordx4 v[40:43], v12, s[24:27], 0 offen offset:384
    buffer_load_dwordx4 v[44:47], v13, s[24:27], 0 offen offset:384
    buffer_load_dwordx4 v[48:51], v12, s[24:27], 0 offen offset:512
    buffer_load_dwordx4 v[52:55], v13, s[24:27], 0 offen offset:512
    buffer_load_dwordx4 v[56:59], v12, s[24:27], 0 offen offset:640
    buffer_load_dwordx4 v[60:63], v13, s[24:27], 0 offen offset:640
    buffer_load_dwordx4 v[64:67], v12, s[24:27], 0 offen offset:768
    buffer_load_dwordx4 v[68:71], v13, s[24:27], 0 offen offset:768
    buffer_load_dwordx4 v[72:75], v12, s[24:27], 0 offen offset:896
    buffer_load_dwordx4 v[76:79], v13, s[24:27], 0 offen offset:896
    buffer_load_dwordx4 v[80:83], v12, s[24:27], 0 offen offset:1024
    buffer_load_dwordx4 v[84:87], v13, s[24:27], 0 offen offset:1024
    buffer_load_dwordx4 v[88:91], v12, s[24:27], 0 offen offset:1152
    buffer_load_dwordx4 v[92:95], v13, s[24:27], 0 offen offset:1152
    v_lshlrev_b32 v1, 4, v0
    s_lshl_b32 s52, s98, 12
    s_add_u32 s52, s52, 65536
    v_add_u32 v5, s52, v1
    v_and_b32 v2, 15, v0
    v_lshlrev_b32 v2, 7, v2
    v_lshrrev_b32 v3, 4, v0
    v_and_b32 v4, 6, v0
    v_xor_b32 v3, v3, v4
    v_lshl_add_u32 v2, v3, 4, v2
    v_add_u32 v2, s52, v2
    v_xor_b32 v3, 64, v2
    s_waitcnt vmcnt(16)
    ds_write_b128 v5, v[16:19] offset:0
    ds_write_b128 v5, v[20:23] offset:1024
    ds_write_b128 v5, v[24:27] offset:2048
    ds_write_b128 v5, v[28:31] offset:3072
    ds_read_b128 v[16:19], v2 offset:0
    ds_read_b128 v[20:23], v3 offset:0
    ds_read_b128 v[24:27], v2 offset:2048
    ds_read_b128 v[28:31], v3 offset:2048
    s_waitcnt vmcnt(12)
    ds_write_b128 v5, v[32:35] offset:0
    ds_write_b128 v5, v[36:39] offset:1024
    ds_write_b128 v5, v[40:43] offset:2048
    ds_write_b128 v5, v[44:47] offset:3072
    ds_read_b128 v[32:35], v2 offset:0
    ds_read_b128 v[36:39], v3 offset:0
    ds_read_b128 v[40:43], v2 offset:2048
    ds_read_b128 v[44:47], v3 offset:2048
    s_waitcnt vmcnt(8)
    ds_write_b128 v5, v[48:51] offset:0
    ds_write_b128 v5, v[52:55] offset:1024
    ds_write_b128 v5, v[56:59] offset:2048
    ds_write_b128 v5, v[60:63] offset:3072
    ds_read_b128 v[48:51], v2 offset:0
    ds_read_b128 v[52:55], v3 offset:0
    ds_read_b128 v[56:59], v2 offset:2048
    ds_read_b128 v[60:63], v3 offset:2048
    s_waitcnt vmcnt(4)
    ds_write_b128 v5, v[64:67] offset:0
    ds_write_b128 v5, v[68:71] offset:1024
    ds_write_b128 v5, v[72:75] offset:2048
    ds_write_b128 v5, v[76:79] offset:3072
    ds_read_b128 v[64:67], v2 offset:0
    ds_read_b128 v[68:71], v3 offset:0
    ds_read_b128 v[72:75], v2 offset:2048
    ds_read_b128 v[76:79], v3 offset:2048
    s_waitcnt vmcnt(0)
    ds_write_b128 v5, v[80:83] offset:0
    ds_write_b128 v5, v[84:87] offset:1024
    ds_write_b128 v5, v[88:91] offset:2048
    ds_write_b128 v5, v[92:95] offset:3072
    ds_read_b128 v[80:83], v2 offset:0
    ds_read_b128 v[84:87], v3 offset:0
    ds_read_b128 v[88:91], v2 offset:2048
    ds_read_b128 v[92:95], v3 offset:2048
    ds_read_b128 v[116:119], v1 offset:0
    ds_read_b128 v[120:123], v1 offset:1024
    ds_read_b128 v[124:127], v1 offset:2048
    ds_read_b128 v[128:131], v1 offset:3072
    ds_read_b128 v[132:135], v1 offset:4096
    s_waitcnt lgkmcnt(0)
    v_mfma_f32_16x16x32_bf16 v[176:179], v[16:19], v[116:119], 0
    ds_read_b128 v[136:139], v1 offset:5120
    ds_read_b128 v[140:143], v1 offset:6144
    v_mfma_f32_16x16x32_bf16 v[96:99], v[56:59], v[116:119], 0
    ds_read_b128 v[144:147], v1 offset:7168
    ds_read_b128 v[148:151], v1 offset:8192
    v_mfma_f32_16x16x32_bf16 v[180:183], v[16:19], v[120:123], 0
    ds_read_b128 v[152:155], v1 offset:9216
    v_mfma_f32_16x16x32_bf16 v[100:103], v[56:59], v[120:123], 0
    v_mfma_f32_16x16x32_bf16 v[184:187], v[16:19], v[124:127], 0
    v_mfma_f32_16x16x32_bf16 v[104:107], v[56:59], v[124:127], 0
    v_mfma_f32_16x16x32_bf16 v[188:191], v[16:19], v[128:131], 0
    v_mfma_f32_16x16x32_bf16 v[108:111], v[56:59], v[128:131], 0
    v_mfma_f32_16x16x32_bf16 v[192:195], v[16:19], v[132:135], 0
    v_mfma_f32_16x16x32_bf16 v[112:115], v[56:59], v[132:135], 0
    s_waitcnt lgkmcnt(0)
    v_mfma_f32_16x16x32_bf16 v[176:179], v[20:23], v[136:139], v[176:179]
    ds_read_b128 v[116:119], v1 offset:10240
    ds_read_b128 v[120:123], v1 offset:11264
    v_mfma_f32_16x16x32_bf16 v[96:99], v[60:63], v[136:139], v[96:99]
    ds_read_b128 v[124:127], v1 offset:12288
    ds_read_b128 v[128:131], v1 offset:13312
    v_mfma_f32_16x16x32_bf16 v[180:183], v[20:23], v[140:143], v[180:183]
    ds_read_b128 v[132:135], v1 offset:14336
    v_mfma_f32_16x16x32_bf16 v[100:103], v[60:63], v[140:143], v[100:103]
    v_mfma_f32_16x16x32_bf16 v[184:187], v[20:23], v[144:147], v[184:187]
    v_mfma_f32_16x16x32_bf16 v[104:107], v[60:63], v[144:147], v[104:107]
    v_mfma_f32_16x16x32_bf16 v[188:191], v[20:23], v[148:151], v[188:191]
    v_mfma_f32_16x16x32_bf16 v[108:111], v[60:63], v[148:151], v[108:111]
    v_mfma_f32_16x16x32_bf16 v[192:195], v[20:23], v[152:155], v[192:195]
    v_mfma_f32_16x16x32_bf16 v[112:115], v[60:63], v[152:155], v[112:115]
    s_waitcnt lgkmcnt(0)
    v_mfma_f32_16x16x32_bf16 v[176:179], v[24:27], v[116:119], v[176:179]
    ds_read_b128 v[136:139], v1 offset:15360
    ds_read_b128 v[140:143], v1 offset:16384
    v_mfma_f32_16x16x32_bf16 v[96:99], v[64:67], v[116:119], v[96:99]
    ds_read_b128 v[144:147], v1 offset:17408
    ds_read_b128 v[148:151], v1 offset:18432
    v_mfma_f32_16x16x32_bf16 v[180:183], v[24:27], v[120:123], v[180:183]
    ds_read_b128 v[152:155], v1 offset:19456
    v_mfma_f32_16x16x32_bf16 v[100:103], v[64:67], v[120:123], v[100:103]
    v_mfma_f32_16x16x32_bf16 v[184:187], v[24:27], v[124:127], v[184:187]
    v_mfma_f32_16x16x32_bf16 v[104:107], v[64:67], v[124:127], v[104:107]
    v_mfma_f32_16x16x32_bf16 v[188:191], v[24:27], v[128:131], v[188:191]
    v_mfma_f32_16x16x32_bf16 v[108:111], v[64:67], v[128:131], v[108:111]
    v_mfma_f32_16x16x32_bf16 v[192:195], v[24:27], v[132:135], v[192:195]
    v_mfma_f32_16x16x32_bf16 v[112:115], v[64:67], v[132:135], v[112:115]
    s_waitcnt lgkmcnt(0)
    v_mfma_f32_16x16x32_bf16 v[176:179], v[28:31], v[136:139], v[176:179]
    ds_read_b128 v[116:119], v1 offset:20480
    ds_read_b128 v[120:123], v1 offset:21504
    v_mfma_f32_16x16x32_bf16 v[96:99], v[68:71], v[136:139], v[96:99]
    ds_read_b128 v[124:127], v1 offset:22528
    ds_read_b128 v[128:131], v1 offset:23552
    v_mfma_f32_16x16x32_bf16 v[180:183], v[28:31], v[140:143], v[180:183]
    ds_read_b128 v[132:135], v1 offset:24576
    v_mfma_f32_16x16x32_bf16 v[100:103], v[68:71], v[140:143], v[100:103]
    v_mfma_f32_16x16x32_bf16 v[184:187], v[28:31], v[144:147], v[184:187]
    v_mfma_f32_16x16x32_bf16 v[104:107], v[68:71], v[144:147], v[104:107]
    v_mfma_f32_16x16x32_bf16 v[188:191], v[28:31], v[148:151], v[188:191]
    v_mfma_f32_16x16x32_bf16 v[108:111], v[68:71], v[148:151], v[108:111]
    v_mfma_f32_16x16x32_bf16 v[192:195], v[28:31], v[152:155], v[192:195]
    v_mfma_f32_16x16x32_bf16 v[112:115], v[68:71], v[152:155], v[112:115]
    s_waitcnt lgkmcnt(0)
    v_mfma_f32_16x16x32_bf16 v[176:179], v[32:35], v[116:119], v[176:179]
    ds_read_b128 v[136:139], v1 offset:25600
    ds_read_b128 v[140:143], v1 offset:26624
    v_mfma_f32_16x16x32_bf16 v[96:99], v[72:75], v[116:119], v[96:99]
    ds_read_b128 v[144:147], v1 offset:27648
    ds_read_b128 v[148:151], v1 offset:28672
    v_mfma_f32_16x16x32_bf16 v[180:183], v[32:35], v[120:123], v[180:183]
    ds_read_b128 v[152:155], v1 offset:29696
    v_mfma_f32_16x16x32_bf16 v[100:103], v[72:75], v[120:123], v[100:103]
    v_mfma_f32_16x16x32_bf16 v[184:187], v[32:35], v[124:127], v[184:187]
    v_mfma_f32_16x16x32_bf16 v[104:107], v[72:75], v[124:127], v[104:107]
    v_mfma_f32_16x16x32_bf16 v[188:191], v[32:35], v[128:131], v[188:191]
    v_mfma_f32_16x16x32_bf16 v[108:111], v[72:75], v[128:131], v[108:111]
    v_mfma_f32_16x16x32_bf16 v[192:195], v[32:35], v[132:135], v[192:195]
    v_mfma_f32_16x16x32_bf16 v[112:115], v[72:75], v[132:135], v[112:115]
    s_waitcnt lgkmcnt(0)
    v_mfma_f32_16x16x32_bf16 v[176:179], v[36:39], v[136:139], v[176:179]
    ds_read_b128 v[116:119], v1 offset:30720
    ds_read_b128 v[120:123], v1 offset:31744
    v_mfma_f32_16x16x32_bf16 v[96:99], v[76:79], v[136:139], v[96:99]
    ds_read_b128 v[124:127], v1 offset:32768
    ds_read_b128 v[128:131], v1 offset:33792
    v_mfma_f32_16x16x32_bf16 v[180:183], v[36:39], v[140:143], v[180:183]
    ds_read_b128 v[132:135], v1 offset:34816
    v_mfma_f32_16x16x32_bf16 v[100:103], v[76:79], v[140:143], v[100:103]
    v_mfma_f32_16x16x32_bf16 v[184:187], v[36:39], v[144:147], v[184:187]
    v_mfma_f32_16x16x32_bf16 v[104:107], v[76:79], v[144:147], v[104:107]
    v_mfma_f32_16x16x32_bf16 v[188:191], v[36:39], v[148:151], v[188:191]
    v_mfma_f32_16x16x32_bf16 v[108:111], v[76:79], v[148:151], v[108:111]
    v_mfma_f32_16x16x32_bf16 v[192:195], v[36:39], v[152:155], v[192:195]
    v_mfma_f32_16x16x32_bf16 v[112:115], v[76:79], v[152:155], v[112:115]
    s_waitcnt lgkmcnt(0)
    v_mfma_f32_16x16x32_bf16 v[176:179], v[40:43], v[116:119], v[176:179]
    ds_read_b128 v[136:139], v1 offset:35840
    ds_read_b128 v[140:143], v1 offset:36864
    v_mfma_f32_16x16x32_bf16 v[96:99], v[80:83], v[116:119], v[96:99]
    ds_read_b128 v[144:147], v1 offset:37888
    ds_read_b128 v[148:151], v1 offset:38912
    v_mfma_f32_16x16x32_bf16 v[180:183], v[40:43], v[120:123], v[180:183]
    ds_read_b128 v[152:155], v1 offset:39936
    v_mfma_f32_16x16x32_bf16 v[100:103], v[80:83], v[120:123], v[100:103]
    v_mfma_f32_16x16x32_bf16 v[184:187], v[40:43], v[124:127], v[184:187]
    v_mfma_f32_16x16x32_bf16 v[104:107], v[80:83], v[124:127], v[104:107]
    v_mfma_f32_16x16x32_bf16 v[188:191], v[40:43], v[128:131], v[188:191]
    v_mfma_f32_16x16x32_bf16 v[108:111], v[80:83], v[128:131], v[108:111]
    v_mfma_f32_16x16x32_bf16 v[192:195], v[40:43], v[132:135], v[192:195]
    v_mfma_f32_16x16x32_bf16 v[112:115], v[80:83], v[132:135], v[112:115]
    s_waitcnt lgkmcnt(0)
    v_mfma_f32_16x16x32_bf16 v[176:179], v[44:47], v[136:139], v[176:179]
    ds_read_b128 v[116:119], v1 offset:40960
    ds_read_b128 v[120:123], v1 offset:41984
    v_mfma_f32_16x16x32_bf16 v[96:99], v[84:87], v[136:139], v[96:99]
    ds_read_b128 v[124:127], v1 offset:43008
    ds_read_b128 v[128:131], v1 offset:44032
    v_mfma_f32_16x16x32_bf16 v[180:183], v[44:47], v[140:143], v[180:183]
    ds_read_b128 v[132:135], v1 offset:45056
    v_mfma_f32_16x16x32_bf16 v[100:103], v[84:87], v[140:143], v[100:103]
    v_mfma_f32_16x16x32_bf16 v[184:187], v[44:47], v[144:147], v[184:187]
    v_mfma_f32_16x16x32_bf16 v[104:107], v[84:87], v[144:147], v[104:107]
    v_mfma_f32_16x16x32_bf16 v[188:191], v[44:47], v[148:151], v[188:191]
    v_mfma_f32_16x16x32_bf16 v[108:111], v[84:87], v[148:151], v[108:111]
    v_mfma_f32_16x16x32_bf16 v[192:195], v[44:47], v[152:155], v[192:195]
    v_mfma_f32_16x16x32_bf16 v[112:115], v[84:87], v[152:155], v[112:115]
    s_waitcnt lgkmcnt(0)
    v_mfma_f32_16x16x32_bf16 v[176:179], v[48:51], v[116:119], v[176:179]
    ds_read_b128 v[136:139], v1 offset:46080
    ds_read_b128 v[140:143], v1 offset:47104
    v_mfma_f32_16x16x32_bf16 v[96:99], v[88:91], v[116:119], v[96:99]
    ds_read_b128 v[144:147], v1 offset:48128
    ds_read_b128 v[148:151], v1 offset:49152
    v_mfma_f32_16x16x32_bf16 v[180:183], v[48:51], v[120:123], v[180:183]
    ds_read_b128 v[152:155], v1 offset:50176
    v_mfma_f32_16x16x32_bf16 v[100:103], v[88:91], v[120:123], v[100:103]
    v_mfma_f32_16x16x32_bf16 v[184:187], v[48:51], v[124:127], v[184:187]
    v_mfma_f32_16x16x32_bf16 v[104:107], v[88:91], v[124:127], v[104:107]
    v_mfma_f32_16x16x32_bf16 v[188:191], v[48:51], v[128:131], v[188:191]
    v_mfma_f32_16x16x32_bf16 v[108:111], v[88:91], v[128:131], v[108:111]
    v_mfma_f32_16x16x32_bf16 v[192:195], v[48:51], v[132:135], v[192:195]
    v_mfma_f32_16x16x32_bf16 v[112:115], v[88:91], v[132:135], v[112:115]
    s_waitcnt lgkmcnt(0)
    v_mfma_f32_16x16x32_bf16 v[176:179], v[52:55], v[136:139], v[176:179]
    v_mfma_f32_16x16x32_bf16 v[96:99], v[92:95], v[136:139], v[96:99]
    v_mfma_f32_16x16x32_bf16 v[180:183], v[52:55], v[140:143], v[180:183]
    v_mfma_f32_16x16x32_bf16 v[100:103], v[92:95], v[140:143], v[100:103]
    v_mfma_f32_16x16x32_bf16 v[184:187], v[52:55], v[144:147], v[184:187]
    v_mfma_f32_16x16x32_bf16 v[104:107], v[92:95], v[144:147], v[104:107]
    v_mfma_f32_16x16x32_bf16 v[188:191], v[52:55], v[148:151], v[188:191]
    v_mfma_f32_16x16x32_bf16 v[108:111], v[92:95], v[148:151], v[108:111]
    v_mfma_f32_16x16x32_bf16 v[192:195], v[52:55], v[152:155], v[192:195]
    v_mfma_f32_16x16x32_bf16 v[112:115], v[92:95], v[152:155], v[112:115]
    v_and_b32 v2, 2, v0
    v_lshlrev_b32 v2, 30, v2
    v_xor_b32 v2, 0xbd64f92e, v2
    v_mov_b32 v3, 0x3d64f92e
    v_mul_f32 v176, v3, v176
    v_mul_f32 v177, v3, v177
    v_mul_f32 v178, v3, v178
    v_mul_f32 v179, v3, v179
    v_mul_f32 v180, v3, v180
    v_mul_f32 v181, v3, v181
    v_mul_f32 v182, v3, v182
    v_mul_f32 v183, v3, v183
    v_mul_f32 v184, v3, v184
    v_mul_f32 v185, v3, v185
    v_mul_f32 v186, v3, v186
    v_mul_f32 v187, v3, v187
    v_mul_f32 v188, v3, v188
    v_mul_f32 v189, v3, v189
    v_mul_f32 v190, v3, v190
    v_mul_f32 v191, v3, v191
    v_mul_f32 v192, v3, v192
    v_mul_f32 v193, v3, v193
    v_mul_f32 v194, v3, v194
    v_mul_f32 v195, v3, v195
    v_fmac_f32 v176, v2, v96
    v_fmac_f32 v177, v2, v97
    v_fmac_f32 v178, v2, v98
    v_fmac_f32 v179, v2, v99
    v_fmac_f32 v180, v2, v100
    v_fmac_f32 v181, v2, v101
    v_fmac_f32 v182, v2, v102
    v_fmac_f32 v183, v2, v103
    v_fmac_f32 v184, v2, v104
    v_fmac_f32 v185, v2, v105
    v_fmac_f32 v186, v2, v106
    v_fmac_f32 v187, v2, v107
    v_fmac_f32 v188, v2, v108
    v_fmac_f32 v189, v2, v109
    v_fmac_f32 v190, v2, v110
    v_fmac_f32 v191, v2, v111
    v_fmac_f32 v192, v2, v112
    v_fmac_f32 v193, v2, v113
    v_fmac_f32 v194, v2, v114
    v_fmac_f32 v195, v2, v115
    v_and_b32 v2, 15, v0
    v_mul_u32_u24 v2, 144, v2
    v_lshrrev_b32 v3, 4, v0
    v_lshl_add_u32 v2, v3, 3, v2
    s_lshl_b32 s52, s98, 5
    s_add_u32 s52, s52, s74
    v_add_u32 v2, s52, v2
    v_cvt_pk_bf16_f32 v4, v176, v177
    v_cvt_pk_bf16_f32 v5, v178, v179
    ds_write_b64 v2, v[4:5] offset:0
    v_cvt_pk_bf16_f32 v6, v180, v181
    v_cvt_pk_bf16_f32 v7, v182, v183
    ds_write_b64 v2, v[6:7] offset:2304
    v_cvt_pk_bf16_f32 v8, v184, v185
    v_cvt_pk_bf16_f32 v9, v186, v187
    ds_write_b64 v2, v[8:9] offset:4608
    v_cvt_pk_bf16_f32 v10, v188, v189
    v_cvt_pk_bf16_f32 v11, v190, v191
    ds_write_b64 v2, v[10:11] offset:6912
    v_cvt_pk_bf16_f32 v12, v192, v193
    v_cvt_pk_bf16_f32 v13, v194, v195
    ds_write_b64 v2, v[12:13] offset:9216
    s_waitcnt lgkmcnt(0)
    s_branch L_b1
L_pf_31:
    s_cmp_lg_u32 s42, 0
    s_cbranch_scc1 L_c2_done
L_c2:
    s_cmp_ge_u32 s88, 20
    s_cbranch_scc1 L_nc_38
    s_and_b32 s52, s36, 1
    v_and_b32 v252, 31, v0
    v_lshrrev_b32 v253, 5, v0
    v_lshlrev_b32 v253, 2, v253
    v_lshl_add_u32 v254, v253, 1, s52
    v_cvt_f32_u32 v252, v252
    v_cvt_f32_u32 v254, v254
    v_mul_f32 v253, 0x3a000000, v252
    v_mul_f32 v252, 0x3a800000, v252
    v_mul_f32 v253, v253, v254
    v_fmamk_f32 v104, v252, 0x00000000, v253
    v_fmamk_f32 v105, v252, 0x3f800000, v253
    v_fmamk_f32 v106, v252, 0x40000000, v253
    v_fmamk_f32 v107, v252, 0x40400000, v253
    v_fmamk_f32 v108, v252, 0x41000000, v253
    v_fmamk_f32 v109, v252, 0x41100000, v253
    v_fmamk_f32 v110, v252, 0x41200000, v253
    v_fmamk_f32 v111, v252, 0x41300000, v253
    v_fmamk_f32 v112, v252, 0x41800000, v253
    v_fmamk_f32 v113, v252, 0x41880000, v253
    v_fmamk_f32 v114, v252, 0x41900000, v253
    v_fmamk_f32 v115, v252, 0x41980000, v253
    v_fmamk_f32 v116, v252, 0x41c00000, v253
    v_fmamk_f32 v117, v252, 0x41c80000, v253
    v_fmamk_f32 v118, v252, 0x41d00000, v253
    v_fmamk_f32 v119, v252, 0x41d80000, v253
    v_cos_f32 v88, v104
    v_sin_f32 v104, v104
    v_cos_f32 v89, v105
    v_sin_f32 v105, v105
    v_cos_f32 v90, v106
    v_sin_f32 v106, v106
    v_cos_f32 v91, v107
    v_sin_f32 v107, v107
    v_cos_f32 v92, v108
    v_sin_f32 v108, v108
    v_cos_f32 v93, v109
    v_sin_f32 v109, v109
    v_cos_f32 v94, v110
    v_sin_f32 v110, v110
    v_cos_f32 v95, v111
    v_sin_f32 v111, v111
    v_cos_f32 v96, v112
    v_sin_f32 v112, v112
    v_cos_f32 v97, v113
    v_sin_f32 v113, v113
    v_cos_f32 v98, v114
    v_sin_f32 v114, v114
    v_cos_f32 v99, v115
    v_sin_f32 v115, v115
    v_cos_f32 v100, v116
    v_sin_f32 v116, v116
    v_cos_f32 v101, v117
    v_sin_f32 v117, v117
    v_cos_f32 v102, v118
    v_sin_f32 v118, v118
    v_cos_f32 v103, v119
    v_sin_f32 v119, v119
L_nc_38:
    s_cmp_lg_u32 s42, 0
    s_cbranch_scc1 L_c2_ret
L_c2_done:
    s_cmp_lg_u32 s42, 0
    s_cbranch_scc1 L_tpoll
    s_cmp_lg_u32 s36, 4
    s_cbranch_scc1 L_b1
L_tpoll:
    s_lshl_b32 s54, s37, 12
    s_lshl_b32 s53, s42, 2
    s_add_u32 s54, s54, s53
    s_add_u32 s54, s54, 32768
    v_lshlrev_b32 v3, 7, v0
    s_mov_b32 exec_lo, 0xffffffff
    s_mov_b32 exec_hi, 0
    s_mov_b32 s52, s44
L_poll_40:
    buffer_load_dword v2, v3, s[4:7], s54 offen sc1
    s_add_u32 s52, s52, 1
    s_cmp_ge_u32 s52, 65536
    s_cselect_b32 s44, 65536, s44
    s_waitcnt vmcnt(0)
    s_cbranch_scc1 L_pd_41
    v_cmp_gt_u32 vcc, 1, v2
    s_nop 0
    s_cbranch_vccnz L_poll_40
L_pd_41:
    s_mov_b64 exec, -1
L_b1:
    s_cmp_lg_u32 s42, 0
    s_cbranch_scc1 L_nob1
    s_barrier
L_nob1:
    s_cmp_ge_u32 s88, 20
    s_cbranch_scc1 L_aux_27
L_fft:
    v_lshlrev_b32 v1, 4, v0
    s_lshl_b32 s56, s43, 14
    s_cmp_lt_u32 s36, 4
    s_cbranch_scc1 L_flo2_42
    s_and_b32 s52, s36, 2
    s_lshl_b32 s53, s52, 12
    s_add_u32 s53, s53, s56
    s_add_u32 s54, s53, s46
    s_add_u32 s55, s54, 4096
    s_mov_b32 s59, 0
L_col:
    buffer_load_dwordx4 v[200:203], v1, s[4:7], s54 offen offset:0 sc1
    buffer_load_dwordx4 v[216:219], v1, s[4:7], s55 offen offset:0 sc1
    buffer_load_dwordx4 v[204:207], v1, s[4:7], s54 offen offset:1024 sc1
    buffer_load_dwordx4 v[220:223], v1, s[4:7], s55 offen offset:1024 sc1
    buffer_load_dwordx4 v[208:211], v1, s[4:7], s54 offen offset:2048 sc1
    buffer_load_dwordx4 v[224:227], v1, s[4:7], s55 offen offset:2048 sc1
    buffer_load_dwordx4 v[212:215], v1, s[4:7], s54 offen offset:3072 sc1
    buffer_load_dwordx4 v[228:231], v1, s[4:7], s55 offen offset:3072 sc1
    s_and_b32 s52, s36, 1
    s_lshl_b32 s52, s52, 12
    s_add_u32 s52, s52, 102400
    v_add_u32 v2, s52, v1
    s_setprio 2
    s_cmp_eq_u32 s42, 0
    s_cbranch_scc1 L_col_ok
    s_waitcnt vmcnt(6)
    v_maximum3_f32 v4, v200, v201, v200
    v_maximum3_f32 v4, v202, v203, v4
    v_maximum3_f32 v5, v216, v217, v216
    v_maximum3_f32 v5, v218, v219, v5
    s_waitcnt vmcnt(4)
    v_maximum3_f32 v4, v204, v205, v4
    v_maximum3_f32 v4, v206, v207, v4
    v_maximum3_f32 v5, v220, v221, v5
    v_maximum3_f32 v5, v222, v223, v5
    s_waitcnt vmcnt(2)
    v_maximum3_f32 v4, v208, v209, v4
    v_maximum3_f32 v4, v210, v211, v4
    v_maximum3_f32 v5, v224, v225, v5
    v_maximum3_f32 v5, v226, v227, v5
    s_waitcnt vmcnt(0)
    v_maximum3_f32 v4, v212, v213, v4
    v_maximum3_f32 v4, v214, v215, v4
    v_maximum3_f32 v5, v228, v229, v5
    v_maximum3_f32 v5, v230, v231, v5
    v_cmp_u_f32 vcc, v4, v5
    s_nop 0
    s_cbranch_vccnz L_col_redo
L_col_ok:
    s_barrier
    ds_read_b128 v[232:235], v2 offset:0
    ds_read_b128 v[236:239], v2 offset:1024
    ds_read_b128 v[240:243], v2 offset:2048
    ds_read_b128 v[244:247], v2 offset:3072
    s_waitcnt vmcnt(0)
    s_cmp_lg_u32 s42, 0
    s_cbranch_scc1 L_fl_44
    s_and_b32 s52, s36, 3
    s_lshl_b32 s52, s52, 12
    s_lshl_b32 s53, s43, 14
    s_add_u32 s53, s53, s52
    s_add_u32 s53, s53, 10780672
    buffer_load_dwordx4 v[128:131], v1, s[4:7], s53 offen offset:0 sc1
    buffer_load_dwordx4 v[132:135], v1, s[4:7], s53 offen offset:1024 sc1
    buffer_load_dwordx4 v[144:147], v1, s[4:7], s53 offen offset:2048 sc1
    buffer_load_dwordx4 v[148:151], v1, s[4:7], s53 offen offset:3072 sc1
L_fl_44:
    s_lshl_b32 s52, s43, 3
    s_add_u32 s52, s52, s36
    s_cmp_lt_u32 s52, 1278
    s_cbranch_scc1 L_nz_43
    v_mov_b32 v216, 0
    v_mov_b32 v217, 0
    v_mov_b32 v218, 0
    v_mov_b32 v219, 0
    v_mov_b32 v220, 0
    v_mov_b32 v221, 0
    v_mov_b32 v222, 0
    v_mov_b32 v223, 0
    v_mov_b32 v224, 0
    v_mov_b32 v225, 0
    v_mov_b32 v226, 0
    v_mov_b32 v227, 0
    v_mov_b32 v228, 0
    v_mov_b32 v229, 0
    v_mov_b32 v230, 0
    v_mov_b32 v231, 0
L_nz_43:
    s_waitcnt lgkmcnt(0)
    v_dot2_f32_bf16 v200, v200, v232, 0
    v_dot2_f32_bf16 v201, v201, v233, 0
    v_dot2_f32_bf16 v202, v202, v234, 0
    v_dot2_f32_bf16 v203, v203, v235, 0
    v_dot2_f32_bf16 v204, v204, v236, 0
    v_dot2_f32_bf16 v205, v205, v237, 0
    v_dot2_f32_bf16 v206, v206, v238, 0
    v_dot2_f32_bf16 v207, v207, v239, 0
    v_dot2_f32_bf16 v208, v208, v240, 0
    v_dot2_f32_bf16 v209, v209, v241, 0
    v_dot2_f32_bf16 v210, v210, v242, 0
    v_dot2_f32_bf16 v211, v211, v243, 0
    v_dot2_f32_bf16 v212, v212, v244, 0
    v_dot2_f32_bf16 v213, v213, v245, 0
    v_dot2_f32_bf16 v214, v214, v246, 0
    v_dot2_f32_bf16 v215, v215, v247, 0
    v_dot2_f32_bf16 v216, v216, v232, 0
    v_dot2_f32_bf16 v217, v217, v233, 0
    v_dot2_f32_bf16 v218, v218, v234, 0
    v_dot2_f32_bf16 v219, v219, v235, 0
    v_dot2_f32_bf16 v220, v220, v236, 0
    v_dot2_f32_bf16 v221, v221, v237, 0
    v_dot2_f32_bf16 v222, v222, v238, 0
    v_dot2_f32_bf16 v223, v223, v239, 0
    v_dot2_f32_bf16 v224, v224, v240, 0
    v_dot2_f32_bf16 v225, v225, v241, 0
    v_dot2_f32_bf16 v226, v226, v242, 0
    v_dot2_f32_bf16 v227, v227, v243, 0
    v_dot2_f32_bf16 v228, v228, v244, 0
    v_dot2_f32_bf16 v229, v229, v245, 0
    v_dot2_f32_bf16 v230, v230, v246, 0
    v_dot2_f32_bf16 v231, v231, v247, 0
    v_cvt_pk_bf16_f32 v184, v200, v201
    v_cvt_pk_bf16_f32 v185, v202, v203
    v_cvt_pk_bf16_f32 v186, v204, v205
    v_cvt_pk_bf16_f32 v187, v206, v207
    s_nop 1
    v_mfma_f32_32x32x16_bf16 v[152:167], v[184:187], v[8:11], 0
    v_cvt_pk_bf16_f32 v192, v216, v217
    v_cvt_pk_bf16_f32 v193, v218, v219
    v_cvt_pk_bf16_f32 v194, v220, v221
    v_cvt_pk_bf16_f32 v195, v222, v223
    v_mfma_f32_32x32x16_bf16 v[168:183], v[184:187], v[24:27], 0
    v_cvt_pk_bf16_f32 v188, v208, v209
    v_cvt_pk_bf16_f32 v189, v210, v211
    v_cvt_pk_bf16_f32 v190, v212, v213
    v_cvt_pk_bf16_f32 v191, v214, v215
    v_mfma_f32_32x32x16_bf16 v[152:167], v[192:195], v[16:19], v[152:167]
    v_cvt_pk_bf16_f32 v196, v224, v225
    v_cvt_pk_bf16_f32 v197, v226, v227
    v_cvt_pk_bf16_f32 v198, v228, v229
    v_cvt_pk_bf16_f32 v199, v230, v231
    v_mfma_f32_32x32x16_bf16 v[168:183], v[192:195], v[8:11], v[168:183]
    v_mfma_f32_32x32x16_bf16 v[152:167], v[188:191], v[12:15], v[152:167]
    v_mfma_f32_32x32x16_bf16 v[168:183], v[188:191], v[28:31], v[168:183]
    v_mfma_f32_32x32x16_bf16 v[152:167], v[196:199], v[20:23], v[152:167]
    v_mfma_f32_32x32x16_bf16 v[168:183], v[196:199], v[12:15], v[168:183]
    s_nop 10
    v_pk_mul_f32 v[232:233], v[152:153], v[56:57]
    v_pk_fma_f32 v[232:233], v[168:169], v[72:73], v[232:233]
    v_pk_mul_f32 v[168:169], v[168:169], v[56:57]
    v_pk_fma_f32 v[168:169], v[152:153], v[72:73], v[168:169] neg_lo:[1,0,0] neg_hi:[1,0,0]
    v_pk_mul_f32 v[234:235], v[154:155], v[58:59]
    v_pk_fma_f32 v[234:235], v[170:171], v[74:75], v[234:235]
    v_pk_mul_f32 v[170:171], v[170:171], v[58:59]
    v_pk_fma_f32 v[170:171], v[154:155], v[74:75], v[170:171] neg_lo:[1,0,0] neg_hi:[1,0,0]
    v_pk_mul_f32 v[236:237], v[156:157], v[60:61]
    v_pk_fma_f32 v[236:237], v[172:173], v[76:77], v[236:237]
    v_pk_mul_f32 v[172:173], v[172:173], v[60:61]
    v_pk_fma_f32 v[172:173], v[156:157], v[76:77], v[172:173] neg_lo:[1,0,0] neg_hi:[1,0,0]
    v_pk_mul_f32 v[238:239], v[158:159], v[62:63]
    v_pk_fma_f32 v[238:239], v[174:175], v[78:79], v[238:239]
    v_pk_mul_f32 v[174:175], v[174:175], v[62:63]
    v_pk_fma_f32 v[174:175], v[158:159], v[78:79], v[174:175] neg_lo:[1,0,0] neg_hi:[1,0,0]
    v_pk_mul_f32 v[240:241], v[160:161], v[64:65]
    v_pk_fma_f32 v[240:241], v[176:177], v[80:81], v[240:241]
    v_pk_mul_f32 v[176:177], v[176:177], v[64:65]
    v_pk_fma_f32 v[176:177], v[160:161], v[80:81], v[176:177] neg_lo:[1,0,0] neg_hi:[1,0,0]
    v_pk_mul_f32 v[242:243], v[162:163], v[66:67]
    v_pk_fma_f32 v[242:243], v[178:179], v[82:83], v[242:243]
    v_pk_mul_f32 v[178:179], v[178:179], v[66:67]
    v_pk_fma_f32 v[178:179], v[162:163], v[82:83], v[178:179] neg_lo:[1,0,0] neg_hi:[1,0,0]
    v_pk_mul_f32 v[244:245], v[164:165], v[68:69]
    v_pk_fma_f32 v[244:245], v[180:181], v[84:85], v[244:245]
    v_pk_mul_f32 v[180:181], v[180:181], v[68:69]
    v_pk_fma_f32 v[180:181], v[164:165], v[84:85], v[180:181] neg_lo:[1,0,0] neg_hi:[1,0,0]
    v_pk_mul_f32 v[246:247], v[166:167], v[70:71]
    v_pk_fma_f32 v[246:247], v[182:183], v[86:87], v[246:247]
    v_pk_mul_f32 v[182:183], v[182:183], v[70:71]
    v_pk_fma_f32 v[182:183], v[166:167], v[86:87], v[182:183] neg_lo:[1,0,0] neg_hi:[1,0,0]
    v_cvt_pk_bf16_f32 v184, v232, v233
    v_cvt_pk_bf16_f32 v185, v234, v235
    v_cvt_pk_bf16_f32 v186, v236, v237
    v_cvt_pk_bf16_f32 v187, v238, v239
    s_nop 1
    v_mfma_f32_32x32x16_bf16 v[200:215], v[32:35], v[184:187], 0
    v_cvt_pk_bf16_f32 v192, v168, v169
    v_cvt_pk_bf16_f32 v193, v170, v171
    v_cvt_pk_bf16_f32 v194, v172, v173
    v_cvt_pk_bf16_f32 v195, v174, v175
    v_mfma_f32_32x32x16_bf16 v[216:231], v[48:51], v[184:187], 0
    v_cvt_pk_bf16_f32 v188, v240, v241
    v_cvt_pk_bf16_f32 v189, v242, v243
    v_cvt_pk_bf16_f32 v190, v244, v245
    v_cvt_pk_bf16_f32 v191, v246, v247
    v_mfma_f32_32x32x16_bf16 v[200:215], v[40:43], v[192:195], v[200:215]
    v_cvt_pk_bf16_f32 v196, v176, v177
    v_cvt_pk_bf16_f32 v197, v178, v179
    v_cvt_pk_bf16_f32 v198, v180, v181
    v_cvt_pk_bf16_f32 v199, v182, v183
    v_mfma_f32_32x32x16_bf16 v[216:231], v[32:35], v[192:195], v[216:231]
    s_waitcnt vmcnt(0)
    v_lshlrev_b32 v120, 16, v128
    v_and_b32 v121, 0xffff0000, v128
    v_lshlrev_b32 v122, 16, v129
    v_and_b32 v123, 0xffff0000, v129
    v_lshlrev_b32 v124, 16, v130
    v_and_b32 v125, 0xffff0000, v130
    v_mfma_f32_32x32x16_bf16 v[200:215], v[36:39], v[188:191], v[200:215]
    v_lshlrev_b32 v126, 16, v131
    v_and_b32 v127, 0xffff0000, v131
    v_lshlrev_b32 v128, 16, v132
    v_and_b32 v129, 0xffff0000, v132
    v_lshlrev_b32 v130, 16, v133
    v_and_b32 v131, 0xffff0000, v133
    v_mfma_f32_32x32x16_bf16 v[216:231], v[52:55], v[188:191], v[216:231]
    v_lshlrev_b32 v132, 16, v134
    v_and_b32 v133, 0xffff0000, v134
    v_lshlrev_b32 v134, 16, v135
    v_and_b32 v135, 0xffff0000, v135
    v_lshlrev_b32 v136, 16, v144
    v_and_b32 v137, 0xffff0000, v144
    v_mfma_f32_32x32x16_bf16 v[200:215], v[44:47], v[196:199], v[200:215]
    v_lshlrev_b32 v138, 16, v145
    v_and_b32 v139, 0xffff0000, v145
    v_lshlrev_b32 v140, 16, v146
    v_and_b32 v141, 0xffff0000, v146
    v_lshlrev_b32 v142, 16, v147
    v_and_b32 v143, 0xffff0000, v147
    v_mfma_f32_32x32x16_bf16 v[216:231], v[36:39], v[196:199], v[216:231]
    v_lshlrev_b32 v144, 16, v148
    v_and_b32 v145, 0xffff0000, v148
    v_lshlrev_b32 v146, 16, v149
    v_and_b32 v147, 0xffff0000, v149
    v_lshlrev_b32 v148, 16, v150
    v_and_b32 v149, 0xffff0000, v150
    v_lshlrev_b32 v150, 16, v151
    v_and_b32 v151, 0xffff0000, v151
    s_cmp_lg_u32 s36, 6
    s_cbranch_scc1 L_ow_45
    s_cmp_eq_u32 s42, 0
    s_cselect_b32 s53, 1, 2
    s_and_b32 s66, s45, 15
    s_lshl_b32 s66, s66, 7
    s_lshl_b32 s67, s53, 2
    s_add_u32 s66, s66, s67
    s_add_u32 s53, s66, 131072
    s_mov_b32 s67, 1
    s_atomic_add s67, s[4:5], s53 glc
L_ow_45:
    v_pk_mul_f32 v[232:233], v[200:201], v[120:121]
    s_nop 0
    v_pk_fma_f32 v[232:233], v[216:217], v[136:137], v[232:233] neg_lo:[1,0,0] neg_hi:[1,0,0]
    v_pk_mul_f32 v[216:217], v[216:217], v[120:121]
    v_pk_fma_f32 v[216:217], v[200:201], v[136:137], v[216:217]
    v_pk_mul_f32 v[234:235], v[202:203], v[122:123]
    v_pk_fma_f32 v[234:235], v[218:219], v[138:139], v[234:235] neg_lo:[1,0,0] neg_hi:[1,0,0]
    v_pk_mul_f32 v[218:219], v[218:219], v[122:123]
    v_pk_fma_f32 v[218:219], v[202:203], v[138:139], v[218:219]
    v_pk_mul_f32 v[236:237], v[204:205], v[124:125]
    v_pk_fma_f32 v[236:237], v[220:221], v[140:141], v[236:237] neg_lo:[1,0,0] neg_hi:[1,0,0]
    v_pk_mul_f32 v[220:221], v[220:221], v[124:125]
    v_pk_fma_f32 v[220:221], v[204:205], v[140:141], v[220:221]
    v_pk_mul_f32 v[238:239], v[206:207], v[126:127]
    v_pk_fma_f32 v[238:239], v[222:223], v[142:143], v[238:239] neg_lo:[1,0,0] neg_hi:[1,0,0]
    v_pk_mul_f32 v[222:223], v[222:223], v[126:127]
    v_pk_fma_f32 v[222:223], v[206:207], v[142:143], v[222:223]
    v_pk_mul_f32 v[240:241], v[208:209], v[128:129]
    v_pk_fma_f32 v[240:241], v[224:225], v[144:145], v[240:241] neg_lo:[1,0,0] neg_hi:[1,0,0]
    v_pk_mul_f32 v[224:225], v[224:225], v[128:129]
    v_pk_fma_f32 v[224:225], v[208:209], v[144:145], v[224:225]
    v_pk_mul_f32 v[242:243], v[210:211], v[130:131]
    v_pk_fma_f32 v[242:243], v[226:227], v[146:147], v[242:243] neg_lo:[1,0,0] neg_hi:[1,0,0]
    v_pk_mul_f32 v[226:227], v[226:227], v[130:131]
    v_pk_fma_f32 v[226:227], v[210:211], v[146:147], v[226:227]
    v_pk_mul_f32 v[244:245], v[212:213], v[132:133]
    v_pk_fma_f32 v[244:245], v[228:229], v[148:149], v[244:245] neg_lo:[1,0,0] neg_hi:[1,0,0]
    v_pk_mul_f32 v[228:229], v[228:229], v[132:133]
    v_pk_fma_f32 v[228:229], v[212:213], v[148:149], v[228:229]
    v_pk_mul_f32 v[246:247], v[214:215], v[134:135]
    v_pk_fma_f32 v[246:247], v[230:231], v[150:151], v[246:247] neg_lo:[1,0,0] neg_hi:[1,0,0]
    v_pk_mul_f32 v[230:231], v[230:231], v[134:135]
    v_pk_fma_f32 v[230:231], v[214:215], v[150:151], v[230:231]
    v_cvt_pk_bf16_f32 v184, v232, v233
    v_cvt_pk_bf16_f32 v185, v234, v235
    v_cvt_pk_bf16_f32 v186, v236, v237
    v_cvt_pk_bf16_f32 v187, v238, v239
    s_nop 1
    v_mfma_f32_32x32x16_bf16 v[152:167], v[184:187], v[32:35], 0
    v_cvt_pk_bf16_f32 v192, v216, v217
    v_cvt_pk_bf16_f32 v193, v218, v219
    v_cvt_pk_bf16_f32 v194, v220, v221
    v_cvt_pk_bf16_f32 v195, v222, v223
    v_mfma_f32_32x32x16_bf16 v[168:183], v[184:187], v[40:43], 0
    v_cvt_pk_bf16_f32 v188, v240, v241
    v_cvt_pk_bf16_f32 v189, v242, v243
    v_cvt_pk_bf16_f32 v190, v244, v245
    v_cvt_pk_bf16_f32 v191, v246, v247
    v_mfma_f32_32x32x16_bf16 v[152:167], v[192:195], v[48:51], v[152:167]
    v_cvt_pk_bf16_f32 v196, v224, v225
    v_cvt_pk_bf16_f32 v197, v226, v227
    v_cvt_pk_bf16_f32 v198, v228, v229
    v_cvt_pk_bf16_f32 v199, v230, v231
    v_mfma_f32_32x32x16_bf16 v[168:183], v[192:195], v[32:35], v[168:183]
    v_mfma_f32_32x32x16_bf16 v[152:167], v[188:191], v[36:39], v[152:167]
    v_mfma_f32_32x32x16_bf16 v[168:183], v[188:191], v[44:47], v[168:183]
    v_mfma_f32_32x32x16_bf16 v[152:167], v[196:199], v[52:55], v[152:167]
    v_mfma_f32_32x32x16_bf16 v[168:183], v[196:199], v[36:39], v[168:183]
    s_and_b32 s52, s36, 3
    s_lshl_b32 s52, s52, 12
    s_add_u32 s52, s52, 110592
    v_add_u32 v2, s52, v1
    s_nop 6
    v_pk_mul_f32 v[232:233], v[152:153], v[88:89]
    v_pk_fma_f32 v[232:233], v[168:169], v[104:105], v[232:233] neg_lo:[1,0,0] neg_hi:[1,0,0]
    v_pk_mul_f32 v[168:169], v[168:169], v[88:89]
    v_pk_fma_f32 v[168:169], v[152:153], v[104:105], v[168:169]
    v_pk_mul_f32 v[234:235], v[154:155], v[90:91]
    v_pk_fma_f32 v[234:235], v[170:171], v[106:107], v[234:235] neg_lo:[1,0,0] neg_hi:[1,0,0]
    v_pk_mul_f32 v[170:171], v[170:171], v[90:91]
    v_pk_fma_f32 v[170:171], v[154:155], v[106:107], v[170:171]
    v_pk_mul_f32 v[236:237], v[156:157], v[92:93]
    v_pk_fma_f32 v[236:237], v[172:173], v[108:109], v[236:237] neg_lo:[1,0,0] neg_hi:[1,0,0]
    v_pk_mul_f32 v[172:173], v[172:173], v[92:93]
    v_pk_fma_f32 v[172:173], v[156:157], v[108:109], v[172:173]
    v_pk_mul_f32 v[238:239], v[158:159], v[94:95]
    v_pk_fma_f32 v[238:239], v[174:175], v[110:111], v[238:239] neg_lo:[1,0,0] neg_hi:[1,0,0]
    v_pk_mul_f32 v[174:175], v[174:175], v[94:95]
    v_pk_fma_f32 v[174:175], v[158:159], v[110:111], v[174:175]
    v_pk_mul_f32 v[240:241], v[160:161], v[96:97]
    v_pk_fma_f32 v[240:241], v[176:177], v[112:113], v[240:241] neg_lo:[1,0,0] neg_hi:[1,0,0]
    v_pk_mul_f32 v[176:177], v[176:177], v[96:97]
    v_pk_fma_f32 v[176:177], v[160:161], v[112:113], v[176:177]
    v_pk_mul_f32 v[242:243], v[162:163], v[98:99]
    v_pk_fma_f32 v[242:243], v[178:179], v[114:115], v[242:243] neg_lo:[1,0,0] neg_hi:[1,0,0]
    v_pk_mul_f32 v[178:179], v[178:179], v[98:99]
    v_pk_fma_f32 v[178:179], v[162:163], v[114:115], v[178:179]
    v_pk_mul_f32 v[244:245], v[164:165], v[100:101]
    v_pk_fma_f32 v[244:245], v[180:181], v[116:117], v[244:245] neg_lo:[1,0,0] neg_hi:[1,0,0]
    v_pk_mul_f32 v[180:181], v[180:181], v[100:101]
    v_pk_fma_f32 v[180:181], v[164:165], v[116:117], v[180:181]
    v_pk_mul_f32 v[246:247], v[166:167], v[102:103]
    v_pk_fma_f32 v[246:247], v[182:183], v[118:119], v[246:247] neg_lo:[1,0,0] neg_hi:[1,0,0]
    v_pk_mul_f32 v[182:183], v[182:183], v[102:103]
    v_pk_fma_f32 v[182:183], v[166:167], v[118:119], v[182:183]
    v_cvt_pk_bf16_f32 v184, v232, v233
    v_cvt_pk_bf16_f32 v185, v234, v235
    v_cvt_pk_bf16_f32 v186, v236, v237
    v_cvt_pk_bf16_f32 v187, v238, v239
    ds_write_b128 v2, v[184:187] offset:0
    v_cvt_pk_bf16_f32 v188, v240, v241
    v_cvt_pk_bf16_f32 v189, v242, v243
    v_cvt_pk_bf16_f32 v190, v244, v245
    v_cvt_pk_bf16_f32 v191, v246, v247
    ds_write_b128 v2, v[188:191] offset:1024
    v_cvt_pk_bf16_f32 v192, v168, v169
    v_cvt_pk_bf16_f32 v193, v170, v171
    v_cvt_pk_bf16_f32 v194, v172, v173
    v_cvt_pk_bf16_f32 v195, v174, v175
    ds_write_b128 v2, v[192:195] offset:2048
    v_cvt_pk_bf16_f32 v196, v176, v177
    v_cvt_pk_bf16_f32 v197, v178, v179
    v_cvt_pk_bf16_f32 v198, v180, v181
    v_cvt_pk_bf16_f32 v199, v182, v183
    ds_write_b128 v2, v[196:199] offset:3072
    s_setprio 0
    s_waitcnt lgkmcnt(0)
    s_barrier
    s_cmp_lg_u32 s36, 6
    s_cbranch_scc1 L_ow_47
    s_waitcnt lgkmcnt(0)
    s_cmp_lg_u32 s67, 9
    s_cbranch_scc1 L_sig_48
    s_atomic_add s75, s[4:5], s66
    s_add_u32 s66, s66, 4096
    s_atomic_add s75, s[4:5], s66
    s_add_u32 s66, s66, 4096
    s_atomic_add s75, s[4:5], s66
    s_add_u32 s66, s66, 4096
    s_atomic_add s75, s[4:5], s66
    s_add_u32 s66, s66, 4096
    s_atomic_add s75, s[4:5], s66
    s_add_u32 s66, s66, 4096
    s_atomic_add s75, s[4:5], s66
    s_add_u32 s66, s66, 4096
    s_atomic_add s75, s[4:5], s66
    s_add_u32 s66, s66, 4096
    s_atomic_add s75, s[4:5], s66
L_sig_48:
L_ow_47:
    s_branch L_wdma
L_flo2_42:
    s_lshl_b32 s57, s36, 12
    s_add_u32 s57, s57, s48
    s_mov_b32 s58, 0
L_sr_49:
    buffer_load_dwordx4 v[112:115], v1, s[4:7], s57 offen offset:0 sc1
    buffer_load_dwordx4 v[116:119], v1, s[4:7], s57 offen offset:1024 sc1
    buffer_load_dwordx4 v[120:123], v1, s[4:7], s57 offen offset:2048 sc1
    buffer_load_dwordx4 v[124:127], v1, s[4:7], s57 offen offset:3072 sc1
    s_or_b32 s52, s42, s58
    s_cbranch_scc1 L_sw_50
    s_waitcnt vmcnt(4)
    v_mov_b32 v2, 62976
    v_mov_b32 v3, 1
    s_mov_b64 exec, 1
    ds_add_rtn_u32 v3, v2, v3 offset:0
    s_waitcnt lgkmcnt(0)
    v_readfirstlane_b32 s52, v3
    s_mov_b64 exec, -1
    s_cmp_lg_u32 s52, 3
    s_cbranch_scc1 L_sg_51
    s_lshl_b32 s53, s39, 5
    s_add_u32 s53, s53, s41
    s_lshl_b32 s53, s53, 5
    s_add_u32 s53, s53, s42
    s_lshl_b32 s53, s53, 2
    s_add_u32 s53, s53, 155648
    s_atomic_add s75, s[4:5], s53
L_sg_51:
L_sw_50:
    v_mov_b32 v8, 0x3727c5ac
    s_lshl_b32 s52, s36, 10
    s_add_u32 s52, s52, 102400
    v_lshl_add_u32 v9, v0, 2, s52
    s_add_u32 s58, s58, 1
    v_mov_b32 v3, 8
    v_mov_b32 v18, 0
    s_waitcnt vmcnt(3)
    v_cvt_f32_u32 v4, v112
    v_cvt_f32_u32 v5, v114
    v_cvt_f32_u32 v6, v113
    v_cvt_f32_u32 v7, v115
    v_fmamk_f32 v4, v4, 0x29cccccd, v8
    v_fmamk_f32 v5, v5, 0x29cccccd, v8
    v_fmamk_f32 v4, v6, 0x39cccccd, v4
    v_fmamk_f32 v5, v7, 0x39cccccd, v5
    v_rsq_f32 v4, v4
    v_rsq_f32 v5, v5
    v_bitop3_b32 v3, v3, v112, v114 bitop3:0x80
    v_or3_b32 v18, v18, v112, v114
    v_cvt_pk_bf16_f32 v10, v4, v5
    v_cvt_pk_bf16_f32 v11, v4, -v5
    ds_write2st64_b32 v9, v10, v11 offset0:0 offset1:16
    s_waitcnt vmcnt(2)
    v_cvt_f32_u32 v4, v116
    v_cvt_f32_u32 v5, v118
    v_cvt_f32_u32 v6, v117
    v_cvt_f32_u32 v7, v119
    v_fmamk_f32 v4, v4, 0x29cccccd, v8
    v_fmamk_f32 v5, v5, 0x29cccccd, v8
    v_fmamk_f32 v4, v6, 0x39cccccd, v4
    v_fmamk_f32 v5, v7, 0x39cccccd, v5
    v_rsq_f32 v4, v4
    v_rsq_f32 v5, v5
    v_bitop3_b32 v3, v3, v116, v118 bitop3:0x80
    v_or3_b32 v18, v18, v116, v118
    v_cvt_pk_bf16_f32 v12, v4, v5
    v_cvt_pk_bf16_f32 v13, v4, -v5
    ds_write2st64_b32 v9, v12, v13 offset0:1 offset1:17
    s_waitcnt vmcnt(1)
    v_cvt_f32_u32 v4, v120
    v_cvt_f32_u32 v5, v122
    v_cvt_f32_u32 v6, v121
    v_cvt_f32_u32 v7, v123
    v_fmamk_f32 v4, v4, 0x29cccccd, v8
    v_fmamk_f32 v5, v5, 0x29cccccd, v8
    v_fmamk_f32 v4, v6, 0x39cccccd, v4
    v_fmamk_f32 v5, v7, 0x39cccccd, v5
    v_rsq_f32 v4, v4
    v_rsq_f32 v5, v5
    v_bitop3_b32 v3, v3, v120, v122 bitop3:0x80
    v_or3_b32 v18, v18, v120, v122
    v_cvt_pk_bf16_f32 v14, v4, v5
    v_cvt_pk_bf16_f32 v15, v4, -v5
    ds_write2st64_b32 v9, v14, v15 offset0:2 offset1:18
    s_waitcnt vmcnt(0)
    v_cvt_f32_u32 v4, v124
    v_cvt_f32_u32 v5, v126
    v_cvt_f32_u32 v6, v125
    v_cvt_f32_u32 v7, v127
    v_fmamk_f32 v4, v4, 0x29cccccd, v8
    v_fmamk_f32 v5, v5, 0x29cccccd, v8
    v_fmamk_f32 v4, v6, 0x39cccccd, v4
    v_fmamk_f32 v5, v7, 0x39cccccd, v5
    v_rsq_f32 v4, v4
    v_rsq_f32 v5, v5
    v_bitop3_b32 v3, v3, v124, v126 bitop3:0x80
    v_or3_b32 v18, v18, v124, v126
    v_cvt_pk_bf16_f32 v16, v4, v5
    v_cvt_pk_bf16_f32 v17, v4, -v5
    ds_write2st64_b32 v9, v16, v17 offset0:3 offset1:19
    v_cmp_eq_u32 vcc, 0, v3
    s_cmp_ge_u32 s58, 65536
    s_cselect_b64 vcc, 0, vcc
    v_and_b32 v18, 0xff0, v18
    s_cbranch_vccnz L_sr_49
    v_cmp_ne_u32 vcc, 0, v18
    s_nop 0
    s_cbranch_vccnz L_big_get
L_big_done:
    s_waitcnt lgkmcnt(0)
    s_barrier
    s_lshr_b32 s52, s36, 1
    s_lshl_b32 s52, s52, 11
    s_and_b32 s53, s36, 1
    s_lshl_b32 s53, s53, 8
    s_add_u32 s52, s52, s53
    s_add_u32 s52, s52, s56
    s_add_u32 s52, s52, s46
    v_lshrrev_b32 v2, 4, v0
    v_lshlrev_b32 v2, 9, v2
    v_and_b32 v3, 15, v0
    v_lshl_add_u32 v2, v3, 4, v2
    buffer_load_dwordx4 v[64:67], v2, s[4:7], s52 offen sc1
    s_add_u32 s52, s52, 4096
    buffer_load_dwordx4 v[68:71], v2, s[4:7], s52 offen sc1
    s_add_u32 s52, s52, 4096
    buffer_load_dwordx4 v[72:75], v2, s[4:7], s52 offen sc1
    s_add_u32 s52, s52, 4096
    buffer_load_dwordx4 v[76:79], v2, s[4:7], s52 offen sc1
    s_and_b32 s52, s36, 1
    s_lshl_b32 s53, s52, 8
    s_add_u32 s53, s53, 110592
    v_add_u32 v2, s53, v2
    v_mov_b32 v144, v2
    s_cmp_lg_u32 s42, 0
    s_cbranch_scc1 L_un_lo
L_un_ret:
    v_mov_b32 v2, v144
    s_and_b32 s52, s36, 1
    s_lshr_b32 s53, s36, 1
    s_mul_i32 s53, s53, 1318912
    s_mul_i32 s52, s52, 164864
    s_add_u32 s53, s53, s52
    s_lshl_b32 s52, s43, 8
    s_add_u32 s53, s53, s52
    s_add_u32 s57, s53, s47
    s_add_u32 s58, s57, 41216
    v_lshrrev_b32 v3, 4, v0
    v_bfe_u32 v4, v0, 3, 1
    v_lshl_add_u32 v3, v3, 2, v4
    v_mul_u32_u24 v3, 82432, v3
    v_and_b32 v4, 7, v0
    v_lshl_add_u32 v3, v4, 4, v3
    s_mov_b32 s52, 0x3f003f00
    s_mov_b32 s53, 0xbf003f00
    s_waitcnt vmcnt(0)
    v_dot2_f32_bf16 v32, v64, s52, 0
    v_dot2_f32_bf16 v33, v65, s52, 0
    v_dot2_f32_bf16 v34, v66, s52, 0
    v_dot2_f32_bf16 v35, v67, s52, 0
    v_dot2_f32_bf16 v36, v64, s53, 0
    v_dot2_f32_bf16 v37, v65, s53, 0
    v_dot2_f32_bf16 v38, v66, s53, 0
    v_dot2_f32_bf16 v39, v67, s53, 0
    v_dot2_f32_bf16 v40, v68, s52, 0
    v_dot2_f32_bf16 v41, v69, s52, 0
    v_dot2_f32_bf16 v42, v70, s52, 0
    v_dot2_f32_bf16 v43, v71, s52, 0
    v_dot2_f32_bf16 v44, v68, s53, 0
    v_dot2_f32_bf16 v45, v69, s53, 0
    v_dot2_f32_bf16 v46, v70, s53, 0
    v_dot2_f32_bf16 v47, v71, s53, 0
    v_dot2_f32_bf16 v48, v72, s52, 0
    v_dot2_f32_bf16 v49, v73, s52, 0
    v_dot2_f32_bf16 v50, v74, s52, 0
    v_dot2_f32_bf16 v51, v75, s52, 0
    v_dot2_f32_bf16 v52, v72, s53, 0
    v_dot2_f32_bf16 v53, v73, s53, 0
    v_dot2_f32_bf16 v54, v74, s53, 0
    v_dot2_f32_bf16 v55, v75, s53, 0
    v_dot2_f32_bf16 v56, v76, s52, 0
    v_dot2_f32_bf16 v57, v77, s52, 0
    v_dot2_f32_bf16 v58, v78, s52, 0
    v_dot2_f32_bf16 v59, v79, s52, 0
    v_dot2_f32_bf16 v60, v76, s53, 0
    v_dot2_f32_bf16 v61, v77, s53, 0
    v_dot2_f32_bf16 v62, v78, s53, 0
    v_dot2_f32_bf16 v63, v79, s53, 0
    s_cmp_lg_u32 s42, 0
    s_cbranch_scc1 L_wb_52
    v_bfe_u32 v4, v0, 3, 1
    v_mul_u32_u24 v4, 19, v4
    s_mul_i32 s53, s38, 20
    v_add_u32 v4, s53, v4
    v_lshrrev_b32 v4, 6, v4
    v_lshrrev_b32 v5, 4, v0
    v_mad_u32_u24 v4, v5, 10, v4
    v_and_b32 v5, 7, v4
    v_lshrrev_b32 v4, 3, v4
    v_lshl_add_u32 v4, v5, 2, v4
    v_and_b32 v5, 7, v0
    v_lshl_add_u32 v4, v5, 5, v4
    v_lshlrev_b32 v5, 7, v4
    s_mov_b32 s54, 155648
    s_mov_b32 exec_hi, 0xffff
    s_mov_b32 s52, s44
L_poll_53:
    buffer_load_dword v4, v5, s[4:7], s54 offen sc1
    s_add_u32 s52, s52, 1
    s_cmp_ge_u32 s52, 65536
    s_cselect_b32 s44, 65536, s44
    s_waitcnt vmcnt(0)
    s_cbranch_scc1 L_pd_54
    v_cmp_gt_u32 vcc, 1, v4
    s_nop 0
    s_cbranch_vccnz L_poll_53
L_pd_54:
    s_mov_b64 exec, -1
L_wlo:
    v_lshlrev_b32 v1, 4, v0
    s_mul_i32 s52, s36, 8192
    s_add_u32 m0, s52, 0
    s_mul_i32 s53, s38, 102400
    s_add_u32 s53, s53, m0
    s_add_u32 s53, s53, 13402112
    buffer_load_dwordx4 v1, s[4:7], s53 offen offset:0 sc1 lds
    buffer_load_dwordx4 v1, s[4:7], s53 offen offset:1024 sc1 lds
    buffer_load_dwordx4 v1, s[4:7], s53 offen offset:2048 sc1 lds
    buffer_load_dwordx4 v1, s[4:7], s53 offen offset:3072 sc1 lds
    s_add_u32 m0, m0, 4096
    s_add_u32 s53, s53, 4096
    buffer_load_dwordx4 v1, s[4:7], s53 offen offset:0 sc1 lds
    buffer_load_dwordx4 v1, s[4:7], s53 offen offset:1024 sc1 lds
    buffer_load_dwordx4 v1, s[4:7], s53 offen offset:2048 sc1 lds
    buffer_load_dwordx4 v1, s[4:7], s53 offen offset:3072 sc1 lds
L_wd_55:
    s_cmp_ge_u32 s88, 20
    s_cbranch_scc1 L_auxb
L_wb_52:
    s_setprio 3
    s_barrier
    ds_read_b128 v[80:83], v2 offset:0
    ds_read_b128 v[84:87], v2 offset:2048
    ds_read_b128 v[88:91], v2 offset:4096
    ds_read_b128 v[92:95], v2 offset:6144
    ds_read_b128 v[96:99], v2 offset:8192
    ds_read_b128 v[100:103], v2 offset:10240
    ds_read_b128 v[104:107], v2 offset:12288
    ds_read_b128 v[108:111], v2 offset:14336
    s_waitcnt lgkmcnt(4)
    v_mfma_f32_16x16x32_bf16 v[32:35], v[156:159], v[80:83], v[32:35]
    v_mfma_f32_16x16x32_bf16 v[36:39], v[168:171], v[88:91], v[36:39]
    v_mfma_f32_16x16x32_bf16 v[32:35], v[164:167], v[84:87], v[32:35]
    v_mfma_f32_16x16x32_bf16 v[36:39], v[196:199], v[92:95], v[36:39]
    v_mfma_f32_16x16x32_bf16 v[40:43], v[160:163], v[80:83], v[40:43]
    v_mfma_f32_16x16x32_bf16 v[44:47], v[172:175], v[88:91], v[44:47]
    v_mfma_f32_16x16x32_bf16 v[40:43], v[156:159], v[84:87], v[40:43]
    v_mfma_f32_16x16x32_bf16 v[44:47], v[168:171], v[92:95], v[44:47]
    s_waitcnt lgkmcnt(0)
    v_mfma_f32_16x16x32_bf16 v[48:51], v[156:159], v[96:99], v[48:51]
    v_mfma_f32_16x16x32_bf16 v[52:55], v[168:171], v[104:107], v[52:55]
    v_mfma_f32_16x16x32_bf16 v[48:51], v[164:167], v[100:103], v[48:51]
    v_mfma_f32_16x16x32_bf16 v[52:55], v[196:199], v[108:111], v[52:55]
    s_cmp_eq_u32 s43, 159
    s_cbranch_scc1 L_dc_56
    v_mfma_f32_16x16x32_bf16 v[56:59], v[160:163], v[96:99], v[56:59]
    v_mfma_f32_16x16x32_bf16 v[60:63], v[172:175], v[104:107], v[60:63]
    v_mfma_f32_16x16x32_bf16 v[56:59], v[156:159], v[100:103], v[56:59]
    v_mfma_f32_16x16x32_bf16 v[60:63], v[168:171], v[108:111], v[60:63]
L_dc_56:
    v_pk_add_f32 v[112:113], v[32:33], v[36:37]
    v_pk_add_f32 v[116:117], v[32:33], v[36:37] neg_lo:[0,1] neg_hi:[0,1]
    v_pk_add_f32 v[114:115], v[34:35], v[38:39]
    v_pk_add_f32 v[118:119], v[34:35], v[38:39] neg_lo:[0,1] neg_hi:[0,1]
    v_pk_add_f32 v[120:121], v[40:41], v[44:45]
    v_pk_add_f32 v[124:125], v[40:41], v[44:45] neg_lo:[0,1] neg_hi:[0,1]
    v_pk_add_f32 v[122:123], v[42:43], v[46:47]
    v_pk_add_f32 v[126:127], v[42:43], v[46:47] neg_lo:[0,1] neg_hi:[0,1]
    v_pk_add_f32 v[128:129], v[48:49], v[52:53]
    v_pk_add_f32 v[132:133], v[48:49], v[52:53] neg_lo:[0,1] neg_hi:[0,1]
    v_pk_add_f32 v[130:131], v[50:51], v[54:55]
    v_pk_add_f32 v[134:135], v[50:51], v[54:55] neg_lo:[0,1] neg_hi:[0,1]
    v_pk_add_f32 v[136:137], v[56:57], v[60:61]
    v_pk_add_f32 v[140:141], v[56:57], v[60:61] neg_lo:[0,1] neg_hi:[0,1]
    v_pk_add_f32 v[138:139], v[58:59], v[62:63]
    v_pk_add_f32 v[142:143], v[58:59], v[62:63] neg_lo:[0,1] neg_hi:[0,1]
    v_cvt_pk_bf16_f32 v8, v112, v120
    v_cvt_pk_bf16_f32 v9, v128, v136
    v_cvt_pk_bf16_f32 v10, v116, v124
    v_cvt_pk_bf16_f32 v11, v132, v140
    buffer_store_dwordx4 v[8:11], v3, s[4:7], s57 offen offset:0 sc1
    v_cvt_pk_bf16_f32 v12, v113, v121
    v_cvt_pk_bf16_f32 v13, v129, v137
    v_cvt_pk_bf16_f32 v14, v117, v125
    v_cvt_pk_bf16_f32 v15, v133, v141
    buffer_store_dwordx4 v[12:15], v3, s[4:7], s57 offen offset:128 sc1
    v_cvt_pk_bf16_f32 v16, v114, v122
    v_cvt_pk_bf16_f32 v17, v130, v138
    v_cvt_pk_bf16_f32 v18, v118, v126
    v_cvt_pk_bf16_f32 v19, v134, v142
    buffer_store_dwordx4 v[16:19], v3, s[4:7], s58 offen offset:0 sc1
    v_cvt_pk_bf16_f32 v20, v115, v123
    v_cvt_pk_bf16_f32 v21, v131, v139
    v_cvt_pk_bf16_f32 v22, v119, v127
    v_cvt_pk_bf16_f32 v23, v135, v143
    buffer_store_dwordx4 v[20:23], v3, s[4:7], s58 offen offset:128 sc1
    s_branch L_setup
L_aux_27:
    s_setprio 0
    s_cmp_eq_u32 s42, 0
    s_cbranch_scc1 L_wt_28
    s_cmp_ge_u32 s89, 10
    s_cbranch_scc1 L_setup
    v_lshlrev_b32 v1, 4, v0
    s_mov_b32 s58, s36
L_wtl_57:
    s_cmp_ge_u32 s58, 5
    s_cselect_b32 s52, 1, 0
    s_mul_i32 s53, s52, 5
    s_sub_u32 s53, s58, s53
    s_lshl_b32 s54, s89, 1
    s_add_u32 s54, s54, s52
    s_lshl_b32 s55, s54, 5
    v_lshrrev_b32 v2, 4, v0
    v_lshl_add_u32 v2, v2, 3, s55
    v_lshrrev_b32 v4, 4, v2
    v_lshl_add_u32 v3, v4, 2, v2
    v_subrev_u32 v4, 512, v2
    v_lshrrev_b32 v5, 2, v4
    v_lshl_add_u32 v4, v5, 4, v4
    v_add_u32 v4, 16, v4
    v_cmp_le_u32 vcc, 512, v2
    s_nop 1
    v_cndmask_b32 v3, v3, v4, vcc
    v_add_u32 v2, 4, v2
    v_lshrrev_b32 v4, 4, v2
    v_lshl_add_u32 v6, v4, 2, v2
    v_subrev_u32 v4, 512, v2
    v_lshrrev_b32 v5, 2, v4
    v_lshl_add_u32 v4, v5, 4, v4
    v_add_u32 v4, 16, v4
    v_cmp_le_u32 vcc, 512, v2
    s_nop 1
    v_cndmask_b32 v6, v6, v4, vcc
    s_lshr_b32 s55, s53, 1
    s_lshl_b32 s55, s55, 5
    s_and_b32 s56, s53, 1
    s_lshl_b32 s56, s56, 2
    s_add_u32 s55, s55, s56
    s_mul_i32 s56, s39, 80
    s_add_u32 s55, s55, s56
    s_cmp_eq_u32 s53, 4
    s_cselect_b32 s56, 2, 3
    v_bfe_u32 v4, v0, 2, 2
    v_lshlrev_b32 v4, s56, v4
    v_and_b32 v5, 3, v0
    v_add3_u32 v4, v4, v5, s55
    v_lshlrev_b32 v4, 1, v4
    v_mul_u32_u24 v3, 1280, v3
    v_mul_u32_u24 v6, 1280, v6
    v_add_u32 v3, v3, v4
    v_add_u32 v6, v6, v4
    buffer_load_ushort v12, v3, s[24:27], 0 offen offset:0
    buffer_load_ushort v13, v3, s[24:27], 0 offen offset:1280
    buffer_load_ushort v14, v3, s[24:27], 0 offen offset:2560
    buffer_load_ushort v15, v3, s[24:27], 0 offen offset:3840
    buffer_load_ushort v16, v6, s[24:27], 0 offen offset:0
    buffer_load_ushort v17, v6, s[24:27], 0 offen offset:1280
    buffer_load_ushort v18, v6, s[24:27], 0 offen offset:2560
    buffer_load_ushort v19, v6, s[24:27], 0 offen offset:3840
    s_mul_i32 s52, s39, 100
    s_mul_i32 s54, s54, 5
    s_add_u32 s52, s52, s54
    s_add_u32 s52, s52, s53
    s_lshl_b32 s52, s52, 10
    s_add_u32 s52, s52, 17498112
    s_waitcnt vmcnt(0)
    v_lshl_or_b32 v8, v13, 16, v12
    v_lshl_or_b32 v9, v15, 16, v14
    v_lshl_or_b32 v10, v17, 16, v16
    v_lshl_or_b32 v11, v19, 16, v18
    buffer_store_dwordx4 v[8:11], v1, s[4:7], s52 offen sc1
    s_add_u32 s58, s58, 8
    s_cmp_lt_u32 s58, 10
    s_cbranch_scc1 L_wtl_57
    s_branch L_setup
L_wt_28:
    s_cmp_lt_u32 s36, 4
    s_cbranch_scc1 L_wlo
    s_cmp_ge_u32 s89, 10
    s_cbranch_scc1 L_auxb
    v_and_b32 v2, 15, v0
    v_mul_u32_u24 v2, 144, v2
    v_and_b32 v3, 48, v0
    v_add_u32 v2, v2, v3
    v_lshlrev_b32 v1, 4, v0
    s_mov_b32 s58, s98
L_wfl_58:
    s_cmp_ge_u32 s58, 5
    s_cselect_b32 s52, -11456, 0
    s_mul_i32 s53, s58, 2304
    s_add_u32 s52, s52, s53
    s_add_u32 s52, s52, 51200
    v_add_u32 v3, s52, v2
    ds_read_b128 v[4:7], v3
    s_mul_i32 s52, s39, 100
    s_mul_i32 s53, s89, 10
    s_add_u32 s52, s52, s53
    s_add_u32 s52, s52, s58
    s_lshl_b32 s52, s52, 10
    s_add_u32 s52, s52, 16678912
    s_waitcnt lgkmcnt(0)
    buffer_store_dwordx4 v[4:7], v1, s[4:7], s52 offen sc1
    s_add_u32 s58, s58, 4
    s_cmp_lt_u32 s58, 10
    s_cbranch_scc1 L_wfl_58
L_auxb:
    s_barrier
    s_cmp_lt_u32 s36, 4
    s_cbranch_scc1 L_setup
L_wdma:
    s_cmp_lg_u32 s42, 0
    s_cbranch_scc1 L_setup
    v_lshlrev_b32 v1, 4, v0
    s_mul_i32 s52, s98, 12288
    s_add_u32 m0, s52, 32768
    s_mul_i32 s53, s38, 102400
    s_add_u32 s53, s53, m0
    s_add_u32 s53, s53, 13402112
    buffer_load_dwordx4 v1, s[4:7], s53 offen offset:0 sc1 lds
    buffer_load_dwordx4 v1, s[4:7], s53 offen offset:1024 sc1 lds
    buffer_load_dwordx4 v1, s[4:7], s53 offen offset:2048 sc1 lds
    buffer_load_dwordx4 v1, s[4:7], s53 offen offset:3072 sc1 lds
    s_add_u32 m0, m0, 4096
    s_add_u32 s53, s53, 4096
    buffer_load_dwordx4 v1, s[4:7], s53 offen offset:0 sc1 lds
    buffer_load_dwordx4 v1, s[4:7], s53 offen offset:1024 sc1 lds
    buffer_load_dwordx4 v1, s[4:7], s53 offen offset:2048 sc1 lds
    buffer_load_dwordx4 v1, s[4:7], s53 offen offset:3072 sc1 lds
    s_add_u32 m0, m0, 4096
    s_add_u32 s53, s53, 4096
    buffer_load_dwordx4 v1, s[4:7], s53 offen offset:0 sc1 lds
    buffer_load_dwordx4 v1, s[4:7], s53 offen offset:1024 sc1 lds
    buffer_load_dwordx4 v1, s[4:7], s53 offen offset:2048 sc1 lds
    buffer_load_dwordx4 v1, s[4:7], s53 offen offset:3072 sc1 lds
L_wd_59:
L_setup:
    s_mov_b32 s74, 133120
    v_lshlrev_b32 v1, 4, v0
    v_mov_b32 v8, 157760
    v_mov_b64 v[4:5], 0
    ds_write_b64 v8, v[4:5]
    s_lshl_b32 s60, s90, 3
    s_add_u32 s60, s60, s36
    s_mul_i32 s60, s60, 41216
    s_add_u32 s60, s60, s47
    s_lshr_b32 s53, s36, 2
    s_mul_i32 s55, s53, 11264
    s_add_u32 s54, s55, 102400
    v_add_u32 v8, s54, v1
    s_add_u32 s54, s55, 103424
    v_and_b32 v2, 31, v0
    v_lshl_add_u32 v9, v2, 3, s54
    v_bfe_u32 v2, v0, 2, 2
    v_lshrrev_b32 v3, 5, v0
    v_lshl_add_u32 v2, v3, 3, v2
    v_mul_u32_u24 v2, 48, v2
    v_and_b32 v3, 1, v0
    v_bfe_u32 v4, v0, 1, 1
    v_lshl_add_u32 v3, v3, 1, v4
    v_add_u32 v4, 4, v4
    v_and_b32 v5, 16, v0
    v_cmp_eq_u32 vcc, 0, v5
    s_nop 1
    v_cndmask_b32 v3, v4, v3, vcc
    v_lshl_add_u32 v2, v3, 3, v2
    s_add_u32 s54, s55, 103680
    v_add_u32 v10, s54, v2
    s_lshl_b32 s54, s53, 5
    v_xor_b32 v2, s54, v0
    s_lshl_b32 s54, s98, 9
    s_add_u32 s54, s54, 155648
    v_lshl_add_u32 v11, v2, 3, s54
    v_bfe_u32 v12, v0, 4, 1
    v_mul_u32_u24 v12, 20480, v12
    v_and_b32 v2, 15, v0
    v_lshl_add_u32 v13, v2, 3, v12
    v_lshl_add_u32 v12, v2, 4, v12
    v_lshrrev_b32 v3, 5, v0
    v_lshl_add_u32 v12, v3, 8, v12
    v_lshrrev_b32 v3, 4, v0
    s_cmp_lg_u32 s42, 0
    s_cbranch_scc1 L_k1_60
    s_cmp_ge_u32 s88, 20
    s_cselect_b32 s54, 0x40000000, 0
    s_cmp_lt_u32 s36, 4
    s_cbranch_scc1 L_k3_62
    v_or_b32 v14, s54, v1
    v_lshrrev_b32 v2, 3, v0
    v_and_b32 v3, 7, v0
    v_lshlrev_b32 v5, 12, v2
    v_lshl_add_u32 v5, v3, 4, v5
    v_mov_b32 v15, v5
    s_branch L_k2_61
L_k3_62:
    v_bfe_u32 v4, v0, 2, 1
    v_mul_u32_u24 v4, 41216, v4
    v_bfe_u32 v5, v0, 1, 1
    v_lshl_add_u32 v4, v5, 7, v4
    v_bfe_u32 v5, v0, 3, 1
    v_lshl_add_u32 v4, v5, 4, v4
    v_lshl_add_u32 v14, v3, 8, v4
    v_lshrrev_b32 v3, 4, v0
    v_bfe_u32 v4, v0, 3, 1
    v_lshl_add_u32 v3, v3, 2, v4
    v_mul_u32_u24 v3, 82432, v3
    v_and_b32 v4, 7, v0
    v_lshl_add_u32 v3, v4, 4, v3
    v_or_b32 v15, s54, v3
    s_branch L_k2_61
L_k1_60:
    v_lshlrev_b32 v4, 4, v2
    v_lshl_add_u32 v14, v3, 9, v4
    v_mov_b32 v15, v1
L_k2_61:
    s_lshl_b32 s52, s36, 11
    s_add_u32 s52, s52, 129024
    v_add_u32 v254, s52, v1
    ds_write_b128 v254, v[8:11]
    ds_write_b128 v254, v[12:15] offset:1024
    v_and_b32 v2, 15, v0
    v_lshrrev_b32 v3, 4, v0
    s_mul_i32 s61, s36, 2816
    s_add_u32 s52, s61, 102400
    v_lshl_add_u32 v80, v2, 4, s52
    v_lshrrev_b32 v4, 1, v3
    v_lshl_add_u32 v80, v4, 9, v80
    v_and_b32 v4, 1, v3
    v_lshl_add_u32 v80, v4, 3, v80
    s_add_u32 s53, s52, 1024
    v_lshl_add_u32 v5, v2, 3, s53
    v_mul_u32_u24 v6, 48, v2
    v_lshl_add_u32 v6, v3, 3, v6
    s_add_u32 s53, s52, 1272
    v_add_u32 v6, s53, v6
    v_and_b32 v252, 31, v0
    v_mul_u32_u24 v252, 48, v252
    s_add_u32 s53, s52, 1320
    v_add_u32 v252, s53, v252
    v_add_u32 v253, s52, v1
    s_lshr_b32 s52, s36, 1
    s_lshl_b32 s52, s52, 6
    s_and_b32 s53, s36, 1
    s_lshl_b32 s53, s53, 2
    s_add_u32 s52, s52, s53
    v_and_b32 v7, 7, v2
    v_lshl_add_u32 v7, v7, 3, s52
    v_lshrrev_b32 v88, 3, v2
    v_lshl_add_u32 v7, v88, 1, v7
    s_lshl_b32 s52, s36, 5
    v_add_u32 v88, s52, v2
    s_cmp_eq_u32 s42, 0
    s_cselect_b64 vcc, -1, 0
    s_cselect_b32 s54, 8, 128
    s_lshl_b32 s55, s54, 1
    v_cndmask_b32 v7, v88, v7, vcc
    v_lshrrev_b32 v88, 5, v7
    v_lshlrev_b32 v88, 10, v88
    v_and_b32 v89, 31, v7
    v_lshl_add_u32 v88, v89, 4, v88
    v_and_b32 v89, 1, v3
    v_lshl_add_u32 v88, v89, 3, v88
    v_add_u32 v88, 147456, v88
    v_lshlrev_b32 v7, 3, v7
    v_add_u32 v7, 155648, v7
    v_lshlrev_b32 v89, 3, v2
    v_add_u32 v89, 157952, v89
    v_cmp_gt_u32 s[76:77], 16, v0
    v_cmp_gt_u32 s[78:79], 32, v0
    v_cmp_gt_u32 s[80:81], 48, v0
    v_cndmask_b32 v81, v6, v5, s[76:77]
    v_add_u32 v90, 32, v6
    v_cndmask_b32 v83, v88, v90, s[78:79]
    v_cndmask_b32 v90, v89, v7, s[80:81]
    v_add_u32 v91, 512, v88
    v_cndmask_b32 v85, v90, v91, s[78:79]
    v_add_u32 v5, 128, v5
    v_add_u32 v6, 768, v6
    v_add_u32 v88, s55, v88
    v_add_u32 v7, s54, v7
    v_cndmask_b32 v82, v6, v5, s[76:77]
    v_add_u32 v90, 32, v6
    v_cndmask_b32 v84, v88, v90, s[78:79]
    v_cndmask_b32 v90, v89, v7, s[80:81]
    v_add_u32 v91, 512, v88
    v_cndmask_b32 v86, v90, v91, s[78:79]
    s_lshl_b32 s53, s38, 3
    s_add_u32 s53, s53, s90
    s_mul_i32 s53, s53, 22528
    s_add_u32 s61, s61, s53
    s_add_u32 s61, s61, s49
    v_lshlrev_b32 v87, 3, v2
    v_lshrrev_b32 v6, 5, v0
    v_lshl_add_u32 v6, v6, 3, v3
    v_lshlrev_b32 v6, 9, v6
    v_lshl_add_u32 v6, v2, 4, v6
    v_lshrrev_b32 v7, 2, v0
    v_lshlrev_b32 v7, 8, v7
    v_and_b32 v4, 3, v0
    v_lshl_add_u32 v7, v4, 4, v7
    v_mov_b32 v90, -1
    v_mov_b32 v91, 0xffff
    v_cmp_gt_u32 vcc, 60, v0
    s_lshl_b32 s62, s90, 3
    s_lshr_b32 s52, s38, 2
    s_add_u32 s62, s62, s52
    s_mul_i32 s62, s62, 41216
    s_and_b32 s52, s38, 3
    s_lshl_b32 s52, s52, 6
    s_add_u32 s62, s62, s52
    s_add_u32 s62, s62, s47
    v_cndmask_b32 v90, v91, v90, vcc
    v_mov_b32 v91, 0x3727c5ac
    s_lshl_b32 s64, s42, 13
    s_lshl_b32 s52, s90, 10
    s_add_u32 s64, s64, s52
    s_add_u32 s64, s64, 139264
    s_lshl_b32 s52, s38, 5
    s_add_u32 s63, s64, s52
    s_lshl_b32 s52, s36, 7
    s_add_u32 s64, s64, s52
    v_bfe_u32 v3, v0, 2, 2
    v_sub_u32 v4, 0, v3
    v_lshrrev_b32 v5, 4, v0
    v_xor_b32 v4, v4, v5
    v_and_b32 v4, 3, v4
    v_lshlrev_b32 v3, 8, v3
    v_lshl_add_u32 v3, v4, 6, v3
    v_and_b32 v4, 3, v0
    v_lshl_add_u32 v3, v4, 4, v3
    v_add_u32 v2, 61440, v3
    s_cmp_lg_u32 s42, 0
    s_cbranch_scc1 L_so_64
    s_mul_i32 s80, s38, 102400
    s_mul_i32 s53, s36, 5120
    s_add_u32 s80, s80, s53
    s_add_u32 s80, s80, 13463552
    s_add_u32 s81, s80, 4096
    s_cmp_lt_u32 s36, 4
    s_cbranch_scc1 L_so_66
    s_mul_i32 s56, s39, 327680
    s_lshl_b32 s57, s41, 7
    s_add_u32 s56, s56, s57
    s_add_u32 s56, s56, 2883584
    s_lshl_b32 s57, s98, 15
    s_add_u32 s76, s56, s57
    s_add_u32 s77, s76, 131072
    s_add_u32 s78, s76, 262144
    s_cmp_ge_u32 s36, 6
    s_cselect_b32 s78, s76, s78
    s_mov_b32 s79, s77
    s_lshl_b32 s52, s98, 12
    s_lshl_b32 s84, s43, 14
    s_add_u32 s84, s84, s52
    s_add_u32 s84, s84, 10780672
    s_mov_b32 s85, s84
    s_branch L_so_65
L_so_66:
    s_and_b32 s52, s36, 1
    s_lshr_b32 s53, s36, 1
    s_mul_i32 s53, s53, 1318912
    s_mul_i32 s52, s52, 164864
    s_add_u32 s53, s53, s52
    s_lshl_b32 s52, s43, 8
    s_add_u32 s53, s53, s52
    s_add_u32 s57, s53, 8142848
    s_add_u32 s58, s57, 41216
    s_mov_b32 s76, s57
    s_mov_b32 s78, s58
    s_add_u32 s77, s76, 128
    s_add_u32 s79, s78, 128
    s_mul_i32 s84, s41, 82432
    s_mul_i32 s53, s39, 5120
    s_add_u32 s84, s84, s53
    s_lshl_b32 s53, s36, 5
    s_add_u32 s84, s84, s53
    s_add_u32 s84, s84, s47
    s_add_u32 s85, s84, 4096
    s_branch L_so_65
L_so_64:
    s_lshl_b32 s76, s90, 3
    s_add_u32 s76, s76, s36
    s_mul_i32 s76, s76, 81920
    s_mul_i32 s53, s38, 1280
    s_add_u32 s76, s76, s53
    s_add_u32 s76, s76, 35093760
    s_add_u32 s77, s76, 40960
    s_add_u32 s78, s76, 1024
    s_add_u32 s79, s77, 1024
    s_lshl_b32 s84, s41, 2
    s_add_u32 s84, s84, s36
    s_mul_i32 s84, s84, 40960
    s_mul_i32 s53, s39, 5120
    s_add_u32 s84, s84, s53
    s_add_u32 s84, s84, 35094528
    s_add_u32 s85, s84, 4096
L_so_65:
    s_movk_i32 s53, 256
    s_cmp_eq_u32 s42, 0
    s_cselect_b32 s52, 1024, s53
    s_add_u32 s86, s84, s52
    s_add_u32 s87, s84, 2048
    s_add_u32 s92, s87, s52
    s_setprio 0
    s_mul_i32 s52, s42, 5
    s_cmp_lg_u32 s36, s52
    s_cbranch_scc1 L_s2_67
    s_cmp_eq_u32 s42, 0
    s_cselect_b32 s53, 1, 2
    s_lshl_b32 s54, s37, 12
    s_lshl_b32 s55, s53, 2
    s_add_u32 s54, s54, s55
    v_lshlrev_b32 v5, 7, v0
    s_mov_b32 exec_lo, 0xffff
    s_mov_b32 exec_hi, 0
    s_mov_b32 s52, s44
L_poll_68:
    buffer_load_dword v4, v5, s[4:7], s54 offen sc1
    s_add_u32 s52, s52, 1
    s_cmp_ge_u32 s52, 65536
    s_cselect_b32 s44, 65536, s44
    s_waitcnt vmcnt(0)
    s_cbranch_scc1 L_pd_69
    v_cmp_gt_u32 vcc, 1, v4
    s_nop 0
    s_cbranch_vccnz L_poll_68
L_pd_69:
    s_mov_b64 exec, -1
L_s2_67:
    s_waitcnt vmcnt(0) lgkmcnt(0)
    s_barrier
    s_mov_b32 s65, 0
    s_mov_b64 s[94:95], -1
L_qkv:
    s_add_u32 s52, s60, 0
    buffer_load_dwordx4 v[92:95], v1, s[4:7], s52 offen offset:0 sc1
    buffer_load_dwordx4 v[96:99], v1, s[4:7], s52 offen offset:1024 sc1
    s_add_u32 s52, s60, 2048
    buffer_load_dwordx4 v[100:103], v1, s[4:7], s52 offen offset:0 sc1
    buffer_load_dwordx4 v[104:107], v1, s[4:7], s52 offen offset:1024 sc1
    s_add_u32 s52, s60, 5120
    buffer_load_dwordx4 v[108:111], v1, s[4:7], s52 offen offset:0 sc1
    buffer_load_dwordx4 v[112:115], v1, s[4:7], s52 offen offset:1024 sc1
    v_mov_b32 v4, 0x3f80
    v_mov_b32 v5, 0
    ds_write_b64 v252, v[4:5]
    ds_read_b128 v[48:51], v3 offset:0
    ds_read_b128 v[52:55], v3 offset:20480
    ds_read_b128 v[56:59], v3 offset:40960
    ds_read_b128 v[60:63], v2 offset:0
    s_cmp_lt_u32 s88, 20
    s_cbranch_scc1 L_bx_70
    s_cmp_lg_u32 s65, 0
    s_cbranch_scc1 L_bx_70
    s_cmp_lg_u32 s36, 1
    s_cbranch_scc1 L_ow_71
    s_cmp_eq_u32 s42, 0
    s_cselect_b32 s53, 3, 4
    s_and_b32 s66, s45, 15
    s_lshl_b32 s66, s66, 7
    s_lshl_b32 s67, s53, 2
    s_add_u32 s66, s66, s67
    s_add_u32 s53, s66, 131072
    s_mov_b32 s67, 1
    s_atomic_add s67, s[4:5], s53 glc
    s_waitcnt lgkmcnt(0)
    s_cmp_lg_u32 s67, 5
    s_cbranch_scc1 L_sig_72
    s_atomic_add s75, s[4:5], s66
    s_add_u32 s66, s66, 4096
    s_atomic_add s75, s[4:5], s66
    s_add_u32 s66, s66, 4096
    s_atomic_add s75, s[4:5], s66
    s_add_u32 s66, s66, 4096
    s_atomic_add s75, s[4:5], s66
    s_add_u32 s66, s66, 4096
    s_atomic_add s75, s[4:5], s66
    s_add_u32 s66, s66, 4096
    s_atomic_add s75, s[4:5], s66
    s_add_u32 s66, s66, 4096
    s_atomic_add s75, s[4:5], s66
    s_add_u32 s66, s66, 4096
    s_atomic_add s75, s[4:5], s66
L_sig_72:
L_ow_71:
L_bx_70:
    s_waitcnt vmcnt(4)
    v_swap_b32 v94, v96
    v_swap_b32 v95, v97
    s_waitcnt lgkmcnt(0)
    s_nop 0
    v_mfma_f32_16x16x32_bf16 v[8:11], v[48:51], v[92:95], 0
    ds_read_b128 v[64:67], v3 offset:1024
    ds_read_b128 v[68:71], v3 offset:21504
    v_mfma_f32_16x16x32_bf16 v[12:15], v[48:51], v[96:99], 0
    ds_read_b128 v[72:75], v3 offset:41984
    ds_read_b128 v[76:79], v2 offset:1024
    v_mfma_f32_16x16x32_bf16 v[16:19], v[52:55], v[92:95], 0
    s_add_u32 s52, s60, 7168
    buffer_load_dwordx4 v[116:119], v1, s[4:7], s52 offen offset:0 sc1
    v_mfma_f32_16x16x32_bf16 v[20:23], v[52:55], v[96:99], 0
    buffer_load_dwordx4 v[120:123], v1, s[4:7], s52 offen offset:1024 sc1
    v_mfma_f32_16x16x32_bf16 v[24:27], v[56:59], v[92:95], 0
    s_waitcnt vmcnt(4)
    v_mfma_f32_16x16x32_bf16 v[28:31], v[56:59], v[96:99], 0
    v_swap_b32 v102, v104
    v_mfma_f32_16x16x32_bf16 v[32:35], v[60:63], v[92:95], 0
    v_swap_b32 v103, v105
    v_mfma_f32_16x16x32_bf16 v[36:39], v[60:63], v[96:99], 0
    s_waitcnt lgkmcnt(0)
    v_mfma_f32_16x16x32_bf16 v[8:11], v[64:67], v[100:103], v[8:11]
    ds_read_b128 v[48:51], v3 offset:2048
    ds_read_b128 v[52:55], v3 offset:22528
    v_mfma_f32_16x16x32_bf16 v[12:15], v[64:67], v[104:107], v[12:15]
    ds_read_b128 v[56:59], v3 offset:43008
    ds_read_b128 v[60:63], v2 offset:2048
    v_mfma_f32_16x16x32_bf16 v[16:19], v[68:71], v[100:103], v[16:19]
    s_add_u32 s52, s60, 4096
    buffer_load_dwordx4 v[124:127], v6, s[4:7], s52 offen offset:0 sc1
    v_mfma_f32_16x16x32_bf16 v[20:23], v[68:71], v[104:107], v[20:23]
    buffer_load_dwordx4 v[128:131], v6, s[4:7], s52 offen offset:256 sc1
    v_mfma_f32_16x16x32_bf16 v[24:27], v[72:75], v[100:103], v[24:27]
    s_cmp_lg_u32 s36, 0
    s_cbranch_scc1 L_ow_73
    s_add_u32 s52, s62, 0
    buffer_load_dwordx4 v[212:215], v7, s[4:7], s52 offen sc1
    s_add_u32 s52, s62, 4096
    buffer_load_dwordx4 v[216:219], v7, s[4:7], s52 offen sc1
    s_add_u32 s52, s62, 8192
    buffer_load_dwordx4 v[220:223], v7, s[4:7], s52 offen sc1
    s_add_u32 s52, s62, 12288
    buffer_load_dwordx4 v[224:227], v7, s[4:7], s52 offen sc1
    s_add_u32 s52, s62, 16384
    buffer_load_dwordx4 v[228:231], v7, s[4:7], s52 offen sc1
    s_add_u32 s52, s62, 20480
    buffer_load_dwordx4 v[232:235], v7, s[4:7], s52 offen sc1
    s_add_u32 s52, s62, 24576
    buffer_load_dwordx4 v[236:239], v7, s[4:7], s52 offen sc1
    s_add_u32 s52, s62, 28672
    buffer_load_dwordx4 v[240:243], v7, s[4:7], s52 offen sc1
    s_add_u32 s52, s62, 32768
    buffer_load_dwordx4 v[244:247], v7, s[4:7], s52 offen sc1
    s_add_u32 s52, s62, 36864
    buffer_load_dwordx4 v[248:251], v7, s[4:7], s52 offen sc1
L_ow_73:
    s_waitcnt vmcnt(4)
    v_mfma_f32_16x16x32_bf16 v[28:31], v[72:75], v[104:107], v[28:31]
    v_swap_b32 v110, v112
    v_mfma_f32_16x16x32_bf16 v[32:35], v[76:79], v[100:103], v[32:35]
    v_swap_b32 v111, v113
    v_mfma_f32_16x16x32_bf16 v[36:39], v[76:79], v[104:107], v[36:39]
    s_waitcnt lgkmcnt(0)
    v_mfma_f32_16x16x32_bf16 v[8:11], v[48:51], v[108:111], v[8:11]
    ds_read_b128 v[64:67], v3 offset:3072
    ds_read_b128 v[68:71], v3 offset:23552
    v_mfma_f32_16x16x32_bf16 v[12:15], v[48:51], v[112:115], v[12:15]
    ds_read_b128 v[72:75], v3 offset:44032
    ds_read_b128 v[76:79], v2 offset:3072
    v_mfma_f32_16x16x32_bf16 v[16:19], v[52:55], v[108:111], v[16:19]
    s_add_u32 s52, s60, 10240
    buffer_load_dwordx4 v[132:135], v1, s[4:7], s52 offen offset:0 sc1
    v_mfma_f32_16x16x32_bf16 v[20:23], v[52:55], v[112:115], v[20:23]
    buffer_load_dwordx4 v[136:139], v1, s[4:7], s52 offen offset:1024 sc1
    v_mfma_f32_16x16x32_bf16 v[24:27], v[56:59], v[108:111], v[24:27]
    s_waitcnt vmcnt(4)
    v_mfma_f32_16x16x32_bf16 v[28:31], v[56:59], v[112:115], v[28:31]
    v_swap_b32 v118, v120
    v_mfma_f32_16x16x32_bf16 v[32:35], v[60:63], v[108:111], v[32:35]
    v_swap_b32 v119, v121
    v_mfma_f32_16x16x32_bf16 v[36:39], v[60:63], v[112:115], v[36:39]
    s_waitcnt lgkmcnt(0)
    v_cmp_u_f32 vcc, v8, v12
    s_and_b64 vcc, vcc, s[94:95]
    s_cbranch_scc1 L_qkv_early
    v_mfma_f32_16x16x32_bf16 v[8:11], v[64:67], v[116:119], v[8:11]
    ds_read_b128 v[48:51], v3 offset:4096
    ds_read_b128 v[52:55], v3 offset:24576
    v_mfma_f32_16x16x32_bf16 v[12:15], v[64:67], v[120:123], v[12:15]
    ds_read_b128 v[56:59], v3 offset:45056
    ds_read_b128 v[60:63], v2 offset:4096
    v_mfma_f32_16x16x32_bf16 v[16:19], v[68:71], v[116:119], v[16:19]
    s_add_u32 s52, s60, 12288
    buffer_load_dwordx4 v[140:143], v1, s[4:7], s52 offen offset:0 sc1
    v_mfma_f32_16x16x32_bf16 v[20:23], v[68:71], v[120:123], v[20:23]
    buffer_load_dwordx4 v[144:147], v1, s[4:7], s52 offen offset:1024 sc1
    v_mfma_f32_16x16x32_bf16 v[24:27], v[72:75], v[116:119], v[24:27]
    s_waitcnt vmcnt(4)
    v_mfma_f32_16x16x32_bf16 v[28:31], v[72:75], v[120:123], v[28:31]
    v_swap_b32 v126, v128
    v_mfma_f32_16x16x32_bf16 v[32:35], v[76:79], v[116:119], v[32:35]
    v_swap_b32 v127, v129
    v_mfma_f32_16x16x32_bf16 v[36:39], v[76:79], v[120:123], v[36:39]
    s_waitcnt lgkmcnt(0)
    v_mfma_f32_16x16x32_bf16 v[8:11], v[48:51], v[124:127], v[8:11]
    ds_read_b128 v[64:67], v3 offset:5120
    ds_read_b128 v[68:71], v3 offset:25600
    v_mfma_f32_16x16x32_bf16 v[12:15], v[48:51], v[128:131], v[12:15]
    ds_read_b128 v[72:75], v3 offset:46080
    ds_read_b128 v[76:79], v2 offset:5120
    v_mfma_f32_16x16x32_bf16 v[16:19], v[52:55], v[124:127], v[16:19]
    s_add_u32 s52, s60, 15360
    buffer_load_dwordx4 v[148:151], v1, s[4:7], s52 offen offset:0 sc1
    v_mfma_f32_16x16x32_bf16 v[20:23], v[52:55], v[128:131], v[20:23]
    buffer_load_dwordx4 v[152:155], v1, s[4:7], s52 offen offset:1024 sc1
    v_mfma_f32_16x16x32_bf16 v[24:27], v[56:59], v[124:127], v[24:27]
    s_waitcnt vmcnt(4)
    v_mfma_f32_16x16x32_bf16 v[28:31], v[56:59], v[128:131], v[28:31]
    v_swap_b32 v134, v136
    v_mfma_f32_16x16x32_bf16 v[32:35], v[60:63], v[124:127], v[32:35]
    v_swap_b32 v135, v137
    v_mfma_f32_16x16x32_bf16 v[36:39], v[60:63], v[128:131], v[36:39]
    s_waitcnt lgkmcnt(0)
    v_mfma_f32_16x16x32_bf16 v[8:11], v[64:67], v[132:135], v[8:11]
    ds_read_b128 v[48:51], v3 offset:6144
    ds_read_b128 v[52:55], v3 offset:26624
    v_mfma_f32_16x16x32_bf16 v[12:15], v[64:67], v[136:139], v[12:15]
    ds_read_b128 v[56:59], v3 offset:47104
    ds_read_b128 v[60:63], v2 offset:6144
    v_mfma_f32_16x16x32_bf16 v[16:19], v[68:71], v[132:135], v[16:19]
    s_add_u32 s52, s60, 17408
    buffer_load_dwordx4 v[156:159], v1, s[4:7], s52 offen offset:0 sc1
    v_mfma_f32_16x16x32_bf16 v[20:23], v[68:71], v[136:139], v[20:23]
    buffer_load_dwordx4 v[160:163], v1, s[4:7], s52 offen offset:1024 sc1
    v_mfma_f32_16x16x32_bf16 v[24:27], v[72:75], v[132:135], v[24:27]
    s_cmp_lg_u32 s36, 0
    s_cbranch_scc1 L_ow_74
    v_dot2_f32_bf16 v40, v212, v212, 0
    v_dot2_f32_bf16 v41, v213, v213, 0
    v_dot2_f32_bf16 v42, v214, v214, 0
    v_dot2_f32_bf16 v43, v215, v215, 0
    v_dot2_f32_bf16 v40, v216, v216, v40
    v_dot2_f32_bf16 v41, v217, v217, v41
    v_dot2_f32_bf16 v42, v218, v218, v42
    v_dot2_f32_bf16 v43, v219, v219, v43
    v_dot2_f32_bf16 v40, v220, v220, v40
    v_dot2_f32_bf16 v41, v221, v221, v41
    v_dot2_f32_bf16 v42, v222, v222, v42
    v_dot2_f32_bf16 v43, v223, v223, v43
    v_dot2_f32_bf16 v40, v224, v224, v40
    v_dot2_f32_bf16 v41, v225, v225, v41
    v_dot2_f32_bf16 v42, v226, v226, v42
    v_dot2_f32_bf16 v43, v227, v227, v43
    v_dot2_f32_bf16 v40, v228, v228, v40
    v_dot2_f32_bf16 v41, v229, v229, v41
    v_dot2_f32_bf16 v42, v230, v230, v42
    v_dot2_f32_bf16 v43, v231, v231, v43
L_ow_74:
    s_waitcnt vmcnt(4)
    v_mfma_f32_16x16x32_bf16 v[28:31], v[72:75], v[136:139], v[28:31]
    v_swap_b32 v142, v144
    v_mfma_f32_16x16x32_bf16 v[32:35], v[76:79], v[132:135], v[32:35]
    v_swap_b32 v143, v145
    v_mfma_f32_16x16x32_bf16 v[36:39], v[76:79], v[136:139], v[36:39]
    s_waitcnt lgkmcnt(0)
    v_cmp_u_f32 vcc, v8, v12
    s_and_b64 vcc, vcc, s[94:95]
    s_cbranch_scc1 L_qkv_early
    v_mfma_f32_16x16x32_bf16 v[8:11], v[48:51], v[140:143], v[8:11]
    ds_read_b128 v[64:67], v3 offset:7168
    ds_read_b128 v[68:71], v3 offset:27648
    v_mfma_f32_16x16x32_bf16 v[12:15], v[48:51], v[144:147], v[12:15]
    ds_read_b128 v[72:75], v3 offset:48128
    ds_read_b128 v[76:79], v2 offset:7168
    v_mfma_f32_16x16x32_bf16 v[16:19], v[52:55], v[140:143], v[16:19]
    s_add_u32 s52, s60, 14336
    buffer_load_dwordx4 v[164:167], v6, s[4:7], s52 offen offset:0 sc1
    v_mfma_f32_16x16x32_bf16 v[20:23], v[52:55], v[144:147], v[20:23]
    buffer_load_dwordx4 v[168:171], v6, s[4:7], s52 offen offset:256 sc1
    v_mfma_f32_16x16x32_bf16 v[24:27], v[56:59], v[140:143], v[24:27]
    s_cmp_lg_u32 s36, 0
    s_cbranch_scc1 L_ow_75
    v_and_b32 v249, v90, v249
    v_and_b32 v251, v90, v251
    v_dot2_f32_bf16 v40, v232, v232, v40
    v_dot2_f32_bf16 v41, v233, v233, v41
    v_dot2_f32_bf16 v42, v234, v234, v42
    v_dot2_f32_bf16 v43, v235, v235, v43
    v_dot2_f32_bf16 v40, v236, v236, v40
    v_dot2_f32_bf16 v41, v237, v237, v41
    v_dot2_f32_bf16 v42, v238, v238, v42
    v_dot2_f32_bf16 v43, v239, v239, v43
    v_dot2_f32_bf16 v40, v240, v240, v40
    v_dot2_f32_bf16 v41, v241, v241, v41
    v_dot2_f32_bf16 v42, v242, v242, v42
    v_dot2_f32_bf16 v43, v243, v243, v43
    v_dot2_f32_bf16 v40, v244, v244, v40
    v_dot2_f32_bf16 v41, v245, v245, v41
    v_dot2_f32_bf16 v42, v246, v246, v42
    v_dot2_f32_bf16 v43, v247, v247, v43
    v_dot2_f32_bf16 v40, v248, v248, v40
    v_dot2_f32_bf16 v41, v249, v249, v41
    v_dot2_f32_bf16 v42, v250, v250, v42
    v_dot2_f32_bf16 v43, v251, v251, v43
L_ow_75:
    s_waitcnt vmcnt(4)
    v_mfma_f32_16x16x32_bf16 v[28:31], v[56:59], v[144:147], v[28:31]
    v_swap_b32 v150, v152
    v_mfma_f32_16x16x32_bf16 v[32:35], v[60:63], v[140:143], v[32:35]
    v_swap_b32 v151, v153
    v_mfma_f32_16x16x32_bf16 v[36:39], v[60:63], v[144:147], v[36:39]
    s_waitcnt lgkmcnt(0)
    v_mfma_f32_16x16x32_bf16 v[8:11], v[64:67], v[148:151], v[8:11]
    ds_read_b128 v[48:51], v3 offset:8192
    ds_read_b128 v[52:55], v3 offset:28672
    v_mfma_f32_16x16x32_bf16 v[12:15], v[64:67], v[152:155], v[12:15]
    ds_read_b128 v[56:59], v3 offset:49152
    ds_read_b128 v[60:63], v2 offset:8192
    v_mfma_f32_16x16x32_bf16 v[16:19], v[68:71], v[148:151], v[16:19]
    s_add_u32 s52, s60, 20480
    buffer_load_dwordx4 v[172:175], v1, s[4:7], s52 offen offset:0 sc1
    v_mfma_f32_16x16x32_bf16 v[20:23], v[68:71], v[152:155], v[20:23]
    buffer_load_dwordx4 v[176:179], v1, s[4:7], s52 offen offset:1024 sc1
    v_mfma_f32_16x16x32_bf16 v[24:27], v[72:75], v[148:151], v[24:27]
    s_cmp_lg_u32 s36, 0
    s_cbranch_scc1 L_ow_76
    v_add_f32 v40, v40, v41
    v_add_f32 v41, v42, v43
    v_cmp_u_f32 vcc, v40, v41
    s_nop 0
    s_cbranch_vccnz L_stat_redo
L_stat_ok:
    v_add_f32_dpp v40, v40, v40 row_ror:4 row_mask:0xf bank_mask:0xf
    v_add_f32_dpp v41, v41, v41 row_ror:4 row_mask:0xf bank_mask:0xf
    s_nop 0
    v_add_f32_dpp v40, v40, v40 row_ror:8 row_mask:0xf bank_mask:0xf
    v_add_f32_dpp v41, v41, v41 row_ror:8 row_mask:0xf bank_mask:0xf
    v_mov_b64 v[42:43], v[40:41]
    s_nop 1
    v_permlane16_swap_b32 v40, v42
    v_permlane16_swap_b32 v41, v43
    v_add_f32 v40, v40, v42
    v_add_f32 v41, v41, v43
    v_mov_b64 v[42:43], v[40:41]
    s_nop 1
    v_permlane32_swap_b32 v40, v42
    v_permlane32_swap_b32 v41, v43
    v_add_f32 v40, v40, v42
    v_add_f32 v41, v41, v43
    v_fmamk_f32 v40, v40, 0x3acccccd, v91
    v_fmamk_f32 v41, v41, 0x3acccccd, v91
    v_rsq_f32 v40, v40
    v_rsq_f32 v41, v41
    v_or_b32 v40, 1, v40
    v_or_b32 v41, 1, v41
    s_mov_b64 exec, 15
    buffer_store_dwordx2 v[40:41], v87, s[4:7], s63 offen sc1
    s_mov_b64 exec, -1
L_ow_76:
    s_waitcnt vmcnt(4)
    v_mfma_f32_16x16x32_bf16 v[28:31], v[72:75], v[152:155], v[28:31]
    v_swap_b32 v158, v160
    v_mfma_f32_16x16x32_bf16 v[32:35], v[76:79], v[148:151], v[32:35]
    v_swap_b32 v159, v161
    v_mfma_f32_16x16x32_bf16 v[36:39], v[76:79], v[152:155], v[36:39]
    s_waitcnt lgkmcnt(0)
    v_mfma_f32_16x16x32_bf16 v[8:11], v[48:51], v[156:159], v[8:11]
    ds_read_b128 v[64:67], v3 offset:9216
    ds_read_b128 v[68:71], v3 offset:29696
    v_mfma_f32_16x16x32_bf16 v[12:15], v[48:51], v[160:163], v[12:15]
    ds_read_b128 v[72:75], v3 offset:50176
    ds_read_b128 v[76:79], v2 offset:9216
    v_mfma_f32_16x16x32_bf16 v[16:19], v[52:55], v[156:159], v[16:19]
    s_add_u32 s52, s60, 22528
    buffer_load_dwordx4 v[180:183], v1, s[4:7], s52 offen offset:0 sc1
    v_mfma_f32_16x16x32_bf16 v[20:23], v[52:55], v[160:163], v[20:23]
    buffer_load_dwordx4 v[184:187], v1, s[4:7], s52 offen offset:1024 sc1
    v_mfma_f32_16x16x32_bf16 v[24:27], v[56:59], v[156:159], v[24:27]
    s_waitcnt vmcnt(4)
    v_mfma_f32_16x16x32_bf16 v[28:31], v[56:59], v[160:163], v[28:31]
    v_swap_b32 v166, v168
    v_mfma_f32_16x16x32_bf16 v[32:35], v[60:63], v[156:159], v[32:35]
    v_swap_b32 v167, v169
    v_mfma_f32_16x16x32_bf16 v[36:39], v[60:63], v[160:163], v[36:39]
    s_waitcnt lgkmcnt(0)
    v_mfma_f32_16x16x32_bf16 v[8:11], v[64:67], v[164:167], v[8:11]
    ds_read_b128 v[48:51], v3 offset:10240
    ds_read_b128 v[52:55], v3 offset:30720
    v_mfma_f32_16x16x32_bf16 v[12:15], v[64:67], v[168:171], v[12:15]
    ds_read_b128 v[56:59], v3 offset:51200
    ds_read_b128 v[60:63], v2 offset:10240
    v_mfma_f32_16x16x32_bf16 v[16:19], v[68:71], v[164:167], v[16:19]
    s_add_u32 s52, s60, 25600
    buffer_load_dwordx4 v[188:191], v1, s[4:7], s52 offen offset:0 sc1
    v_mfma_f32_16x16x32_bf16 v[20:23], v[68:71], v[168:171], v[20:23]
    buffer_load_dwordx4 v[192:195], v1, s[4:7], s52 offen offset:1024 sc1
    v_mfma_f32_16x16x32_bf16 v[24:27], v[72:75], v[164:167], v[24:27]
    s_waitcnt vmcnt(4)
    v_mfma_f32_16x16x32_bf16 v[28:31], v[72:75], v[168:171], v[28:31]
    v_swap_b32 v174, v176
    v_mfma_f32_16x16x32_bf16 v[32:35], v[76:79], v[164:167], v[32:35]
    v_swap_b32 v175, v177
    v_mfma_f32_16x16x32_bf16 v[36:39], v[76:79], v[168:171], v[36:39]
    s_waitcnt lgkmcnt(0)
    v_mfma_f32_16x16x32_bf16 v[8:11], v[48:51], v[172:175], v[8:11]
    ds_read_b128 v[64:67], v3 offset:11264
    ds_read_b128 v[68:71], v3 offset:31744
    v_mfma_f32_16x16x32_bf16 v[12:15], v[48:51], v[176:179], v[12:15]
    ds_read_b128 v[72:75], v3 offset:52224
    ds_read_b128 v[76:79], v2 offset:11264
    v_mfma_f32_16x16x32_bf16 v[16:19], v[52:55], v[172:175], v[16:19]
    s_add_u32 s52, s60, 27648
    buffer_load_dwordx4 v[196:199], v1, s[4:7], s52 offen offset:0 sc1
    v_mfma_f32_16x16x32_bf16 v[20:23], v[52:55], v[176:179], v[20:23]
    buffer_load_dwordx4 v[200:203], v1, s[4:7], s52 offen offset:1024 sc1
    v_mfma_f32_16x16x32_bf16 v[24:27], v[56:59], v[172:175], v[24:27]
    s_waitcnt vmcnt(4)
    v_mfma_f32_16x16x32_bf16 v[28:31], v[56:59], v[176:179], v[28:31]
    v_swap_b32 v182, v184
    v_mfma_f32_16x16x32_bf16 v[32:35], v[60:63], v[172:175], v[32:35]
    v_swap_b32 v183, v185
    v_mfma_f32_16x16x32_bf16 v[36:39], v[60:63], v[176:179], v[36:39]
    s_waitcnt lgkmcnt(0)
    v_mfma_f32_16x16x32_bf16 v[8:11], v[64:67], v[180:183], v[8:11]
    ds_read_b128 v[48:51], v3 offset:12288
    ds_read_b128 v[52:55], v3 offset:32768
    v_mfma_f32_16x16x32_bf16 v[12:15], v[64:67], v[184:187], v[12:15]
    ds_read_b128 v[56:59], v3 offset:53248
    ds_read_b128 v[60:63], v2 offset:12288
    v_mfma_f32_16x16x32_bf16 v[16:19], v[68:71], v[180:183], v[16:19]
    s_add_u32 s52, s60, 24576
    buffer_load_dwordx4 v[204:207], v6, s[4:7], s52 offen offset:0 sc1
    v_mfma_f32_16x16x32_bf16 v[20:23], v[68:71], v[184:187], v[20:23]
    buffer_load_dwordx4 v[208:211], v6, s[4:7], s52 offen offset:256 sc1
    v_mfma_f32_16x16x32_bf16 v[24:27], v[72:75], v[180:183], v[24:27]
    s_waitcnt vmcnt(4)
    v_mfma_f32_16x16x32_bf16 v[28:31], v[72:75], v[184:187], v[28:31]
    v_swap_b32 v190, v192
    v_mfma_f32_16x16x32_bf16 v[32:35], v[76:79], v[180:183], v[32:35]
    v_swap_b32 v191, v193
    v_mfma_f32_16x16x32_bf16 v[36:39], v[76:79], v[184:187], v[36:39]
    s_waitcnt lgkmcnt(0)
    v_mfma_f32_16x16x32_bf16 v[8:11], v[48:51], v[188:191], v[8:11]
    ds_read_b128 v[64:67], v3 offset:13312
    ds_read_b128 v[68:71], v3 offset:33792
    v_mfma_f32_16x16x32_bf16 v[12:15], v[48:51], v[192:195], v[12:15]
    ds_read_b128 v[72:75], v3 offset:54272
    ds_read_b128 v[76:79], v2 offset:13312
    v_mfma_f32_16x16x32_bf16 v[16:19], v[52:55], v[188:191], v[16:19]
    s_add_u32 s52, s60, 30720
    buffer_load_dwordx4 v[212:215], v1, s[4:7], s52 offen offset:0 sc1
    v_mfma_f32_16x16x32_bf16 v[20:23], v[52:55], v[192:195], v[20:23]
    buffer_load_dwordx4 v[216:219], v1, s[4:7], s52 offen offset:1024 sc1
    v_mfma_f32_16x16x32_bf16 v[24:27], v[56:59], v[188:191], v[24:27]
    s_waitcnt vmcnt(4)
    v_mfma_f32_16x16x32_bf16 v[28:31], v[56:59], v[192:195], v[28:31]
    v_swap_b32 v198, v200
    v_mfma_f32_16x16x32_bf16 v[32:35], v[60:63], v[188:191], v[32:35]
    v_swap_b32 v199, v201
    v_mfma_f32_16x16x32_bf16 v[36:39], v[60:63], v[192:195], v[36:39]
    s_waitcnt lgkmcnt(0)
    v_mfma_f32_16x16x32_bf16 v[8:11], v[64:67], v[196:199], v[8:11]
    ds_read_b128 v[48:51], v3 offset:14336
    ds_read_b128 v[52:55], v3 offset:34816
    v_mfma_f32_16x16x32_bf16 v[12:15], v[64:67], v[200:203], v[12:15]
    ds_read_b128 v[56:59], v3 offset:55296
    ds_read_b128 v[60:63], v2 offset:14336
    v_mfma_f32_16x16x32_bf16 v[16:19], v[68:71], v[196:199], v[16:19]
    s_add_u32 s52, s60, 32768
    buffer_load_dwordx4 v[220:223], v1, s[4:7], s52 offen offset:0 sc1
    v_mfma_f32_16x16x32_bf16 v[20:23], v[68:71], v[200:203], v[20:23]
    buffer_load_dwordx4 v[224:227], v1, s[4:7], s52 offen offset:1024 sc1
    v_mfma_f32_16x16x32_bf16 v[24:27], v[72:75], v[196:199], v[24:27]
    s_waitcnt vmcnt(4)
    v_mfma_f32_16x16x32_bf16 v[28:31], v[72:75], v[200:203], v[28:31]
    v_swap_b32 v206, v208
    v_mfma_f32_16x16x32_bf16 v[32:35], v[76:79], v[196:199], v[32:35]
    v_swap_b32 v207, v209
    v_mfma_f32_16x16x32_bf16 v[36:39], v[76:79], v[200:203], v[36:39]
    s_waitcnt lgkmcnt(0)
    v_mfma_f32_16x16x32_bf16 v[8:11], v[48:51], v[204:207], v[8:11]
    ds_read_b128 v[64:67], v3 offset:15360
    ds_read_b128 v[68:71], v3 offset:35840
    v_mfma_f32_16x16x32_bf16 v[12:15], v[48:51], v[208:211], v[12:15]
    ds_read_b128 v[72:75], v3 offset:56320
    ds_read_b128 v[76:79], v2 offset:15360
    v_mfma_f32_16x16x32_bf16 v[16:19], v[52:55], v[204:207], v[16:19]
    s_add_u32 s52, s60, 35840
    buffer_load_dwordx4 v[228:231], v1, s[4:7], s52 offen offset:0 sc1
    v_mfma_f32_16x16x32_bf16 v[20:23], v[52:55], v[208:211], v[20:23]
    buffer_load_dwordx4 v[232:235], v1, s[4:7], s52 offen offset:1024 sc1
    v_mfma_f32_16x16x32_bf16 v[24:27], v[56:59], v[204:207], v[24:27]
    s_waitcnt vmcnt(4)
    v_mfma_f32_16x16x32_bf16 v[28:31], v[56:59], v[208:211], v[28:31]
    v_swap_b32 v214, v216
    v_mfma_f32_16x16x32_bf16 v[32:35], v[60:63], v[204:207], v[32:35]
    v_swap_b32 v215, v217
    v_mfma_f32_16x16x32_bf16 v[36:39], v[60:63], v[208:211], v[36:39]
    s_waitcnt lgkmcnt(0)
    v_mfma_f32_16x16x32_bf16 v[8:11], v[64:67], v[212:215], v[8:11]
    ds_read_b128 v[48:51], v3 offset:16384
    ds_read_b128 v[52:55], v3 offset:36864
    v_mfma_f32_16x16x32_bf16 v[12:15], v[64:67], v[216:219], v[12:15]
    ds_read_b128 v[56:59], v3 offset:57344
    ds_read_b128 v[60:63], v2 offset:16384
    v_mfma_f32_16x16x32_bf16 v[16:19], v[68:71], v[212:215], v[16:19]
    s_add_u32 s52, s60, 37888
    buffer_load_dwordx4 v[236:239], v1, s[4:7], s52 offen offset:0 sc1
    v_mfma_f32_16x16x32_bf16 v[20:23], v[68:71], v[216:219], v[20:23]
    buffer_load_dwordx4 v[240:243], v1, s[4:7], s52 offen offset:1024 sc1
    buffer_load_dwordx2 v[88:89], v87, s[4:7], s64 offen sc1
    v_mfma_f32_16x16x32_bf16 v[24:27], v[72:75], v[212:215], v[24:27]
    s_waitcnt vmcnt(5)
    v_mfma_f32_16x16x32_bf16 v[28:31], v[72:75], v[216:219], v[28:31]
    v_swap_b32 v222, v224
    v_mfma_f32_16x16x32_bf16 v[32:35], v[76:79], v[212:215], v[32:35]
    v_swap_b32 v223, v225
    v_mfma_f32_16x16x32_bf16 v[36:39], v[76:79], v[216:219], v[36:39]
    s_waitcnt lgkmcnt(0)
    v_mfma_f32_16x16x32_bf16 v[8:11], v[48:51], v[220:223], v[8:11]
    ds_read_b128 v[64:67], v3 offset:17408
    ds_read_b128 v[68:71], v3 offset:37888
    v_mfma_f32_16x16x32_bf16 v[12:15], v[48:51], v[224:227], v[12:15]
    ds_read_b128 v[72:75], v3 offset:58368
    ds_read_b128 v[76:79], v2 offset:17408
    v_mfma_f32_16x16x32_bf16 v[16:19], v[52:55], v[220:223], v[16:19]
    s_add_u32 s52, s60, 34816
    buffer_load_dwordx4 v[244:247], v6, s[4:7], s52 offen offset:0 sc1
    v_mfma_f32_16x16x32_bf16 v[20:23], v[52:55], v[224:227], v[20:23]
    buffer_load_dwordx4 v[248:251], v6, s[4:7], s52 offen offset:256 sc1
    v_mfma_f32_16x16x32_bf16 v[24:27], v[56:59], v[220:223], v[24:27]
    s_waitcnt vmcnt(5)
    v_mfma_f32_16x16x32_bf16 v[28:31], v[56:59], v[224:227], v[28:31]
    v_swap_b32 v230, v232
    v_mfma_f32_16x16x32_bf16 v[32:35], v[60:63], v[220:223], v[32:35]
    v_swap_b32 v231, v233
    v_mfma_f32_16x16x32_bf16 v[36:39], v[60:63], v[224:227], v[36:39]
    s_waitcnt lgkmcnt(0)
    v_mfma_f32_16x16x32_bf16 v[8:11], v[64:67], v[228:231], v[8:11]
    ds_read_b128 v[48:51], v3 offset:18432
    ds_read_b128 v[52:55], v3 offset:38912
    v_mfma_f32_16x16x32_bf16 v[12:15], v[64:67], v[232:235], v[12:15]
    ds_read_b128 v[56:59], v3 offset:59392
    ds_read_b128 v[60:63], v2 offset:18432
    v_mfma_f32_16x16x32_bf16 v[16:19], v[68:71], v[228:231], v[16:19]
    v_mfma_f32_16x16x32_bf16 v[20:23], v[68:71], v[232:235], v[20:23]
    v_mfma_f32_16x16x32_bf16 v[24:27], v[72:75], v[228:231], v[24:27]
    s_waitcnt vmcnt(3)
    v_mfma_f32_16x16x32_bf16 v[28:31], v[72:75], v[232:235], v[28:31]
    v_swap_b32 v238, v240
    v_mfma_f32_16x16x32_bf16 v[32:35], v[76:79], v[228:231], v[32:35]
    v_swap_b32 v239, v241
    v_mfma_f32_16x16x32_bf16 v[36:39], v[76:79], v[232:235], v[36:39]
    s_waitcnt lgkmcnt(0)
    v_mfma_f32_16x16x32_bf16 v[8:11], v[48:51], v[236:239], v[8:11]
    ds_read_b128 v[64:67], v3 offset:19456
    ds_read_b128 v[68:71], v3 offset:39936
    v_mfma_f32_16x16x32_bf16 v[12:15], v[48:51], v[240:243], v[12:15]
    ds_read_b128 v[72:75], v3 offset:60416
    ds_read_b128 v[76:79], v2 offset:19456
    v_mfma_f32_16x16x32_bf16 v[16:19], v[52:55], v[236:239], v[16:19]
    v_mfma_f32_16x16x32_bf16 v[20:23], v[52:55], v[240:243], v[20:23]
    v_mfma_f32_16x16x32_bf16 v[24:27], v[56:59], v[236:239], v[24:27]
    s_waitcnt vmcnt(0)
    v_mfma_f32_16x16x32_bf16 v[28:31], v[56:59], v[240:243], v[28:31]
    v_swap_b32 v246, v248
    v_mfma_f32_16x16x32_bf16 v[32:35], v[60:63], v[236:239], v[32:35]
    v_swap_b32 v247, v249
    v_mfma_f32_16x16x32_bf16 v[36:39], v[60:63], v[240:243], v[36:39]
    s_waitcnt lgkmcnt(0)
    v_mfma_f32_16x16x32_bf16 v[8:11], v[64:67], v[244:247], v[8:11]
    v_mfma_f32_16x16x32_bf16 v[12:15], v[64:67], v[248:251], v[12:15]
    v_mfma_f32_16x16x32_bf16 v[16:19], v[68:71], v[244:247], v[16:19]
    v_mfma_f32_16x16x32_bf16 v[20:23], v[68:71], v[248:251], v[20:23]
    v_mfma_f32_16x16x32_bf16 v[24:27], v[72:75], v[244:247], v[24:27]
    v_mfma_f32_16x16x32_bf16 v[28:31], v[72:75], v[248:251], v[28:31]
    v_mfma_f32_16x16x32_bf16 v[32:35], v[76:79], v[244:247], v[32:35]
    v_mfma_f32_16x16x32_bf16 v[36:39], v[76:79], v[248:251], v[36:39]
    s_nop 1
    v_cmp_u_f32 vcc, v8, v12
    s_nop 0
    s_cbranch_vccnz L_qkv_redo
L_qkv_ok:
    s_cmp_lg_u32 s36, 3
    s_cbranch_scc1 L_ow_77
    s_cmp_eq_u32 s42, 0
    s_cselect_b32 s53, 3, 4
    s_lshl_b32 s54, s37, 12
    s_lshl_b32 s55, s53, 2
    s_add_u32 s54, s54, s55
    v_lshlrev_b32 v5, 7, v0
    s_mov_b32 exec_lo, 0xffff
    s_mov_b32 exec_hi, 0
    s_mov_b32 s52, s44
L_poll_78:
    buffer_load_dword v4, v5, s[4:7], s54 offen sc1
    s_add_u32 s52, s52, 1
    s_cmp_ge_u32 s52, 65536
    s_cselect_b32 s44, 65536, s44
    s_waitcnt vmcnt(0)
    s_cbranch_scc1 L_pd_79
    v_cmp_gt_u32 vcc, 1, v4
    s_nop 0
    s_cbranch_vccnz L_poll_78
L_pd_79:
    s_mov_b64 exec, -1
L_ow_77:
    s_mov_b32 s52, 0
    s_branch L_rs_81
L_rs_80:
    buffer_load_dwordx2 v[88:89], v87, s[4:7], s64 offen sc1
L_rs_81:
    s_add_u32 s52, s52, 1
    s_waitcnt vmcnt(0)
    v_min_u32 v4, v88, v89
    v_cmp_eq_u32 vcc, 0, v4
    s_cmp_ge_u32 s52, 65536
    s_cselect_b64 vcc, 0, vcc
    s_cbranch_vccnz L_rs_80
    v_mul_f32 v8, v88, v8
    v_mul_f32 v9, v88, v9
    v_mul_f32 v10, v88, v10
    v_mul_f32 v11, v88, v11
    v_cvt_pk_bf16_f32 v8, v8, v9
    v_cvt_pk_bf16_f32 v9, v10, v11
    ds_write_b64 v80, v[8:9] offset:0
    v_mul_f32 v16, v88, v16
    v_mul_f32 v17, v88, v17
    v_mul_f32 v18, v88, v18
    v_mul_f32 v19, v88, v19
    v_cvt_pk_bf16_f32 v16, v16, v17
    v_cvt_pk_bf16_f32 v17, v18, v19
    ds_write_b64 v81, v[16:17] offset:0
    v_mul_f32 v24, v88, v24
    v_mul_f32 v25, v88, v25
    v_mul_f32 v26, v88, v26
    v_mul_f32 v27, v88, v27
    v_cvt_pk_bf16_f32 v24, v24, v25
    v_cvt_pk_bf16_f32 v25, v26, v27
    ds_write_b64 v83, v[24:25] offset:0
    v_mul_f32 v12, v89, v12
    v_mul_f32 v13, v89, v13
    v_mul_f32 v14, v89, v14
    v_mul_f32 v15, v89, v15
    v_cvt_pk_bf16_f32 v12, v12, v13
    v_cvt_pk_bf16_f32 v13, v14, v15
    ds_write_b64 v80, v[12:13] offset:256
    v_mul_f32 v20, v89, v20
    v_mul_f32 v21, v89, v21
    v_mul_f32 v22, v89, v22
    v_mul_f32 v23, v89, v23
    v_cvt_pk_bf16_f32 v20, v20, v21
    v_cvt_pk_bf16_f32 v21, v22, v23
    ds_write_b64 v82, v[20:21] offset:0
    v_mul_f32 v28, v89, v28
    v_mul_f32 v29, v89, v29
    v_mul_f32 v30, v89, v30
    v_mul_f32 v31, v89, v31
    v_cvt_pk_bf16_f32 v28, v28, v29
    v_cvt_pk_bf16_f32 v29, v30, v31
    ds_write_b64 v84, v[28:29] offset:0
    ds_read_b128 v[40:43], v253 offset:0
    ds_read_b128 v[44:47], v253 offset:1024
    ds_read_b128 v[48:51], v253 offset:2048
    v_mul_f32 v8, v88, v32
    v_mul_f32 v9, v88, v33
    v_mul_f32 v10, v88, v34
    v_mul_f32 v11, v88, v35
    v_cvt_pk_bf16_f32 v8, v8, v9
    v_cvt_pk_bf16_f32 v9, v10, v11
    ds_write_b64 v85, v[8:9] offset:0
    v_mul_f32 v12, v89, v36
    v_mul_f32 v13, v89, v37
    v_mul_f32 v14, v89, v38
    v_mul_f32 v15, v89, v39
    v_cvt_pk_bf16_f32 v12, v12, v13
    v_cvt_pk_bf16_f32 v13, v14, v15
    ds_write_b64 v86, v[12:13] offset:0
    s_waitcnt lgkmcnt(4)
    buffer_store_dwordx4 v[40:43], v1, s[4:7], s61 offen offset:0 sc1
    s_waitcnt lgkmcnt(3)
    buffer_store_dwordx4 v[44:47], v1, s[4:7], s61 offen offset:1024 sc1
    s_mov_b32 exec_hi, 0xffff
    s_waitcnt lgkmcnt(2)
    buffer_store_dwordx4 v[48:51], v1, s[4:7], s61 offen offset:2048 sc1
    s_mov_b64 exec, -1
    s_setprio 0
    s_cmp_eq_u32 s42, 0
    s_cbranch_scc1 L_qe_82
    ds_read_b128 v[56:59], v2 offset:20480
    ds_read_b128 v[60:63], v2 offset:21504
    ds_read_b128 v[64:67], v2 offset:22528
    ds_read_b128 v[68:71], v2 offset:23552
    s_waitcnt lgkmcnt(3)
    v_mfma_f32_16x16x32_bf16 v[16:19], v[56:59], v[92:95], 0
    ds_read_b128 v[72:75], v2 offset:24576
    v_mfma_f32_16x16x32_bf16 v[20:23], v[56:59], v[96:99], 0
    s_waitcnt lgkmcnt(3)
    v_mfma_f32_16x16x32_bf16 v[16:19], v[60:63], v[100:103], v[16:19]
    ds_read_b128 v[56:59], v2 offset:25600
    v_mfma_f32_16x16x32_bf16 v[20:23], v[60:63], v[104:107], v[20:23]
    s_waitcnt lgkmcnt(3)
    v_mfma_f32_16x16x32_bf16 v[16:19], v[64:67], v[108:111], v[16:19]
    ds_read_b128 v[60:63], v2 offset:26624
    v_mfma_f32_16x16x32_bf16 v[20:23], v[64:67], v[112:115], v[20:23]
    s_waitcnt lgkmcnt(3)
    v_mfma_f32_16x16x32_bf16 v[16:19], v[68:71], v[116:119], v[16:19]
    ds_read_b128 v[64:67], v2 offset:27648
    v_mfma_f32_16x16x32_bf16 v[20:23], v[68:71], v[120:123], v[20:23]
    s_waitcnt lgkmcnt(3)
    v_mfma_f32_16x16x32_bf16 v[16:19], v[72:75], v[124:127], v[16:19]
    ds_read_b128 v[68:71], v2 offset:28672
    v_mfma_f32_16x16x32_bf16 v[20:23], v[72:75], v[128:131], v[20:23]
    s_waitcnt lgkmcnt(3)
    v_mfma_f32_16x16x32_bf16 v[16:19], v[56:59], v[132:135], v[16:19]
    ds_read_b128 v[72:75], v2 offset:29696
    v_mfma_f32_16x16x32_bf16 v[20:23], v[56:59], v[136:139], v[20:23]
    s_waitcnt lgkmcnt(3)
    v_mfma_f32_16x16x32_bf16 v[16:19], v[60:63], v[140:143], v[16:19]
    ds_read_b128 v[56:59], v2 offset:30720
    v_mfma_f32_16x16x32_bf16 v[20:23], v[60:63], v[144:147], v[20:23]
    s_waitcnt lgkmcnt(3)
    v_mfma_f32_16x16x32_bf16 v[16:19], v[64:67], v[148:151], v[16:19]
    ds_read_b128 v[60:63], v2 offset:31744
    v_mfma_f32_16x16x32_bf16 v[20:23], v[64:67], v[152:155], v[20:23]
    s_waitcnt lgkmcnt(3)
    v_mfma_f32_16x16x32_bf16 v[16:19], v[68:71], v[156:159], v[16:19]
    ds_read_b128 v[64:67], v2 offset:32768
    v_mfma_f32_16x16x32_bf16 v[20:23], v[68:71], v[160:163], v[20:23]
    s_waitcnt lgkmcnt(3)
    v_mfma_f32_16x16x32_bf16 v[16:19], v[72:75], v[164:167], v[16:19]
    ds_read_b128 v[68:71], v2 offset:33792
    v_mfma_f32_16x16x32_bf16 v[20:23], v[72:75], v[168:171], v[20:23]
    s_waitcnt lgkmcnt(3)
    v_mfma_f32_16x16x32_bf16 v[16:19], v[56:59], v[172:175], v[16:19]
    ds_read_b128 v[72:75], v2 offset:34816
    v_mfma_f32_16x16x32_bf16 v[20:23], v[56:59], v[176:179], v[20:23]
    s_waitcnt lgkmcnt(3)
    v_mfma_f32_16x16x32_bf16 v[16:19], v[60:63], v[180:183], v[16:19]
    ds_read_b128 v[56:59], v2 offset:35840
    v_mfma_f32_16x16x32_bf16 v[20:23], v[60:63], v[184:187], v[20:23]
    s_waitcnt lgkmcnt(3)
    v_mfma_f32_16x16x32_bf16 v[16:19], v[64:67], v[188:191], v[16:19]
    ds_read_b128 v[60:63], v2 offset:36864
    v_mfma_f32_16x16x32_bf16 v[20:23], v[64:67], v[192:195], v[20:23]
    s_waitcnt lgkmcnt(3)
    v_mfma_f32_16x16x32_bf16 v[16:19], v[68:71], v[196:199], v[16:19]
    ds_read_b128 v[64:67], v2 offset:37888
    v_mfma_f32_16x16x32_bf16 v[20:23], v[68:71], v[200:203], v[20:23]
    s_waitcnt lgkmcnt(3)
    v_mfma_f32_16x16x32_bf16 v[16:19], v[72:75], v[204:207], v[16:19]
    ds_read_b128 v[68:71], v2 offset:38912
    v_mfma_f32_16x16x32_bf16 v[20:23], v[72:75], v[208:211], v[20:23]
    s_waitcnt lgkmcnt(3)
    v_mfma_f32_16x16x32_bf16 v[16:19], v[56:59], v[212:215], v[16:19]
    ds_read_b128 v[72:75], v2 offset:39936
    v_mfma_f32_16x16x32_bf16 v[20:23], v[56:59], v[216:219], v[20:23]
    s_waitcnt lgkmcnt(3)
    v_mfma_f32_16x16x32_bf16 v[16:19], v[60:63], v[220:223], v[16:19]
    v_mfma_f32_16x16x32_bf16 v[20:23], v[60:63], v[224:227], v[20:23]
    s_waitcnt lgkmcnt(2)
    v_mfma_f32_16x16x32_bf16 v[16:19], v[64:67], v[228:231], v[16:19]
    v_mfma_f32_16x16x32_bf16 v[20:23], v[64:67], v[232:235], v[20:23]
    s_waitcnt lgkmcnt(1)
    v_mfma_f32_16x16x32_bf16 v[16:19], v[68:71], v[236:239], v[16:19]
    v_mfma_f32_16x16x32_bf16 v[20:23], v[68:71], v[240:243], v[20:23]
    s_waitcnt lgkmcnt(0)
    v_mfma_f32_16x16x32_bf16 v[16:19], v[72:75], v[244:247], v[16:19]
    v_mfma_f32_16x16x32_bf16 v[20:23], v[72:75], v[248:251], v[20:23]
    v_mov_b64 v[152:153], v[32:33]
    v_mov_b64 v[154:155], v[34:35]
    v_mov_b64 v[156:157], v[36:37]
    v_mov_b64 v[158:159], v[38:39]
    s_nop 2
    v_mov_b64 v[160:161], v[16:17]
    v_mov_b64 v[162:163], v[18:19]
    v_mov_b64 v[164:165], v[20:21]
    v_mov_b64 v[166:167], v[22:23]
L_qe_82:
    ds_read_b128 v[144:147], v254
    ds_read_b128 v[148:151], v254 offset:1024
L_aq_83:
    s_lshr_b32 s53, s36, 2
    s_lshl_b32 s54, s98, 1
    s_add_u32 s64, s54, s53
    s_lshl_b32 s54, s64, 10
    s_add_u32 s54, s54, 147456
    v_add_u32 v6, s54, v1
    v_xor_b32 v7, 1024, v6
    s_cmp_eq_u32 s42, 0
    s_cbranch_scc1 L_py_84
    s_waitcnt vmcnt(0)
L_py_84:
    s_waitcnt lgkmcnt(0)
    s_barrier
    s_lshl_b32 s52, s42, 3
    s_add_u32 s52, s52, s36
    s_cmp_lg_u32 s52, 15
    s_cbranch_scc1 L_pz_85
    s_lshl_b32 s53, s38, 3
    s_add_u32 s53, s53, s90
    s_lshl_b32 s53, s53, 5
    s_add_u32 s53, s53, s42
    s_lshl_b32 s53, s53, 2
    s_add_u32 s53, s53, 188416
    s_atomic_add s75, s[4:5], s53
L_pz_85:
    ds_read_b64 v[112:113], v147
    ds_read_b64 v[124:125], v145 offset:0
    ds_read_b128 v[116:119], v144 offset:0
    ds_read_b128 v[104:107], v6
    ds_read_b128 v[108:111], v7
    ds_read_b64_tr_b16 v[128:129], v146 offset:0
    ds_read_b64_tr_b16 v[130:131], v146 offset:192
    ds_read_b64_tr_b16 v[132:133], v146 offset:768
    ds_read_b64_tr_b16 v[134:135], v146 offset:960
    ds_read_b64 v[126:127], v145 offset:2816
    ds_read_b128 v[120:123], v144 offset:2816
    s_mul_i32 s62, s36, 2816
    s_mul_i32 s61, s38, 180224
    s_add_u32 s61, s61, s62
    s_add_u32 s61, s61, s49
    s_add_u32 s68, s62, 102400
    s_lshl_b32 s65, s42, 3
    s_add_u32 s65, s65, s39
    s_mul_i32 s65, s65, 102400
    s_mul_i32 s66, s36, 12800
    s_add_u32 s65, s65, s66
    s_add_u32 s65, s65, 16678912
    s_lshl_b32 s52, s90, 3
    s_add_u32 s52, s52, s64
    s_mul_i32 s52, s52, 40960
    s_add_u32 s52, s52, s50
    s_lshl_b32 s53, s38, 9
    s_add_u32 s70, s52, s53
    s_lshl_b32 s53, s38, 7
    s_add_u32 s71, s52, s53
    s_add_u32 s71, s71, 16384
    s_mov_b32 s91, 0
    s_waitcnt lgkmcnt(9)
    v_mfma_f32_32x32x4_2b_bf16 v[8:39], v[124:125], v[112:113], 0
    v_mov_b64 v[72:73], 0
    v_mov_b64 v[74:75], 0
    v_mov_b64 v[76:77], 0
    v_mov_b64 v[78:79], 0
    v_mov_b64 v[80:81], 0
    v_mov_b64 v[82:83], 0
    v_mov_b64 v[84:85], 0
    v_mov_b64 v[86:87], 0
    v_mov_b64 v[88:89], 0
    v_mov_b64 v[90:91], 0
    v_mov_b64 v[92:93], 0
    v_mov_b64 v[94:95], 0
    v_mov_b64 v[96:97], 0
    v_mov_b64 v[98:99], 0
    v_mov_b64 v[100:101], 0
    v_mov_b64 v[102:103], 0
    v_mov_b32 v114, 0xdddddddd
    s_waitcnt lgkmcnt(6)
    v_mfma_f32_32x32x16_bf16 v[8:23], v[116:119], v[104:107], v[8:23]
    v_mfma_f32_32x32x16_bf16 v[24:39], v[116:119], v[108:111], v[24:39]
    v_cmp_le_u32 vcc, 48, v0
    v_mov_b32 v7, 0x40000000
    s_cmp_lg_u32 s42, 0
    v_cndmask_b32 v7, v7, v1, vcc
    v_mov_b32 v6, v1
    s_cbranch_scc1 L_sg_86
    v_mov_b32 v6, v150
    v_mov_b32 v7, v151
    s_mov_b32 s82, 0x7f817f81
    s_mov_b32 s83, s82
    v_mov_b64 v[152:153], s[82:83]
    v_mov_b64 v[154:155], s[82:83]
    v_mov_b64 v[156:157], s[82:83]
    v_mov_b64 v[158:159], s[82:83]
    v_mov_b64 v[160:161], s[82:83]
    v_mov_b64 v[162:163], s[82:83]
    v_mov_b64 v[164:165], s[82:83]
    v_mov_b64 v[166:167], s[82:83]
    s_lshl_b32 s52, s36, 10
    v_add_u32 v2, s52, v1
    ds_read_b128 v[200:203], v2 offset:0
    ds_read_b128 v[204:207], v2 offset:8192
    ds_read_b128 v[208:211], v2 offset:16384
    ds_read_b128 v[212:215], v2 offset:24576
    ds_read_b128 v[216:219], v2 offset:32768
    ds_read_b128 v[220:223], v2 offset:40960
    ds_read_b128 v[224:227], v2 offset:49152
    ds_read_b128 v[228:231], v2 offset:57344
    s_waitcnt vmcnt(0)
    v_mov_b32 v2, 157760
    v_mov_b32 v3, 1
    s_mov_b64 exec, 1
    ds_add_rtn_u32 v3, v2, v3 offset:0
    s_waitcnt lgkmcnt(0)
    v_readfirstlane_b32 s52, v3
    s_mov_b64 exec, -1
    s_cmp_lg_u32 s52, 7
    s_cbranch_scc1 L_sg_87
    s_lshl_b32 s53, s38, 3
    s_add_u32 s53, s53, s90
    s_lshl_b32 s53, s53, 5
    s_add_u32 s53, s53, s42
    s_lshl_b32 s53, s53, 2
    s_add_u32 s53, s53, 188416
    s_atomic_add s75, s[4:5], s53
L_sg_87:
L_sg_86:
    s_nop 4
    v_exp_f32 v8, v8
    v_exp_f32 v9, v9
    ds_read_b64_tr_b16 v[136:137], v146 offset:2816
    ds_read_b64_tr_b16 v[138:139], v146 offset:3008
    ds_read_b64_tr_b16 v[140:141], v146 offset:3584
    ds_read_b64_tr_b16 v[142:143], v146 offset:3776
    v_exp_f32 v10, v10
    v_exp_f32 v11, v11
    v_exp_f32 v12, v12
    v_exp_f32 v13, v13
    s_waitcnt lgkmcnt(4)
    v_mfma_f32_32x32x4_2b_bf16 v[40:71], v[126:127], v[112:113], 0
    v_exp_f32 v14, v14
    v_exp_f32 v15, v15
    v_exp_f32 v16, v16
    v_exp_f32 v17, v17
    v_exp_f32 v18, v18
    v_exp_f32 v19, v19
    v_exp_f32 v20, v20
    v_exp_f32 v21, v21
    v_smfmac_f32_32x32x32_bf16 v[72:87], v[128:131], v[8:15], v114
    v_exp_f32 v22, v22
    v_exp_f32 v23, v23
    v_exp_f32 v24, v24
    v_exp_f32 v25, v25
    v_smfmac_f32_32x32x32_bf16 v[72:87], v[132:135], v[16:23], v114
    ds_read_b64 v[124:125], v145 offset:5632
    ds_read_b128 v[116:119], v144 offset:5632
    v_exp_f32 v26, v26
    v_exp_f32 v27, v27
    v_exp_f32 v28, v28
    v_exp_f32 v29, v29
    v_mfma_f32_32x32x16_bf16 v[40:55], v[120:123], v[104:107], v[40:55]
    v_exp_f32 v30, v30
    v_exp_f32 v31, v31
    v_exp_f32 v32, v32
    v_exp_f32 v33, v33
    v_smfmac_f32_32x32x32_bf16 v[88:103], v[128:131], v[24:31], v114
    v_exp_f32 v34, v34
    v_exp_f32 v35, v35
    v_exp_f32 v36, v36
    v_exp_f32 v37, v37
    v_mfma_f32_32x32x16_bf16 v[56:71], v[120:123], v[108:111], v[56:71]
    v_exp_f32 v38, v38
    v_exp_f32 v39, v39
    s_cmp_ge_u32 s36, 4
    s_cbranch_scc1 L_ff_88
    s_cmp_lg_u32 s42, 1
    s_cbranch_scc1 L_ff_88
    s_lshl_b32 s54, s38, 10
    s_lshl_b32 s53, s42, 2
    s_add_u32 s54, s54, s53
    s_add_u32 s54, s54, 188416
    v_lshlrev_b32 v3, 7, v0
    s_mov_b32 exec_lo, 0xff
    s_mov_b32 exec_hi, 0
    s_mov_b32 s52, s44
L_poll_89:
    buffer_load_dword v2, v3, s[4:7], s54 offen sc1
    s_add_u32 s52, s52, 1
    s_cmp_ge_u32 s52, 65536
    s_cselect_b32 s44, 65536, s44
    s_waitcnt vmcnt(0)
    s_cbranch_scc1 L_pd_90
    v_cmp_gt_u32 vcc, 1, v2
    s_nop 0
    s_cbranch_vccnz L_poll_89
L_pd_90:
    s_mov_b64 exec, -1
    s_add_u32 s56, 1, s90
    s_and_b32 s56, s56, 7
    s_mul_i32 s56, s56, 22528
    s_add_u32 s56, s56, s61
    s_add_u32 m0, s68, 22528
    s_add_u32 s57, s56, 0
    buffer_load_dwordx4 v1, s[4:7], s57 offen offset:0 sc1 lds
    buffer_load_dwordx4 v1, s[4:7], s57 offen offset:1024 sc1 lds
    buffer_load_dwordx4 v1, s[4:7], s57 offen offset:1792 sc1 lds
    s_add_u32 m0, s68, 33792
    s_add_u32 s57, s56, 11264
    buffer_load_dwordx4 v1, s[4:7], s57 offen offset:0 sc1 lds
    buffer_load_dwordx4 v1, s[4:7], s57 offen offset:1024 sc1 lds
    buffer_load_dwordx4 v1, s[4:7], s57 offen offset:1792 sc1 lds
L_ff_88:
    v_exp_f32 v40, v40
    v_exp_f32 v41, v41
    v_smfmac_f32_32x32x32_bf16 v[88:103], v[132:135], v[32:39], v114
    ds_read_b64_tr_b16 v[128:129], v146 offset:5632
    ds_read_b64_tr_b16 v[130:131], v146 offset:5824
    ds_read_b64_tr_b16 v[132:133], v146 offset:6400
    ds_read_b64_tr_b16 v[134:135], v146 offset:6592
    v_exp_f32 v42, v42
    v_exp_f32 v43, v43
    v_exp_f32 v44, v44
    v_exp_f32 v45, v45
    s_waitcnt lgkmcnt(4)
    v_mfma_f32_32x32x4_2b_bf16 v[8:39], v[124:125], v[112:113], 0
    v_exp_f32 v46, v46
    v_exp_f32 v47, v47
    v_exp_f32 v48, v48
    v_exp_f32 v49, v49
    v_exp_f32 v50, v50
    v_exp_f32 v51, v51
    v_exp_f32 v52, v52
    v_exp_f32 v53, v53
    v_smfmac_f32_32x32x32_bf16 v[72:87], v[136:139], v[40:47], v114
    v_exp_f32 v54, v54
    v_exp_f32 v55, v55
    v_exp_f32 v56, v56
    v_exp_f32 v57, v57
    v_smfmac_f32_32x32x32_bf16 v[72:87], v[140:143], v[48:55], v114
    ds_read_b64 v[126:127], v145 offset:8448
    ds_read_b128 v[120:123], v144 offset:8448
    v_exp_f32 v58, v58
    v_exp_f32 v59, v59
    v_exp_f32 v60, v60
    v_exp_f32 v61, v61
    v_mfma_f32_32x32x16_bf16 v[8:23], v[116:119], v[104:107], v[8:23]
    v_exp_f32 v62, v62
    v_exp_f32 v63, v63
    v_exp_f32 v64, v64
    v_exp_f32 v65, v65
    v_smfmac_f32_32x32x32_bf16 v[88:103], v[136:139], v[56:63], v114
    v_exp_f32 v66, v66
    v_exp_f32 v67, v67
    v_exp_f32 v68, v68
    v_exp_f32 v69, v69
    v_mfma_f32_32x32x16_bf16 v[24:39], v[116:119], v[108:111], v[24:39]
    v_exp_f32 v70, v70
    v_exp_f32 v71, v71
    s_cmp_ge_u32 s36, 4
    s_cbranch_scc1 L_ff_91
    s_cmp_lg_u32 s42, 0
    s_cbranch_scc1 L_ff_91
    s_lshl_b32 s54, s38, 10
    s_lshl_b32 s53, s42, 2
    s_add_u32 s54, s54, s53
    s_add_u32 s54, s54, 188416
    v_lshlrev_b32 v3, 7, v0
    s_mov_b32 exec_lo, 0xff
    s_mov_b32 exec_hi, 0
    s_mov_b32 s52, s44
L_poll_92:
    buffer_load_dword v2, v3, s[4:7], s54 offen sc1
    s_add_u32 s52, s52, 1
    s_cmp_ge_u32 s52, 65536
    s_cselect_b32 s44, 65536, s44
    s_waitcnt vmcnt(0)
    s_cbranch_scc1 L_pd_93
    v_cmp_gt_u32 vcc, 1, v2
    s_nop 0
    s_cbranch_vccnz L_poll_92
L_pd_93:
    s_mov_b64 exec, -1
    s_add_u32 s56, 1, s90
    s_and_b32 s56, s56, 7
    s_mul_i32 s56, s56, 22528
    s_add_u32 s56, s56, s61
    s_add_u32 m0, s68, 22528
    s_add_u32 s57, s56, 0
    buffer_load_dwordx4 v1, s[4:7], s57 offen offset:0 sc1 lds
    buffer_load_dwordx4 v1, s[4:7], s57 offen offset:1024 sc1 lds
    buffer_load_dwordx4 v1, s[4:7], s57 offen offset:1792 sc1 lds
    s_add_u32 m0, s68, 33792
    s_add_u32 s57, s56, 11264
    buffer_load_dwordx4 v1, s[4:7], s57 offen offset:0 sc1 lds
    buffer_load_dwordx4 v1, s[4:7], s57 offen offset:1024 sc1 lds
    buffer_load_dwordx4 v1, s[4:7], s57 offen offset:1792 sc1 lds
L_ff_91:
    v_exp_f32 v8, v8
    v_exp_f32 v9, v9
    v_smfmac_f32_32x32x32_bf16 v[88:103], v[140:143], v[64:71], v114
    ds_read_b64_tr_b16 v[136:137], v146 offset:8448
    ds_read_b64_tr_b16 v[138:139], v146 offset:8640
    ds_read_b64_tr_b16 v[140:141], v146 offset:9216
    ds_read_b64_tr_b16 v[142:143], v146 offset:9408
    v_exp_f32 v10, v10
    v_exp_f32 v11, v11
    v_exp_f32 v12, v12
    v_exp_f32 v13, v13
    s_waitcnt lgkmcnt(4)
    v_mfma_f32_32x32x4_2b_bf16 v[40:71], v[126:127], v[112:113], 0
    v_exp_f32 v14, v14
    v_exp_f32 v15, v15
    v_exp_f32 v16, v16
    v_exp_f32 v17, v17
    v_exp_f32 v18, v18
    v_exp_f32 v19, v19
    v_exp_f32 v20, v20
    v_exp_f32 v21, v21
    v_smfmac_f32_32x32x32_bf16 v[72:87], v[128:131], v[8:15], v114
    v_exp_f32 v22, v22
    v_exp_f32 v23, v23
    v_exp_f32 v24, v24
    v_exp_f32 v25, v25
    v_smfmac_f32_32x32x32_bf16 v[72:87], v[132:135], v[16:23], v114
    v_exp_f32 v26, v26
    v_exp_f32 v27, v27
    v_exp_f32 v28, v28
    v_exp_f32 v29, v29
    v_mfma_f32_32x32x16_bf16 v[40:55], v[120:123], v[104:107], v[40:55]
    v_exp_f32 v30, v30
    v_exp_f32 v31, v31
    v_exp_f32 v32, v32
    v_exp_f32 v33, v33
    v_smfmac_f32_32x32x32_bf16 v[88:103], v[128:131], v[24:31], v114
    v_exp_f32 v34, v34
    v_exp_f32 v35, v35
    v_exp_f32 v36, v36
    v_exp_f32 v37, v37
    v_mfma_f32_32x32x16_bf16 v[56:71], v[120:123], v[108:111], v[56:71]
    v_exp_f32 v38, v38
    v_exp_f32 v39, v39
    v_exp_f32 v40, v40
    v_exp_f32 v41, v41
    v_smfmac_f32_32x32x32_bf16 v[88:103], v[132:135], v[32:39], v114
    s_add_u32 s56, 2, s90
    s_and_b32 s56, s56, 7
    s_mul_i32 s56, s56, 22528
    s_add_u32 s56, s56, s61
    v_exp_f32 v42, v42
    v_exp_f32 v43, v43
    v_exp_f32 v44, v44
    v_exp_f32 v45, v45
    v_exp_f32 v46, v46
    v_exp_f32 v47, v47
    v_exp_f32 v48, v48
    v_exp_f32 v49, v49
    s_waitcnt lgkmcnt(0)
    v_smfmac_f32_32x32x32_bf16 v[72:87], v[136:139], v[40:47], v114
    v_exp_f32 v50, v50
    v_exp_f32 v51, v51
    v_exp_f32 v52, v52
    v_exp_f32 v53, v53
    v_exp_f32 v54, v54
    v_exp_f32 v55, v55
    v_exp_f32 v56, v56
    v_exp_f32 v57, v57
    v_smfmac_f32_32x32x32_bf16 v[72:87], v[140:143], v[48:55], v114
    s_waitcnt vmcnt(0) lgkmcnt(0)
    s_barrier
    s_setprio 3
    ds_read_b64 v[124:125], v145 offset:22528
    ds_read_b128 v[116:119], v144 offset:22528
    ds_read_b64_tr_b16 v[128:129], v146 offset:22528
    ds_read_b64_tr_b16 v[130:131], v146 offset:22720
    ds_read_b64_tr_b16 v[132:133], v146 offset:23296
    ds_read_b64_tr_b16 v[134:135], v146 offset:23488
    ds_read_b64 v[126:127], v145 offset:25344
    ds_read_b128 v[120:123], v144 offset:25344
    v_exp_f32 v58, v58
    v_exp_f32 v59, v59
    v_exp_f32 v60, v60
    v_exp_f32 v61, v61
    s_add_u32 m0, s68, 0
    s_nop 0
    buffer_load_dwordx4 v1, s[4:7], s56 offen offset:0 sc1 lds
    v_exp_f32 v62, v62
    v_exp_f32 v63, v63
    v_exp_f32 v64, v64
    v_exp_f32 v65, v65
    s_waitcnt lgkmcnt(6)
    v_mfma_f32_32x32x4_2b_bf16 v[8:39], v[124:125], v[112:113], 0
    buffer_load_dwordx4 v1, s[4:7], s56 offen offset:1024 sc1 lds
    v_exp_f32 v66, v66
    v_exp_f32 v67, v67
    v_exp_f32 v68, v68
    buffer_load_dwordx4 v1, s[4:7], s56 offen offset:1792 sc1 lds
    v_exp_f32 v69, v69
    v_exp_f32 v70, v70
    v_exp_f32 v71, v71
    v_smfmac_f32_32x32x32_bf16 v[88:103], v[136:139], v[56:63], v114
    s_add_u32 m0, s66, 0
    s_add_u32 s54, s65, 0
    buffer_load_dwordx4 v1, s[4:7], s54 offen offset:0 sc1 lds
    buffer_load_dwordx4 v1, s[4:7], s54 offen offset:1024 sc1 lds
    s_nop 4
    v_mfma_f32_32x32x16_bf16 v[8:23], v[116:119], v[104:107], v[8:23]
    v_mfma_f32_32x32x16_bf16 v[24:39], v[116:119], v[108:111], v[24:39]
    s_cmp_lg_u32 s42, 0
    s_cselect_b64 vcc, -1, 0
    s_nop 8
    v_exp_f32 v8, v8
    v_exp_f32 v9, v9
    v_smfmac_f32_32x32x32_bf16 v[88:103], v[140:143], v[64:71], v114
    ds_read_b64_tr_b16 v[136:137], v146 offset:25344
    ds_read_b64_tr_b16 v[138:139], v146 offset:25536
    ds_read_b64_tr_b16 v[140:141], v146 offset:26112
    ds_read_b64_tr_b16 v[142:143], v146 offset:26304
    v_exp_f32 v10, v10
    v_exp_f32 v11, v11
    v_exp_f32 v12, v12
    v_exp_f32 v13, v13
    s_waitcnt lgkmcnt(4)
    v_mfma_f32_32x32x4_2b_bf16 v[40:71], v[126:127], v[112:113], 0
    v_exp_f32 v14, v14
    v_exp_f32 v15, v15
    v_exp_f32 v16, v16
    v_exp_f32 v17, v17
    v_exp_f32 v18, v18
    v_exp_f32 v19, v19
    v_exp_f32 v20, v20
    v_exp_f32 v21, v21
    v_smfmac_f32_32x32x32_bf16 v[72:87], v[128:131], v[8:15], v114
    v_exp_f32 v22, v22
    v_exp_f32 v23, v23
    v_exp_f32 v24, v24
    v_exp_f32 v25, v25
    v_smfmac_f32_32x32x32_bf16 v[72:87], v[132:135], v[16:23], v114
    ds_read_b64 v[124:125], v145 offset:28160
    ds_read_b128 v[116:119], v144 offset:28160
    v_exp_f32 v26, v26
    v_exp_f32 v27, v27
    v_exp_f32 v28, v28
    v_exp_f32 v29, v29
    v_mfma_f32_32x32x16_bf16 v[40:55], v[120:123], v[104:107], v[40:55]
    v_exp_f32 v30, v30
    v_exp_f32 v31, v31
    v_exp_f32 v32, v32
    v_exp_f32 v33, v33
    v_smfmac_f32_32x32x32_bf16 v[88:103], v[128:131], v[24:31], v114
    v_exp_f32 v34, v34
    v_exp_f32 v35, v35
    v_exp_f32 v36, v36
    v_exp_f32 v37, v37
    v_mfma_f32_32x32x16_bf16 v[56:71], v[120:123], v[108:111], v[56:71]
    v_exp_f32 v38, v38
    v_exp_f32 v39, v39
    v_exp_f32 v40, v40
    v_exp_f32 v41, v41
    v_smfmac_f32_32x32x32_bf16 v[88:103], v[132:135], v[32:39], v114
    ds_read_b64_tr_b16 v[128:129], v146 offset:28160
    ds_read_b64_tr_b16 v[130:131], v146 offset:28352
    ds_read_b64_tr_b16 v[132:133], v146 offset:28928
    ds_read_b64_tr_b16 v[134:135], v146 offset:29120
    s_setprio 2
    v_exp_f32 v42, v42
    v_exp_f32 v43, v43
    v_exp_f32 v44, v44
    v_exp_f32 v45, v45
    s_waitcnt lgkmcnt(4)
    v_mfma_f32_32x32x4_2b_bf16 v[8:39], v[124:125], v[112:113], 0
    buffer_store_dwordx4 v[152:155], v7, s[4:7], s76 offen sc1
    v_exp_f32 v46, v46
    v_exp_f32 v47, v47
    v_exp_f32 v48, v48
    v_exp_f32 v49, v49
    v_exp_f32 v50, v50
    v_exp_f32 v51, v51
    v_exp_f32 v52, v52
    v_exp_f32 v53, v53
    v_smfmac_f32_32x32x32_bf16 v[72:87], v[136:139], v[40:47], v114
    buffer_store_dwordx4 v[156:159], v7, s[4:7], s77 offen sc1
    v_exp_f32 v54, v54
    v_exp_f32 v55, v55
    v_exp_f32 v56, v56
    v_exp_f32 v57, v57
    v_smfmac_f32_32x32x32_bf16 v[72:87], v[140:143], v[48:55], v114
    ds_read_b64 v[126:127], v145 offset:30976
    ds_read_b128 v[120:123], v144 offset:30976
    v_exp_f32 v58, v58
    v_exp_f32 v59, v59
    v_exp_f32 v60, v60
    v_exp_f32 v61, v61
    v_mfma_f32_32x32x16_bf16 v[8:23], v[116:119], v[104:107], v[8:23]
    s_add_u32 s56, 3, s90
    s_and_b32 s56, s56, 7
    s_mul_i32 s56, s56, 22528
    s_add_u32 s56, s56, s61
    v_exp_f32 v62, v62
    v_exp_f32 v63, v63
    v_exp_f32 v64, v64
    v_exp_f32 v65, v65
    v_smfmac_f32_32x32x32_bf16 v[88:103], v[136:139], v[56:63], v114
    v_exp_f32 v66, v66
    v_exp_f32 v67, v67
    v_exp_f32 v68, v68
    v_exp_f32 v69, v69
    v_mfma_f32_32x32x16_bf16 v[24:39], v[116:119], v[108:111], v[24:39]
    buffer_store_dwordx4 v[160:163], v151, s[4:7], s78 offen sc1
    v_exp_f32 v70, v70
    v_exp_f32 v71, v71
    v_exp_f32 v8, v8
    v_exp_f32 v9, v9
    v_smfmac_f32_32x32x32_bf16 v[88:103], v[140:143], v[64:71], v114
    ds_read_b64_tr_b16 v[136:137], v146 offset:30976
    ds_read_b64_tr_b16 v[138:139], v146 offset:31168
    ds_read_b64_tr_b16 v[140:141], v146 offset:31744
    ds_read_b64_tr_b16 v[142:143], v146 offset:31936
    s_setprio 1
    v_exp_f32 v10, v10
    v_exp_f32 v11, v11
    v_exp_f32 v12, v12
    v_exp_f32 v13, v13
    s_waitcnt lgkmcnt(4)
    v_mfma_f32_32x32x4_2b_bf16 v[40:71], v[126:127], v[112:113], 0
    buffer_store_dwordx4 v[164:167], v151, s[4:7], s79 offen sc1
    v_exp_f32 v14, v14
    v_exp_f32 v15, v15
    v_exp_f32 v16, v16
    v_exp_f32 v17, v17
    v_exp_f32 v18, v18
    v_exp_f32 v19, v19
    v_exp_f32 v20, v20
    v_exp_f32 v21, v21
    v_smfmac_f32_32x32x32_bf16 v[72:87], v[128:131], v[8:15], v114
    s_setprio 0
    v_exp_f32 v22, v22
    v_exp_f32 v23, v23
    v_exp_f32 v24, v24
    v_exp_f32 v25, v25
    v_smfmac_f32_32x32x32_bf16 v[72:87], v[132:135], v[16:23], v114
    s_waitcnt vmcnt(4) lgkmcnt(0)
    s_barrier
    ds_read_b64 v[124:125], v145 offset:0
    ds_read_b128 v[116:119], v144 offset:0
    s_setprio 3
    v_exp_f32 v26, v26
    v_exp_f32 v27, v27
    v_exp_f32 v28, v28
    v_exp_f32 v29, v29
    v_mfma_f32_32x32x16_bf16 v[40:55], v[120:123], v[104:107], v[40:55]
    s_add_u32 m0, s68, 22528
    s_nop 0
    buffer_load_dwordx4 v1, s[4:7], s56 offen offset:0 sc1 lds
    v_exp_f32 v30, v30
    v_exp_f32 v31, v31
    v_exp_f32 v32, v32
    v_exp_f32 v33, v33
    v_smfmac_f32_32x32x32_bf16 v[88:103], v[128:131], v[24:31], v114
    v_exp_f32 v34, v34
    v_exp_f32 v35, v35
    v_exp_f32 v36, v36
    v_exp_f32 v37, v37
    v_mfma_f32_32x32x16_bf16 v[56:71], v[120:123], v[108:111], v[56:71]
    buffer_load_dwordx4 v1, s[4:7], s56 offen offset:1024 sc1 lds
    v_exp_f32 v38, v38
    v_exp_f32 v39, v39
    v_exp_f32 v40, v40
    v_exp_f32 v41, v41
    v_smfmac_f32_32x32x32_bf16 v[88:103], v[132:135], v[32:39], v114
    ds_read_b64_tr_b16 v[128:129], v146 offset:0
    ds_read_b64_tr_b16 v[130:131], v146 offset:192
    ds_read_b64_tr_b16 v[132:133], v146 offset:768
    ds_read_b64_tr_b16 v[134:135], v146 offset:960
    v_exp_f32 v42, v42
    v_exp_f32 v43, v43
    v_exp_f32 v44, v44
    v_exp_f32 v45, v45
    s_waitcnt lgkmcnt(4)
    v_mfma_f32_32x32x4_2b_bf16 v[8:39], v[124:125], v[112:113], 0
    buffer_load_dwordx4 v1, s[4:7], s56 offen offset:1792 sc1 lds
    v_exp_f32 v46, v46
    v_exp_f32 v47, v47
    v_exp_f32 v48, v48
    v_exp_f32 v49, v49
    v_exp_f32 v50, v50
    v_exp_f32 v51, v51
    v_exp_f32 v52, v52
    v_exp_f32 v53, v53
    v_smfmac_f32_32x32x32_bf16 v[72:87], v[136:139], v[40:47], v114
    s_add_u32 m0, s66, 2048
    s_add_u32 s54, s65, 2048
    buffer_load_dwordx4 v1, s[4:7], s54 offen offset:0 sc1 lds
    v_exp_f32 v54, v54
    v_exp_f32 v55, v55
    v_exp_f32 v56, v56
    v_exp_f32 v57, v57
    v_smfmac_f32_32x32x32_bf16 v[72:87], v[140:143], v[48:55], v114
    ds_read_b64 v[126:127], v145 offset:2816
    ds_read_b128 v[120:123], v144 offset:2816
    v_exp_f32 v58, v58
    v_exp_f32 v59, v59
    v_exp_f32 v60, v60
    v_exp_f32 v61, v61
    v_mfma_f32_32x32x16_bf16 v[8:23], v[116:119], v[104:107], v[8:23]
    buffer_load_dwordx4 v1, s[4:7], s54 offen offset:1024 sc1 lds
    v_exp_f32 v62, v62
    v_exp_f32 v63, v63
    v_exp_f32 v64, v64
    v_exp_f32 v65, v65
    v_smfmac_f32_32x32x32_bf16 v[88:103], v[136:139], v[56:63], v114
    v_exp_f32 v66, v66
    v_exp_f32 v67, v67
    v_exp_f32 v68, v68
    v_exp_f32 v69, v69
    v_mfma_f32_32x32x16_bf16 v[24:39], v[116:119], v[108:111], v[24:39]
    v_exp_f32 v70, v70
    v_exp_f32 v71, v71
    v_exp_f32 v8, v8
    v_exp_f32 v9, v9
    v_smfmac_f32_32x32x32_bf16 v[88:103], v[140:143], v[64:71], v114
    ds_read_b64_tr_b16 v[136:137], v146 offset:2816
    ds_read_b64_tr_b16 v[138:139], v146 offset:3008
    ds_read_b64_tr_b16 v[140:141], v146 offset:3584
    ds_read_b64_tr_b16 v[142:143], v146 offset:3776
    v_exp_f32 v10, v10
    v_exp_f32 v11, v11
    v_exp_f32 v12, v12
    v_exp_f32 v13, v13
    s_waitcnt lgkmcnt(4)
    v_mfma_f32_32x32x4_2b_bf16 v[40:71], v[126:127], v[112:113], 0
    v_exp_f32 v14, v14
    v_exp_f32 v15, v15
    v_exp_f32 v16, v16
    v_exp_f32 v17, v17
    v_exp_f32 v18, v18
    v_exp_f32 v19, v19
    v_exp_f32 v20, v20
    v_exp_f32 v21, v21
    v_smfmac_f32_32x32x32_bf16 v[72:87], v[128:131], v[8:15], v114
    v_exp_f32 v22, v22
    v_exp_f32 v23, v23
    v_exp_f32 v24, v24
    v_exp_f32 v25, v25
    v_smfmac_f32_32x32x32_bf16 v[72:87], v[132:135], v[16:23], v114
    ds_read_b64 v[124:125], v145 offset:5632
    ds_read_b128 v[116:119], v144 offset:5632
    v_exp_f32 v26, v26
    v_exp_f32 v27, v27
    v_exp_f32 v28, v28
    v_exp_f32 v29, v29
    v_mfma_f32_32x32x16_bf16 v[40:55], v[120:123], v[104:107], v[40:55]
    v_exp_f32 v30, v30
    v_exp_f32 v31, v31
    v_exp_f32 v32, v32
    v_exp_f32 v33, v33
    v_smfmac_f32_32x32x32_bf16 v[88:103], v[128:131], v[24:31], v114
    v_exp_f32 v34, v34
    v_exp_f32 v35, v35
    v_exp_f32 v36, v36
    v_exp_f32 v37, v37
    v_mfma_f32_32x32x16_bf16 v[56:71], v[120:123], v[108:111], v[56:71]
    v_exp_f32 v38, v38
    v_exp_f32 v39, v39
    v_exp_f32 v40, v40
    v_exp_f32 v41, v41
    v_smfmac_f32_32x32x32_bf16 v[88:103], v[132:135], v[32:39], v114
    ds_read_b64_tr_b16 v[128:129], v146 offset:5632
    ds_read_b64_tr_b16 v[130:131], v146 offset:5824
    ds_read_b64_tr_b16 v[132:133], v146 offset:6400
    ds_read_b64_tr_b16 v[134:135], v146 offset:6592
    s_setprio 2
    v_exp_f32 v42, v42
    v_exp_f32 v43, v43
    v_exp_f32 v44, v44
    v_exp_f32 v45, v45
    s_waitcnt lgkmcnt(4)
    v_mfma_f32_32x32x4_2b_bf16 v[8:39], v[124:125], v[112:113], 0
    v_exp_f32 v46, v46
    v_exp_f32 v47, v47
    v_exp_f32 v48, v48
    v_exp_f32 v49, v49
    v_exp_f32 v50, v50
    v_exp_f32 v51, v51
    v_exp_f32 v52, v52
    v_exp_f32 v53, v53
    v_smfmac_f32_32x32x32_bf16 v[72:87], v[136:139], v[40:47], v114
    v_exp_f32 v54, v54
    v_exp_f32 v55, v55
    v_exp_f32 v56, v56
    v_exp_f32 v57, v57
    v_smfmac_f32_32x32x32_bf16 v[72:87], v[140:143], v[48:55], v114
    ds_read_b64 v[126:127], v145 offset:8448
    ds_read_b128 v[120:123], v144 offset:8448
    v_exp_f32 v58, v58
    v_exp_f32 v59, v59
    v_exp_f32 v60, v60
    v_exp_f32 v61, v61
    v_mfma_f32_32x32x16_bf16 v[8:23], v[116:119], v[104:107], v[8:23]
    s_add_u32 s56, 4, s90
    s_and_b32 s56, s56, 7
    s_mul_i32 s56, s56, 22528
    s_add_u32 s56, s56, s61
    v_exp_f32 v62, v62
    v_exp_f32 v63, v63
    v_exp_f32 v64, v64
    v_exp_f32 v65, v65
    v_smfmac_f32_32x32x32_bf16 v[88:103], v[136:139], v[56:63], v114
    v_exp_f32 v66, v66
    v_exp_f32 v67, v67
    v_exp_f32 v68, v68
    v_exp_f32 v69, v69
    v_mfma_f32_32x32x16_bf16 v[24:39], v[116:119], v[108:111], v[24:39]
    v_exp_f32 v70, v70
    v_exp_f32 v71, v71
    v_exp_f32 v8, v8
    v_exp_f32 v9, v9
    v_smfmac_f32_32x32x32_bf16 v[88:103], v[140:143], v[64:71], v114
    ds_read_b64_tr_b16 v[136:137], v146 offset:8448
    ds_read_b64_tr_b16 v[138:139], v146 offset:8640
    ds_read_b64_tr_b16 v[140:141], v146 offset:9216
    ds_read_b64_tr_b16 v[142:143], v146 offset:9408
    s_setprio 1
    v_exp_f32 v10, v10
    v_exp_f32 v11, v11
    v_exp_f32 v12, v12
    v_exp_f32 v13, v13
    s_waitcnt lgkmcnt(4)
    v_mfma_f32_32x32x4_2b_bf16 v[40:71], v[126:127], v[112:113], 0
    v_exp_f32 v14, v14
    v_exp_f32 v15, v15
    v_exp_f32 v16, v16
    v_exp_f32 v17, v17
    v_exp_f32 v18, v18
    v_exp_f32 v19, v19
    v_exp_f32 v20, v20
    v_exp_f32 v21, v21
    v_smfmac_f32_32x32x32_bf16 v[72:87], v[128:131], v[8:15], v114
    s_setprio 0
    v_exp_f32 v22, v22
    v_exp_f32 v23, v23
    v_exp_f32 v24, v24
    v_exp_f32 v25, v25
    v_smfmac_f32_32x32x32_bf16 v[72:87], v[132:135], v[16:23], v114
    s_waitcnt vmcnt(0) lgkmcnt(0)
    s_barrier
    ds_read_b64 v[124:125], v145 offset:22528
    ds_read_b128 v[116:119], v144 offset:22528
    s_setprio 3
    v_exp_f32 v26, v26
    v_exp_f32 v27, v27
    v_exp_f32 v28, v28
    v_exp_f32 v29, v29
    v_mfma_f32_32x32x16_bf16 v[40:55], v[120:123], v[104:107], v[40:55]
    s_add_u32 m0, s68, 0
    s_nop 0
    buffer_load_dwordx4 v1, s[4:7], s56 offen offset:0 sc1 lds
    v_exp_f32 v30, v30
    v_exp_f32 v31, v31
    v_exp_f32 v32, v32
    v_exp_f32 v33, v33
    v_smfmac_f32_32x32x32_bf16 v[88:103], v[128:131], v[24:31], v114
    v_exp_f32 v34, v34
    v_exp_f32 v35, v35
    v_exp_f32 v36, v36
    v_exp_f32 v37, v37
    v_mfma_f32_32x32x16_bf16 v[56:71], v[120:123], v[108:111], v[56:71]
    buffer_load_dwordx4 v1, s[4:7], s56 offen offset:1024 sc1 lds
    v_exp_f32 v38, v38
    v_exp_f32 v39, v39
    v_exp_f32 v40, v40
    v_exp_f32 v41, v41
    v_smfmac_f32_32x32x32_bf16 v[88:103], v[132:135], v[32:39], v114
    ds_read_b64_tr_b16 v[128:129], v146 offset:22528
    ds_read_b64_tr_b16 v[130:131], v146 offset:22720
    ds_read_b64_tr_b16 v[132:133], v146 offset:23296
    ds_read_b64_tr_b16 v[134:135], v146 offset:23488
    v_exp_f32 v42, v42
    v_exp_f32 v43, v43
    v_exp_f32 v44, v44
    v_exp_f32 v45, v45
    s_waitcnt lgkmcnt(4)
    v_mfma_f32_32x32x4_2b_bf16 v[8:39], v[124:125], v[112:113], 0
    buffer_load_dwordx4 v1, s[4:7], s56 offen offset:1792 sc1 lds
    v_exp_f32 v46, v46
    v_exp_f32 v47, v47
    v_exp_f32 v48, v48
    v_exp_f32 v49, v49
    v_exp_f32 v50, v50
    v_exp_f32 v51, v51
    v_exp_f32 v52, v52
    v_exp_f32 v53, v53
    v_smfmac_f32_32x32x32_bf16 v[72:87], v[136:139], v[40:47], v114
    s_add_u32 m0, s66, 4096
    s_add_u32 s54, s65, 4096
    buffer_load_dwordx4 v1, s[4:7], s54 offen offset:0 sc1 lds
    v_exp_f32 v54, v54
    v_exp_f32 v55, v55
    v_exp_f32 v56, v56
    v_exp_f32 v57, v57
    v_smfmac_f32_32x32x32_bf16 v[72:87], v[140:143], v[48:55], v114
    ds_read_b64 v[126:127], v145 offset:25344
    ds_read_b128 v[120:123], v144 offset:25344
    v_exp_f32 v58, v58
    v_exp_f32 v59, v59
    v_exp_f32 v60, v60
    v_exp_f32 v61, v61
    v_mfma_f32_32x32x16_bf16 v[8:23], v[116:119], v[104:107], v[8:23]
    buffer_load_dwordx4 v1, s[4:7], s54 offen offset:1024 sc1 lds
    v_exp_f32 v62, v62
    v_exp_f32 v63, v63
    v_exp_f32 v64, v64
    v_exp_f32 v65, v65
    v_smfmac_f32_32x32x32_bf16 v[88:103], v[136:139], v[56:63], v114
    v_exp_f32 v66, v66
    v_exp_f32 v67, v67
    v_exp_f32 v68, v68
    v_exp_f32 v69, v69
    v_mfma_f32_32x32x16_bf16 v[24:39], v[116:119], v[108:111], v[24:39]
    v_exp_f32 v70, v70
    v_exp_f32 v71, v71
    v_exp_f32 v8, v8
    v_exp_f32 v9, v9
    v_smfmac_f32_32x32x32_bf16 v[88:103], v[140:143], v[64:71], v114
    ds_read_b64_tr_b16 v[136:137], v146 offset:25344
    ds_read_b64_tr_b16 v[138:139], v146 offset:25536
    ds_read_b64_tr_b16 v[140:141], v146 offset:26112
    ds_read_b64_tr_b16 v[142:143], v146 offset:26304
    v_exp_f32 v10, v10
    v_exp_f32 v11, v11
    v_exp_f32 v12, v12
    v_exp_f32 v13, v13
    s_waitcnt lgkmcnt(4)
    v_mfma_f32_32x32x4_2b_bf16 v[40:71], v[126:127], v[112:113], 0
    s_lshl_b32 s52, s42, 3
    s_add_u32 s52, s52, s36
    s_cmp_eq_u32 s52, 12
    s_cbranch_scc1 L_x3_say
L_x3_said:
    v_exp_f32 v14, v14
    v_exp_f32 v15, v15
    v_exp_f32 v16, v16
    v_exp_f32 v17, v17
    v_exp_f32 v18, v18
    v_exp_f32 v19, v19
    v_exp_f32 v20, v20
    v_exp_f32 v21, v21
    v_smfmac_f32_32x32x32_bf16 v[72:87], v[128:131], v[8:15], v114
    v_exp_f32 v22, v22
    v_exp_f32 v23, v23
    v_exp_f32 v24, v24
    v_exp_f32 v25, v25
    v_smfmac_f32_32x32x32_bf16 v[72:87], v[132:135], v[16:23], v114
    ds_read_b64 v[124:125], v145 offset:28160
    ds_read_b128 v[116:119], v144 offset:28160
    v_exp_f32 v26, v26
    v_exp_f32 v27, v27
    v_exp_f32 v28, v28
    v_exp_f32 v29, v29
    v_mfma_f32_32x32x16_bf16 v[40:55], v[120:123], v[104:107], v[40:55]
    v_exp_f32 v30, v30
    v_exp_f32 v31, v31
    v_exp_f32 v32, v32
    v_exp_f32 v33, v33
    v_smfmac_f32_32x32x32_bf16 v[88:103], v[128:131], v[24:31], v114
    v_exp_f32 v34, v34
    v_exp_f32 v35, v35
    v_exp_f32 v36, v36
    v_exp_f32 v37, v37
    v_mfma_f32_32x32x16_bf16 v[56:71], v[120:123], v[108:111], v[56:71]
    v_exp_f32 v38, v38
    v_exp_f32 v39, v39
    v_exp_f32 v40, v40
    v_exp_f32 v41, v41
    v_smfmac_f32_32x32x32_bf16 v[88:103], v[132:135], v[32:39], v114
    ds_read_b64_tr_b16 v[128:129], v146 offset:28160
    ds_read_b64_tr_b16 v[130:131], v146 offset:28352
    ds_read_b64_tr_b16 v[132:133], v146 offset:28928
    ds_read_b64_tr_b16 v[134:135], v146 offset:29120
    s_setprio 2
    v_exp_f32 v42, v42
    v_exp_f32 v43, v43
    v_exp_f32 v44, v44
    v_exp_f32 v45, v45
    s_waitcnt lgkmcnt(4)
    v_mfma_f32_32x32x4_2b_bf16 v[8:39], v[124:125], v[112:113], 0
    v_exp_f32 v46, v46
    v_exp_f32 v47, v47
    v_exp_f32 v48, v48
    v_exp_f32 v49, v49
    v_exp_f32 v50, v50
    v_exp_f32 v51, v51
    v_exp_f32 v52, v52
    v_exp_f32 v53, v53
    v_smfmac_f32_32x32x32_bf16 v[72:87], v[136:139], v[40:47], v114
    v_exp_f32 v54, v54
    v_exp_f32 v55, v55
    v_exp_f32 v56, v56
    v_exp_f32 v57, v57
    v_smfmac_f32_32x32x32_bf16 v[72:87], v[140:143], v[48:55], v114
    ds_read_b64 v[126:127], v145 offset:30976
    ds_read_b128 v[120:123], v144 offset:30976
    v_exp_f32 v58, v58
    v_exp_f32 v59, v59
    v_exp_f32 v60, v60
    v_exp_f32 v61, v61
    v_mfma_f32_32x32x16_bf16 v[8:23], v[116:119], v[104:107], v[8:23]
    s_add_u32 s56, 5, s90
    s_and_b32 s56, s56, 7
    s_mul_i32 s56, s56, 22528
    s_add_u32 s56, s56, s61
    v_exp_f32 v62, v62
    v_exp_f32 v63, v63
    v_exp_f32 v64, v64
    v_exp_f32 v65, v65
    v_smfmac_f32_32x32x32_bf16 v[88:103], v[136:139], v[56:63], v114
    v_exp_f32 v66, v66
    v_exp_f32 v67, v67
    v_exp_f32 v68, v68
    v_exp_f32 v69, v69
    v_mfma_f32_32x32x16_bf16 v[24:39], v[116:119], v[108:111], v[24:39]
    v_exp_f32 v70, v70
    v_exp_f32 v71, v71
    v_exp_f32 v8, v8
    v_exp_f32 v9, v9
    v_smfmac_f32_32x32x32_bf16 v[88:103], v[140:143], v[64:71], v114
    ds_read_b64_tr_b16 v[136:137], v146 offset:30976
    ds_read_b64_tr_b16 v[138:139], v146 offset:31168
    ds_read_b64_tr_b16 v[140:141], v146 offset:31744
    ds_read_b64_tr_b16 v[142:143], v146 offset:31936
    s_setprio 1
    v_exp_f32 v10, v10
    v_exp_f32 v11, v11
    v_exp_f32 v12, v12
    v_exp_f32 v13, v13
    s_waitcnt lgkmcnt(4)
    v_mfma_f32_32x32x4_2b_bf16 v[40:71], v[126:127], v[112:113], 0
    v_exp_f32 v14, v14
    v_exp_f32 v15, v15
    v_exp_f32 v16, v16
    v_exp_f32 v17, v17
    v_exp_f32 v18, v18
    v_exp_f32 v19, v19
    v_exp_f32 v20, v20
    v_exp_f32 v21, v21
    v_smfmac_f32_32x32x32_bf16 v[72:87], v[128:131], v[8:15], v114
    s_setprio 0
    v_exp_f32 v22, v22
    v_exp_f32 v23, v23
    v_exp_f32 v24, v24
    v_exp_f32 v25, v25
    v_smfmac_f32_32x32x32_bf16 v[72:87], v[132:135], v[16:23], v114
    s_waitcnt vmcnt(0) lgkmcnt(0)
    s_barrier
    ds_read_b64 v[124:125], v145 offset:0
    ds_read_b128 v[116:119], v144 offset:0
    s_setprio 3
    v_exp_f32 v26, v26
    v_exp_f32 v27, v27
    v_exp_f32 v28, v28
    v_exp_f32 v29, v29
    v_mfma_f32_32x32x16_bf16 v[40:55], v[120:123], v[104:107], v[40:55]
    s_add_u32 m0, s68, 22528
    s_nop 0
    buffer_load_dwordx4 v1, s[4:7], s56 offen offset:0 sc1 lds
    v_exp_f32 v30, v30
    v_exp_f32 v31, v31
    v_exp_f32 v32, v32
    v_exp_f32 v33, v33
    v_smfmac_f32_32x32x32_bf16 v[88:103], v[128:131], v[24:31], v114
    v_exp_f32 v34, v34
    v_exp_f32 v35, v35
    v_exp_f32 v36, v36
    v_exp_f32 v37, v37
    v_mfma_f32_32x32x16_bf16 v[56:71], v[120:123], v[108:111], v[56:71]
    buffer_load_dwordx4 v1, s[4:7], s56 offen offset:1024 sc1 lds
    v_exp_f32 v38, v38
    v_exp_f32 v39, v39
    v_exp_f32 v40, v40
    v_exp_f32 v41, v41
    v_smfmac_f32_32x32x32_bf16 v[88:103], v[132:135], v[32:39], v114
    ds_read_b64_tr_b16 v[128:129], v146 offset:0
    ds_read_b64_tr_b16 v[130:131], v146 offset:192
    ds_read_b64_tr_b16 v[132:133], v146 offset:768
    ds_read_b64_tr_b16 v[134:135], v146 offset:960
    v_exp_f32 v42, v42
    v_exp_f32 v43, v43
    v_exp_f32 v44, v44
    v_exp_f32 v45, v45
    s_waitcnt lgkmcnt(4)
    v_mfma_f32_32x32x4_2b_bf16 v[8:39], v[124:125], v[112:113], 0
    buffer_load_dwordx4 v1, s[4:7], s56 offen offset:1792 sc1 lds
    v_exp_f32 v46, v46
    v_exp_f32 v47, v47
    v_exp_f32 v48, v48
    v_exp_f32 v49, v49
    v_exp_f32 v50, v50
    v_exp_f32 v51, v51
    v_exp_f32 v52, v52
    v_exp_f32 v53, v53
    v_smfmac_f32_32x32x32_bf16 v[72:87], v[136:139], v[40:47], v114
    s_add_u32 m0, s66, 6144
    s_add_u32 s54, s65, 6144
    buffer_load_dwordx4 v1, s[4:7], s54 offen offset:0 sc1 lds
    v_exp_f32 v54, v54
    v_exp_f32 v55, v55
    v_exp_f32 v56, v56
    v_exp_f32 v57, v57
    v_smfmac_f32_32x32x32_bf16 v[72:87], v[140:143], v[48:55], v114
    ds_read_b64 v[126:127], v145 offset:2816
    ds_read_b128 v[120:123], v144 offset:2816
    v_exp_f32 v58, v58
    v_exp_f32 v59, v59
    v_exp_f32 v60, v60
    v_exp_f32 v61, v61
    v_mfma_f32_32x32x16_bf16 v[8:23], v[116:119], v[104:107], v[8:23]
    buffer_load_dwordx4 v1, s[4:7], s54 offen offset:1024 sc1 lds
    v_exp_f32 v62, v62
    v_exp_f32 v63, v63
    v_exp_f32 v64, v64
    v_exp_f32 v65, v65
    v_smfmac_f32_32x32x32_bf16 v[88:103], v[136:139], v[56:63], v114
    v_exp_f32 v66, v66
    v_exp_f32 v67, v67
    v_exp_f32 v68, v68
    v_exp_f32 v69, v69
    v_mfma_f32_32x32x16_bf16 v[24:39], v[116:119], v[108:111], v[24:39]
    v_exp_f32 v70, v70
    v_exp_f32 v71, v71
    v_exp_f32 v8, v8
    v_exp_f32 v9, v9
    v_smfmac_f32_32x32x32_bf16 v[88:103], v[140:143], v[64:71], v114
    ds_read_b64_tr_b16 v[136:137], v146 offset:2816
    ds_read_b64_tr_b16 v[138:139], v146 offset:3008
    ds_read_b64_tr_b16 v[140:141], v146 offset:3584
    ds_read_b64_tr_b16 v[142:143], v146 offset:3776
    v_exp_f32 v10, v10
    v_exp_f32 v11, v11
    v_exp_f32 v12, v12
    v_exp_f32 v13, v13
    s_waitcnt lgkmcnt(4)
    v_mfma_f32_32x32x4_2b_bf16 v[40:71], v[126:127], v[112:113], 0
    s_mov_b32 s82, 0x7f817f81
    s_mov_b32 s83, s82
    v_mov_b64 v[152:153], s[82:83]
    v_mov_b64 v[154:155], s[82:83]
    v_exp_f32 v14, v14
    v_exp_f32 v15, v15
    v_exp_f32 v16, v16
    v_exp_f32 v17, v17
    v_exp_f32 v18, v18
    v_exp_f32 v19, v19
    v_exp_f32 v20, v20
    v_exp_f32 v21, v21
    v_smfmac_f32_32x32x32_bf16 v[72:87], v[128:131], v[8:15], v114
    buffer_store_dwordx4 v[152:155], v148, s[4:7], s70 offen sc1
    v_exp_f32 v22, v22
    v_exp_f32 v23, v23
    v_exp_f32 v24, v24
    v_exp_f32 v25, v25
    v_smfmac_f32_32x32x32_bf16 v[72:87], v[132:135], v[16:23], v114
    ds_read_b64 v[124:125], v145 offset:5632
    ds_read_b128 v[116:119], v144 offset:5632
    v_exp_f32 v26, v26
    v_exp_f32 v27, v27
    v_exp_f32 v28, v28
    v_exp_f32 v29, v29
    v_mfma_f32_32x32x16_bf16 v[40:55], v[120:123], v[104:107], v[40:55]
    buffer_store_dwordx2 v[152:153], v149, s[4:7], s71 offen sc1
    v_exp_f32 v30, v30
    v_exp_f32 v31, v31
    v_exp_f32 v32, v32
    v_exp_f32 v33, v33
    v_smfmac_f32_32x32x32_bf16 v[88:103], v[128:131], v[24:31], v114
    v_exp_f32 v34, v34
    v_exp_f32 v35, v35
    v_exp_f32 v36, v36
    v_exp_f32 v37, v37
    v_mfma_f32_32x32x16_bf16 v[56:71], v[120:123], v[108:111], v[56:71]
    v_exp_f32 v38, v38
    v_exp_f32 v39, v39
    v_exp_f32 v40, v40
    v_exp_f32 v41, v41
    v_smfmac_f32_32x32x32_bf16 v[88:103], v[132:135], v[32:39], v114
    ds_read_b64_tr_b16 v[128:129], v146 offset:5632
    ds_read_b64_tr_b16 v[130:131], v146 offset:5824
    ds_read_b64_tr_b16 v[132:133], v146 offset:6400
    ds_read_b64_tr_b16 v[134:135], v146 offset:6592
    s_setprio 2
    v_exp_f32 v42, v42
    v_exp_f32 v43, v43
    v_exp_f32 v44, v44
    v_exp_f32 v45, v45
    s_waitcnt lgkmcnt(4)
    v_mfma_f32_32x32x4_2b_bf16 v[8:39], v[124:125], v[112:113], 0
    v_exp_f32 v46, v46
    v_exp_f32 v47, v47
    v_exp_f32 v48, v48
    v_exp_f32 v49, v49
    v_exp_f32 v50, v50
    v_exp_f32 v51, v51
    v_exp_f32 v52, v52
    v_exp_f32 v53, v53
    v_smfmac_f32_32x32x32_bf16 v[72:87], v[136:139], v[40:47], v114
    v_exp_f32 v54, v54
    v_exp_f32 v55, v55
    v_exp_f32 v56, v56
    v_exp_f32 v57, v57
    v_smfmac_f32_32x32x32_bf16 v[72:87], v[140:143], v[48:55], v114
    ds_read_b64 v[126:127], v145 offset:8448
    ds_read_b128 v[120:123], v144 offset:8448
    v_exp_f32 v58, v58
    v_exp_f32 v59, v59
    v_exp_f32 v60, v60
    v_exp_f32 v61, v61
    v_mfma_f32_32x32x16_bf16 v[8:23], v[116:119], v[104:107], v[8:23]
    s_add_u32 s56, 6, s90
    s_and_b32 s56, s56, 7
    s_mul_i32 s56, s56, 22528
    s_add_u32 s56, s56, s61
    v_exp_f32 v62, v62
    v_exp_f32 v63, v63
    v_exp_f32 v64, v64
    v_exp_f32 v65, v65
    v_smfmac_f32_32x32x32_bf16 v[88:103], v[136:139], v[56:63], v114
    v_exp_f32 v66, v66
    v_exp_f32 v67, v67
    v_exp_f32 v68, v68
    v_exp_f32 v69, v69
    v_mfma_f32_32x32x16_bf16 v[24:39], v[116:119], v[108:111], v[24:39]
    v_exp_f32 v70, v70
    v_exp_f32 v71, v71
    v_exp_f32 v8, v8
    v_exp_f32 v9, v9
    v_smfmac_f32_32x32x32_bf16 v[88:103], v[140:143], v[64:71], v114
    ds_read_b64_tr_b16 v[136:137], v146 offset:8448
    ds_read_b64_tr_b16 v[138:139], v146 offset:8640
    ds_read_b64_tr_b16 v[140:141], v146 offset:9216
    ds_read_b64_tr_b16 v[142:143], v146 offset:9408
    s_setprio 1
    v_exp_f32 v10, v10
    v_exp_f32 v11, v11
    v_exp_f32 v12, v12
    v_exp_f32 v13, v13
    s_waitcnt lgkmcnt(4)
    v_mfma_f32_32x32x4_2b_bf16 v[40:71], v[126:127], v[112:113], 0
    v_exp_f32 v14, v14
    v_exp_f32 v15, v15
    v_exp_f32 v16, v16
    v_exp_f32 v17, v17
    v_exp_f32 v18, v18
    v_exp_f32 v19, v19
    v_exp_f32 v20, v20
    v_exp_f32 v21, v21
    v_smfmac_f32_32x32x32_bf16 v[72:87], v[128:131], v[8:15], v114
    s_setprio 0
    v_exp_f32 v22, v22
    v_exp_f32 v23, v23
    v_exp_f32 v24, v24
    v_exp_f32 v25, v25
    v_smfmac_f32_32x32x32_bf16 v[72:87], v[132:135], v[16:23], v114
    s_waitcnt vmcnt(0) lgkmcnt(0)
    s_barrier
    ds_read_b64 v[124:125], v145 offset:22528
    ds_read_b128 v[116:119], v144 offset:22528
    s_setprio 3
    v_exp_f32 v26, v26
    v_exp_f32 v27, v27
    v_exp_f32 v28, v28
    v_exp_f32 v29, v29
    v_mfma_f32_32x32x16_bf16 v[40:55], v[120:123], v[104:107], v[40:55]
    s_add_u32 m0, s68, 0
    s_nop 0
    buffer_load_dwordx4 v1, s[4:7], s56 offen offset:0 sc1 lds
    v_exp_f32 v30, v30
    v_exp_f32 v31, v31
    v_exp_f32 v32, v32
    v_exp_f32 v33, v33
    v_smfmac_f32_32x32x32_bf16 v[88:103], v[128:131], v[24:31], v114
    v_exp_f32 v34, v34
    v_exp_f32 v35, v35
    v_exp_f32 v36, v36
    v_exp_f32 v37, v37
    v_mfma_f32_32x32x16_bf16 v[56:71], v[120:123], v[108:111], v[56:71]
    buffer_load_dwordx4 v1, s[4:7], s56 offen offset:1024 sc1 lds
    v_exp_f32 v38, v38
    v_exp_f32 v39, v39
    v_exp_f32 v40, v40
    v_exp_f32 v41, v41
    v_smfmac_f32_32x32x32_bf16 v[88:103], v[132:135], v[32:39], v114
    ds_read_b64_tr_b16 v[128:129], v146 offset:22528
    ds_read_b64_tr_b16 v[130:131], v146 offset:22720
    ds_read_b64_tr_b16 v[132:133], v146 offset:23296
    ds_read_b64_tr_b16 v[134:135], v146 offset:23488
    v_exp_f32 v42, v42
    v_exp_f32 v43, v43
    v_exp_f32 v44, v44
    v_exp_f32 v45, v45
    s_waitcnt lgkmcnt(4)
    v_mfma_f32_32x32x4_2b_bf16 v[8:39], v[124:125], v[112:113], 0
    buffer_load_dwordx4 v1, s[4:7], s56 offen offset:1792 sc1 lds
    v_exp_f32 v46, v46
    v_exp_f32 v47, v47
    v_exp_f32 v48, v48
    v_exp_f32 v49, v49
    v_exp_f32 v50, v50
    v_exp_f32 v51, v51
    v_exp_f32 v52, v52
    v_exp_f32 v53, v53
    v_smfmac_f32_32x32x32_bf16 v[72:87], v[136:139], v[40:47], v114
    s_add_u32 m0, s66, 8192
    s_add_u32 s54, s65, 8192
    buffer_load_dwordx4 v1, s[4:7], s54 offen offset:0 sc1 lds
    v_exp_f32 v54, v54
    v_exp_f32 v55, v55
    v_exp_f32 v56, v56
    v_exp_f32 v57, v57
    v_smfmac_f32_32x32x32_bf16 v[72:87], v[140:143], v[48:55], v114
    ds_read_b64 v[126:127], v145 offset:25344
    ds_read_b128 v[120:123], v144 offset:25344
    v_exp_f32 v58, v58
    v_exp_f32 v59, v59
    v_exp_f32 v60, v60
    v_exp_f32 v61, v61
    v_mfma_f32_32x32x16_bf16 v[8:23], v[116:119], v[104:107], v[8:23]
    buffer_load_dwordx4 v1, s[4:7], s54 offen offset:1024 sc1 lds
    v_exp_f32 v62, v62
    v_exp_f32 v63, v63
    v_exp_f32 v64, v64
    v_exp_f32 v65, v65
    v_smfmac_f32_32x32x32_bf16 v[88:103], v[136:139], v[56:63], v114
    v_exp_f32 v66, v66
    v_exp_f32 v67, v67
    v_exp_f32 v68, v68
    v_exp_f32 v69, v69
    v_mfma_f32_32x32x16_bf16 v[24:39], v[116:119], v[108:111], v[24:39]
    v_exp_f32 v70, v70
    v_exp_f32 v71, v71
    v_exp_f32 v8, v8
    v_exp_f32 v9, v9
    v_smfmac_f32_32x32x32_bf16 v[88:103], v[140:143], v[64:71], v114
    ds_read_b64_tr_b16 v[136:137], v146 offset:25344
    ds_read_b64_tr_b16 v[138:139], v146 offset:25536
    ds_read_b64_tr_b16 v[140:141], v146 offset:26112
    ds_read_b64_tr_b16 v[142:143], v146 offset:26304
    v_exp_f32 v10, v10
    v_exp_f32 v11, v11
    v_exp_f32 v12, v12
    v_exp_f32 v13, v13
    s_waitcnt lgkmcnt(4)
    v_mfma_f32_32x32x4_2b_bf16 v[40:71], v[126:127], v[112:113], 0
    v_exp_f32 v14, v14
    v_exp_f32 v15, v15
    v_exp_f32 v16, v16
    v_exp_f32 v17, v17
    v_exp_f32 v18, v18
    v_exp_f32 v19, v19
    v_exp_f32 v20, v20
    v_exp_f32 v21, v21
    v_smfmac_f32_32x32x32_bf16 v[72:87], v[128:131], v[8:15], v114
    v_exp_f32 v22, v22
    v_exp_f32 v23, v23
    v_exp_f32 v24, v24
    v_exp_f32 v25, v25
    v_smfmac_f32_32x32x32_bf16 v[72:87], v[132:135], v[16:23], v114
    ds_read_b64 v[124:125], v145 offset:28160
    ds_read_b128 v[116:119], v144 offset:28160
    v_exp_f32 v26, v26
    v_exp_f32 v27, v27
    v_exp_f32 v28, v28
    v_exp_f32 v29, v29
    v_mfma_f32_32x32x16_bf16 v[40:55], v[120:123], v[104:107], v[40:55]
    v_exp_f32 v30, v30
    v_exp_f32 v31, v31
    v_exp_f32 v32, v32
    v_exp_f32 v33, v33
    v_smfmac_f32_32x32x32_bf16 v[88:103], v[128:131], v[24:31], v114
    v_exp_f32 v34, v34
    v_exp_f32 v35, v35
    v_exp_f32 v36, v36
    v_exp_f32 v37, v37
    v_mfma_f32_32x32x16_bf16 v[56:71], v[120:123], v[108:111], v[56:71]
    v_exp_f32 v38, v38
    v_exp_f32 v39, v39
    v_exp_f32 v40, v40
    v_exp_f32 v41, v41
    v_smfmac_f32_32x32x32_bf16 v[88:103], v[132:135], v[32:39], v114
    ds_read_b64_tr_b16 v[128:129], v146 offset:28160
    ds_read_b64_tr_b16 v[130:131], v146 offset:28352
    ds_read_b64_tr_b16 v[132:133], v146 offset:28928
    ds_read_b64_tr_b16 v[134:135], v146 offset:29120
    s_setprio 2
    v_exp_f32 v42, v42
    v_exp_f32 v43, v43
    v_exp_f32 v44, v44
    v_exp_f32 v45, v45
    s_waitcnt lgkmcnt(4)
    v_mfma_f32_32x32x4_2b_bf16 v[8:39], v[124:125], v[112:113], 0
    v_exp_f32 v46, v46
    v_exp_f32 v47, v47
    v_exp_f32 v48, v48
    v_exp_f32 v49, v49
    v_exp_f32 v50, v50
    v_exp_f32 v51, v51
    v_exp_f32 v52, v52
    v_exp_f32 v53, v53
    v_smfmac_f32_32x32x32_bf16 v[72:87], v[136:139], v[40:47], v114
    v_exp_f32 v54, v54
    v_exp_f32 v55, v55
    v_exp_f32 v56, v56
    v_exp_f32 v57, v57
    v_smfmac_f32_32x32x32_bf16 v[72:87], v[140:143], v[48:55], v114
    ds_read_b64 v[126:127], v145 offset:30976
    ds_read_b128 v[120:123], v144 offset:30976
    v_exp_f32 v58, v58
    v_exp_f32 v59, v59
    v_exp_f32 v60, v60
    v_exp_f32 v61, v61
    v_mfma_f32_32x32x16_bf16 v[8:23], v[116:119], v[104:107], v[8:23]
    s_add_u32 s56, 7, s90
    s_and_b32 s56, s56, 7
    s_mul_i32 s56, s56, 22528
    s_add_u32 s56, s56, s61
    v_exp_f32 v62, v62
    v_exp_f32 v63, v63
    v_exp_f32 v64, v64
    v_exp_f32 v65, v65
    v_smfmac_f32_32x32x32_bf16 v[88:103], v[136:139], v[56:63], v114
    v_exp_f32 v66, v66
    v_exp_f32 v67, v67
    v_exp_f32 v68, v68
    v_exp_f32 v69, v69
    v_mfma_f32_32x32x16_bf16 v[24:39], v[116:119], v[108:111], v[24:39]
    v_exp_f32 v70, v70
    v_exp_f32 v71, v71
    v_exp_f32 v8, v8
    v_exp_f32 v9, v9
    v_smfmac_f32_32x32x32_bf16 v[88:103], v[140:143], v[64:71], v114
    ds_read_b64_tr_b16 v[136:137], v146 offset:30976
    ds_read_b64_tr_b16 v[138:139], v146 offset:31168
    ds_read_b64_tr_b16 v[140:141], v146 offset:31744
    ds_read_b64_tr_b16 v[142:143], v146 offset:31936
    s_setprio 1
    v_exp_f32 v10, v10
    v_exp_f32 v11, v11
    v_exp_f32 v12, v12
    v_exp_f32 v13, v13
    s_waitcnt lgkmcnt(4)
    v_mfma_f32_32x32x4_2b_bf16 v[40:71], v[126:127], v[112:113], 0
    v_exp_f32 v14, v14
    v_exp_f32 v15, v15
    v_exp_f32 v16, v16
    v_exp_f32 v17, v17
    v_exp_f32 v18, v18
    v_exp_f32 v19, v19
    v_exp_f32 v20, v20
    v_exp_f32 v21, v21
    v_smfmac_f32_32x32x32_bf16 v[72:87], v[128:131], v[8:15], v114
    s_setprio 0
    v_exp_f32 v22, v22
    v_exp_f32 v23, v23
    v_exp_f32 v24, v24
    v_exp_f32 v25, v25
    v_smfmac_f32_32x32x32_bf16 v[72:87], v[132:135], v[16:23], v114
    s_waitcnt vmcnt(0) lgkmcnt(0)
    s_barrier
    ds_read_b64 v[124:125], v145 offset:0
    ds_read_b128 v[116:119], v144 offset:0
    s_setprio 3
    v_exp_f32 v26, v26
    v_exp_f32 v27, v27
    v_exp_f32 v28, v28
    v_exp_f32 v29, v29
    v_mfma_f32_32x32x16_bf16 v[40:55], v[120:123], v[104:107], v[40:55]
    s_add_u32 m0, s68, 22528
    s_nop 0
    buffer_load_dwordx4 v1, s[4:7], s56 offen offset:0 sc1 lds
    v_exp_f32 v30, v30
    v_exp_f32 v31, v31
    v_exp_f32 v32, v32
    v_exp_f32 v33, v33
    v_smfmac_f32_32x32x32_bf16 v[88:103], v[128:131], v[24:31], v114
    v_exp_f32 v34, v34
    v_exp_f32 v35, v35
    v_exp_f32 v36, v36
    v_exp_f32 v37, v37
    v_mfma_f32_32x32x16_bf16 v[56:71], v[120:123], v[108:111], v[56:71]
    buffer_load_dwordx4 v1, s[4:7], s56 offen offset:1024 sc1 lds
    v_exp_f32 v38, v38
    v_exp_f32 v39, v39
    v_exp_f32 v40, v40
    v_exp_f32 v41, v41
    v_smfmac_f32_32x32x32_bf16 v[88:103], v[132:135], v[32:39], v114
    ds_read_b64_tr_b16 v[128:129], v146 offset:0
    ds_read_b64_tr_b16 v[130:131], v146 offset:192
    ds_read_b64_tr_b16 v[132:133], v146 offset:768
    ds_read_b64_tr_b16 v[134:135], v146 offset:960
    v_exp_f32 v42, v42
    v_exp_f32 v43, v43
    v_exp_f32 v44, v44
    v_exp_f32 v45, v45
    s_waitcnt lgkmcnt(4)
    v_mfma_f32_32x32x4_2b_bf16 v[8:39], v[124:125], v[112:113], 0
    buffer_load_dwordx4 v1, s[4:7], s56 offen offset:1792 sc1 lds
    v_exp_f32 v46, v46
    v_exp_f32 v47, v47
    v_exp_f32 v48, v48
    v_exp_f32 v49, v49
    v_exp_f32 v50, v50
    v_exp_f32 v51, v51
    v_exp_f32 v52, v52
    v_exp_f32 v53, v53
    v_smfmac_f32_32x32x32_bf16 v[72:87], v[136:139], v[40:47], v114
    s_add_u32 m0, s66, 10240
    s_add_u32 s54, s65, 10240
    buffer_load_dwordx4 v1, s[4:7], s54 offen offset:0 sc1 lds
    v_exp_f32 v54, v54
    v_exp_f32 v55, v55
    v_exp_f32 v56, v56
    v_exp_f32 v57, v57
    v_smfmac_f32_32x32x32_bf16 v[72:87], v[140:143], v[48:55], v114
    ds_read_b64 v[126:127], v145 offset:2816
    ds_read_b128 v[120:123], v144 offset:2816
    v_exp_f32 v58, v58
    v_exp_f32 v59, v59
    v_exp_f32 v60, v60
    v_exp_f32 v61, v61
    v_mfma_f32_32x32x16_bf16 v[8:23], v[116:119], v[104:107], v[8:23]
    buffer_load_dwordx4 v1, s[4:7], s54 offen offset:1024 sc1 lds
    v_exp_f32 v62, v62
    v_exp_f32 v63, v63
    v_exp_f32 v64, v64
    v_exp_f32 v65, v65
    v_smfmac_f32_32x32x32_bf16 v[88:103], v[136:139], v[56:63], v114
    v_exp_f32 v66, v66
    v_exp_f32 v67, v67
    v_exp_f32 v68, v68
    v_exp_f32 v69, v69
    v_mfma_f32_32x32x16_bf16 v[24:39], v[116:119], v[108:111], v[24:39]
    buffer_load_dwordx4 v1, s[4:7], s54 offen offset:1536 sc1 lds
    v_exp_f32 v70, v70
    v_exp_f32 v71, v71
    v_exp_f32 v8, v8
    v_exp_f32 v9, v9
    v_smfmac_f32_32x32x32_bf16 v[88:103], v[140:143], v[64:71], v114
    ds_read_b64_tr_b16 v[136:137], v146 offset:2816
    ds_read_b64_tr_b16 v[138:139], v146 offset:3008
    ds_read_b64_tr_b16 v[140:141], v146 offset:3584
    ds_read_b64_tr_b16 v[142:143], v146 offset:3776
    v_exp_f32 v10, v10
    v_exp_f32 v11, v11
    v_exp_f32 v12, v12
    v_exp_f32 v13, v13
    s_waitcnt lgkmcnt(4)
    v_mfma_f32_32x32x4_2b_bf16 v[40:71], v[126:127], v[112:113], 0
    s_cbranch_vccz L_fo_99
    s_lshl_b32 s52, s37, 12
    s_add_u32 s52, s52, 65556
    v_and_b32 v5, 31, v0
    v_lshlrev_b32 v5, 7, v5
    buffer_load_dword v4, v5, s[4:7], s52 offen sc1
L_fo_99:
    v_exp_f32 v14, v14
    v_exp_f32 v15, v15
    v_exp_f32 v16, v16
    v_exp_f32 v17, v17
    v_exp_f32 v18, v18
    v_exp_f32 v19, v19
    v_exp_f32 v20, v20
    v_exp_f32 v21, v21
    v_smfmac_f32_32x32x32_bf16 v[72:87], v[128:131], v[8:15], v114
    v_exp_f32 v22, v22
    v_exp_f32 v23, v23
    v_exp_f32 v24, v24
    v_exp_f32 v25, v25
    v_smfmac_f32_32x32x32_bf16 v[72:87], v[132:135], v[16:23], v114
    ds_read_b64 v[124:125], v145 offset:5632
    ds_read_b128 v[116:119], v144 offset:5632
    v_exp_f32 v26, v26
    v_exp_f32 v27, v27
    v_exp_f32 v28, v28
    v_exp_f32 v29, v29
    v_mfma_f32_32x32x16_bf16 v[40:55], v[120:123], v[104:107], v[40:55]
    v_exp_f32 v30, v30
    v_exp_f32 v31, v31
    v_exp_f32 v32, v32
    v_exp_f32 v33, v33
    v_smfmac_f32_32x32x32_bf16 v[88:103], v[128:131], v[24:31], v114
    v_exp_f32 v34, v34
    v_exp_f32 v35, v35
    v_exp_f32 v36, v36
    v_exp_f32 v37, v37
    v_mfma_f32_32x32x16_bf16 v[56:71], v[120:123], v[108:111], v[56:71]
    v_exp_f32 v38, v38
    v_exp_f32 v39, v39
    v_exp_f32 v40, v40
    v_exp_f32 v41, v41
    v_smfmac_f32_32x32x32_bf16 v[88:103], v[132:135], v[32:39], v114
    ds_read_b64_tr_b16 v[128:129], v146 offset:5632
    ds_read_b64_tr_b16 v[130:131], v146 offset:5824
    ds_read_b64_tr_b16 v[132:133], v146 offset:6400
    ds_read_b64_tr_b16 v[134:135], v146 offset:6592
    s_setprio 2
    v_exp_f32 v42, v42
    v_exp_f32 v43, v43
    v_exp_f32 v44, v44
    v_exp_f32 v45, v45
    s_waitcnt lgkmcnt(4)
    v_mfma_f32_32x32x4_2b_bf16 v[8:39], v[124:125], v[112:113], 0
    v_exp_f32 v46, v46
    v_exp_f32 v47, v47
    v_exp_f32 v48, v48
    v_exp_f32 v49, v49
    v_exp_f32 v50, v50
    v_exp_f32 v51, v51
    v_exp_f32 v52, v52
    v_exp_f32 v53, v53
    v_smfmac_f32_32x32x32_bf16 v[72:87], v[136:139], v[40:47], v114
    v_exp_f32 v54, v54
    v_exp_f32 v55, v55
    v_exp_f32 v56, v56
    v_exp_f32 v57, v57
    v_smfmac_f32_32x32x32_bf16 v[72:87], v[140:143], v[48:55], v114
    ds_read_b64 v[126:127], v145 offset:8448
    ds_read_b128 v[120:123], v144 offset:8448
    v_exp_f32 v58, v58
    v_exp_f32 v59, v59
    v_exp_f32 v60, v60
    v_exp_f32 v61, v61
    v_mfma_f32_32x32x16_bf16 v[8:23], v[116:119], v[104:107], v[8:23]
    v_exp_f32 v62, v62
    v_exp_f32 v63, v63
    v_exp_f32 v64, v64
    v_exp_f32 v65, v65
    v_smfmac_f32_32x32x32_bf16 v[88:103], v[136:139], v[56:63], v114
    v_exp_f32 v66, v66
    v_exp_f32 v67, v67
    v_exp_f32 v68, v68
    v_exp_f32 v69, v69
    v_mfma_f32_32x32x16_bf16 v[24:39], v[116:119], v[108:111], v[24:39]
    v_exp_f32 v70, v70
    v_exp_f32 v71, v71
    v_exp_f32 v8, v8
    v_exp_f32 v9, v9
    v_smfmac_f32_32x32x32_bf16 v[88:103], v[140:143], v[64:71], v114
    ds_read_b64_tr_b16 v[136:137], v146 offset:8448
    ds_read_b64_tr_b16 v[138:139], v146 offset:8640
    ds_read_b64_tr_b16 v[140:141], v146 offset:9216
    ds_read_b64_tr_b16 v[142:143], v146 offset:9408
    s_setprio 1
    v_exp_f32 v10, v10
    v_exp_f32 v11, v11
    v_exp_f32 v12, v12
    v_exp_f32 v13, v13
    s_waitcnt lgkmcnt(4)
    v_mfma_f32_32x32x4_2b_bf16 v[40:71], v[126:127], v[112:113], 0
    v_exp_f32 v14, v14
    v_exp_f32 v15, v15
    v_exp_f32 v16, v16
    v_exp_f32 v17, v17
    v_exp_f32 v18, v18
    v_exp_f32 v19, v19
    v_exp_f32 v20, v20
    v_exp_f32 v21, v21
    v_smfmac_f32_32x32x32_bf16 v[72:87], v[128:131], v[8:15], v114
    s_setprio 0
    v_exp_f32 v22, v22
    v_exp_f32 v23, v23
    v_exp_f32 v24, v24
    v_exp_f32 v25, v25
    v_smfmac_f32_32x32x32_bf16 v[72:87], v[132:135], v[16:23], v114
    s_waitcnt vmcnt(0) lgkmcnt(0)
    s_barrier
    ds_read_b64 v[124:125], v145 offset:22528
    ds_read_b128 v[116:119], v144 offset:22528
    s_setprio 3
    v_exp_f32 v26, v26
    v_exp_f32 v27, v27
    v_exp_f32 v28, v28
    v_exp_f32 v29, v29
    v_mfma_f32_32x32x16_bf16 v[40:55], v[120:123], v[104:107], v[40:55]
    s_cbranch_vccnz L_fo_94
    buffer_load_dwordx4 v[232:235], v1, s[4:7], s80 offen offset:0 sc1
L_fo_94:
    v_exp_f32 v30, v30
    v_exp_f32 v31, v31
    v_exp_f32 v32, v32
    v_exp_f32 v33, v33
    v_smfmac_f32_32x32x32_bf16 v[88:103], v[128:131], v[24:31], v114
    v_exp_f32 v34, v34
    v_exp_f32 v35, v35
    v_exp_f32 v36, v36
    v_exp_f32 v37, v37
    v_mfma_f32_32x32x16_bf16 v[56:71], v[120:123], v[108:111], v[56:71]
    s_cbranch_vccnz L_fo_95
    buffer_load_dwordx4 v[236:239], v1, s[4:7], s80 offen offset:1024 sc1
L_fo_95:
    v_exp_f32 v38, v38
    v_exp_f32 v39, v39
    v_exp_f32 v40, v40
    v_exp_f32 v41, v41
    v_smfmac_f32_32x32x32_bf16 v[88:103], v[132:135], v[32:39], v114
    ds_read_b64_tr_b16 v[128:129], v146 offset:22528
    ds_read_b64_tr_b16 v[130:131], v146 offset:22720
    ds_read_b64_tr_b16 v[132:133], v146 offset:23296
    ds_read_b64_tr_b16 v[134:135], v146 offset:23488
    v_exp_f32 v42, v42
    v_exp_f32 v43, v43
    v_exp_f32 v44, v44
    v_exp_f32 v45, v45
    s_waitcnt lgkmcnt(4)
    v_mfma_f32_32x32x4_2b_bf16 v[8:39], v[124:125], v[112:113], 0
    s_cbranch_vccnz L_fo_96
    buffer_load_dwordx4 v[240:243], v1, s[4:7], s80 offen offset:2048 sc1
L_fo_96:
    v_exp_f32 v46, v46
    v_exp_f32 v47, v47
    v_exp_f32 v48, v48
    v_exp_f32 v49, v49
    v_exp_f32 v50, v50
    v_exp_f32 v51, v51
    v_exp_f32 v52, v52
    v_exp_f32 v53, v53
    v_smfmac_f32_32x32x32_bf16 v[72:87], v[136:139], v[40:47], v114
    s_cbranch_vccnz L_fo_97
    buffer_load_dwordx4 v[244:247], v1, s[4:7], s80 offen offset:3072 sc1
L_fo_97:
    v_exp_f32 v54, v54
    v_exp_f32 v55, v55
    v_exp_f32 v56, v56
    v_exp_f32 v57, v57
    v_smfmac_f32_32x32x32_bf16 v[72:87], v[140:143], v[48:55], v114
    ds_read_b64 v[126:127], v145 offset:25344
    ds_read_b128 v[120:123], v144 offset:25344
    v_exp_f32 v58, v58
    v_exp_f32 v59, v59
    v_exp_f32 v60, v60
    v_exp_f32 v61, v61
    v_mfma_f32_32x32x16_bf16 v[8:23], v[116:119], v[104:107], v[8:23]
    v_exp_f32 v62, v62
    v_exp_f32 v63, v63
    v_exp_f32 v64, v64
    v_exp_f32 v65, v65
    v_smfmac_f32_32x32x32_bf16 v[88:103], v[136:139], v[56:63], v114
    v_exp_f32 v66, v66
    v_exp_f32 v67, v67
    v_exp_f32 v68, v68
    v_exp_f32 v69, v69
    v_mfma_f32_32x32x16_bf16 v[24:39], v[116:119], v[108:111], v[24:39]
    s_cbranch_vccnz L_fo_98
    buffer_load_dwordx4 v[248:251], v1, s[4:7], s81 offen offset:0 sc1
L_fo_98:
    v_exp_f32 v70, v70
    v_exp_f32 v71, v71
    s_cbranch_vccz L_xs_100
    s_cmp_ge_u32 s36, 4
    s_cbranch_scc1 L_xs_100
    v_cmp_gt_u32 vcc, 1, v4
    s_nop 0
    s_cbranch_vccnz L_x3_wait
L_xs_100:
L_x3_ok:
    v_exp_f32 v8, v8
    v_exp_f32 v9, v9
    v_smfmac_f32_32x32x32_bf16 v[88:103], v[140:143], v[64:71], v114
    ds_read_b64_tr_b16 v[136:137], v146 offset:25344
    ds_read_b64_tr_b16 v[138:139], v146 offset:25536
    ds_read_b64_tr_b16 v[140:141], v146 offset:26112
    ds_read_b64_tr_b16 v[142:143], v146 offset:26304
    v_exp_f32 v10, v10
    v_exp_f32 v11, v11
    v_exp_f32 v12, v12
    v_exp_f32 v13, v13
    s_waitcnt lgkmcnt(4)
    v_mfma_f32_32x32x4_2b_bf16 v[40:71], v[126:127], v[112:113], 0
    s_cbranch_vccnz L_fo_101
    buffer_load_dwordx4 v[176:179], v150, s[4:7], s84 offen sc1
L_fo_101:
    v_exp_f32 v14, v14
    v_exp_f32 v15, v15
    v_exp_f32 v16, v16
    v_exp_f32 v17, v17
    v_exp_f32 v18, v18
    v_exp_f32 v19, v19
    v_exp_f32 v20, v20
    v_exp_f32 v21, v21
    v_smfmac_f32_32x32x32_bf16 v[72:87], v[128:131], v[8:15], v114
    v_exp_f32 v22, v22
    v_exp_f32 v23, v23
    v_exp_f32 v24, v24
    v_exp_f32 v25, v25
    v_smfmac_f32_32x32x32_bf16 v[72:87], v[132:135], v[16:23], v114
    ds_read_b64 v[124:125], v145 offset:28160
    ds_read_b128 v[116:119], v144 offset:28160
    v_exp_f32 v26, v26
    v_exp_f32 v27, v27
    v_exp_f32 v28, v28
    v_exp_f32 v29, v29
    v_mfma_f32_32x32x16_bf16 v[40:55], v[120:123], v[104:107], v[40:55]
    s_cbranch_vccnz L_fo_102
    buffer_load_dwordx4 v[180:183], v150, s[4:7], s86 offen sc1
L_fo_102:
    v_exp_f32 v30, v30
    v_exp_f32 v31, v31
    v_exp_f32 v32, v32
    v_exp_f32 v33, v33
    v_smfmac_f32_32x32x32_bf16 v[88:103], v[128:131], v[24:31], v114
    v_exp_f32 v34, v34
    v_exp_f32 v35, v35
    v_exp_f32 v36, v36
    v_exp_f32 v37, v37
    v_mfma_f32_32x32x16_bf16 v[56:71], v[120:123], v[108:111], v[56:71]
    v_exp_f32 v38, v38
    v_exp_f32 v39, v39
    v_exp_f32 v40, v40
    v_exp_f32 v41, v41
    v_smfmac_f32_32x32x32_bf16 v[88:103], v[132:135], v[32:39], v114
    ds_read_b64_tr_b16 v[128:129], v146 offset:28160
    ds_read_b64_tr_b16 v[130:131], v146 offset:28352
    ds_read_b64_tr_b16 v[132:133], v146 offset:28928
    ds_read_b64_tr_b16 v[134:135], v146 offset:29120
    s_setprio 2
    v_exp_f32 v42, v42
    v_exp_f32 v43, v43
    v_exp_f32 v44, v44
    v_exp_f32 v45, v45
    s_waitcnt lgkmcnt(4)
    v_mfma_f32_32x32x4_2b_bf16 v[8:39], v[124:125], v[112:113], 0
    s_cbranch_vccnz L_fo_103
    buffer_load_dwordx4 v[184:187], v150, s[4:7], s87 offen sc1
L_fo_103:
    v_exp_f32 v46, v46
    v_exp_f32 v47, v47
    v_exp_f32 v48, v48
    v_exp_f32 v49, v49
    v_exp_f32 v50, v50
    v_exp_f32 v51, v51
    v_exp_f32 v52, v52
    v_exp_f32 v53, v53
    v_smfmac_f32_32x32x32_bf16 v[72:87], v[136:139], v[40:47], v114
    v_exp_f32 v54, v54
    v_exp_f32 v55, v55
    v_exp_f32 v56, v56
    v_exp_f32 v57, v57
    v_smfmac_f32_32x32x32_bf16 v[72:87], v[140:143], v[48:55], v114
    ds_read_b64 v[126:127], v145 offset:30976
    ds_read_b128 v[120:123], v144 offset:30976
    v_exp_f32 v58, v58
    v_exp_f32 v59, v59
    v_exp_f32 v60, v60
    v_exp_f32 v61, v61
    v_mfma_f32_32x32x16_bf16 v[8:23], v[116:119], v[104:107], v[8:23]
    s_cbranch_vccnz L_fo_104
    buffer_load_dwordx4 v[188:191], v150, s[4:7], s92 offen sc1
L_fo_104:
    v_exp_f32 v62, v62
    v_exp_f32 v63, v63
    v_exp_f32 v64, v64
    v_exp_f32 v65, v65
    v_smfmac_f32_32x32x32_bf16 v[88:103], v[136:139], v[56:63], v114
    v_exp_f32 v66, v66
    v_exp_f32 v67, v67
    v_exp_f32 v68, v68
    v_exp_f32 v69, v69
    v_mfma_f32_32x32x16_bf16 v[24:39], v[116:119], v[108:111], v[24:39]
    v_exp_f32 v70, v70
    v_exp_f32 v71, v71
    v_exp_f32 v8, v8
    v_exp_f32 v9, v9
    v_smfmac_f32_32x32x32_bf16 v[88:103], v[140:143], v[64:71], v114
    ds_read_b64_tr_b16 v[136:137], v146 offset:30976
    ds_read_b64_tr_b16 v[138:139], v146 offset:31168
    ds_read_b64_tr_b16 v[140:141], v146 offset:31744
    ds_read_b64_tr_b16 v[142:143], v146 offset:31936
    s_setprio 1
    v_exp_f32 v10, v10
    v_exp_f32 v11, v11
    v_exp_f32 v12, v12
    v_exp_f32 v13, v13
    s_waitcnt lgkmcnt(4)
    v_mfma_f32_32x32x4_2b_bf16 v[40:71], v[126:127], v[112:113], 0
    s_cbranch_vccnz L_fo_105
    buffer_load_dwordx4 v[192:195], v6, s[4:7], s85 offen sc1
L_fo_105:
    v_exp_f32 v14, v14
    v_exp_f32 v15, v15
    v_exp_f32 v16, v16
    v_exp_f32 v17, v17
    v_exp_f32 v18, v18
    v_exp_f32 v19, v19
    v_exp_f32 v20, v20
    v_exp_f32 v21, v21
    v_smfmac_f32_32x32x32_bf16 v[72:87], v[128:131], v[8:15], v114
    s_setprio 0
    v_exp_f32 v22, v22
    v_exp_f32 v23, v23
    v_exp_f32 v24, v24
    v_exp_f32 v25, v25
    v_smfmac_f32_32x32x32_bf16 v[72:87], v[132:135], v[16:23], v114
    s_waitcnt vmcnt(63) lgkmcnt(0)
    s_barrier
    s_setprio 3
    v_exp_f32 v26, v26
    v_exp_f32 v27, v27
    v_exp_f32 v28, v28
    v_exp_f32 v29, v29
    v_mfma_f32_32x32x16_bf16 v[40:55], v[120:123], v[104:107], v[40:55]
    v_exp_f32 v30, v30
    v_exp_f32 v31, v31
    v_exp_f32 v32, v32
    v_exp_f32 v33, v33
    v_smfmac_f32_32x32x32_bf16 v[88:103], v[128:131], v[24:31], v114
    v_exp_f32 v34, v34
    v_exp_f32 v35, v35
    v_exp_f32 v36, v36
    v_exp_f32 v37, v37
    v_mfma_f32_32x32x16_bf16 v[56:71], v[120:123], v[108:111], v[56:71]
    v_exp_f32 v38, v38
    v_exp_f32 v39, v39
    v_exp_f32 v40, v40
    v_exp_f32 v41, v41
    v_smfmac_f32_32x32x32_bf16 v[88:103], v[132:135], v[32:39], v114
    v_exp_f32 v42, v42
    v_exp_f32 v43, v43
    v_exp_f32 v44, v44
    v_exp_f32 v45, v45
    v_exp_f32 v46, v46
    v_exp_f32 v47, v47
    v_exp_f32 v48, v48
    v_exp_f32 v49, v49
    v_exp_f32 v50, v50
    v_exp_f32 v51, v51
    v_exp_f32 v52, v52
    v_exp_f32 v53, v53
    v_smfmac_f32_32x32x32_bf16 v[72:87], v[136:139], v[40:47], v114
    v_exp_f32 v54, v54
    v_exp_f32 v55, v55
    v_exp_f32 v56, v56
    v_exp_f32 v57, v57
    v_smfmac_f32_32x32x32_bf16 v[72:87], v[140:143], v[48:55], v114
    v_exp_f32 v58, v58
    v_exp_f32 v59, v59
    v_exp_f32 v60, v60
    v_exp_f32 v61, v61
    v_exp_f32 v62, v62
    v_exp_f32 v63, v63
    v_exp_f32 v64, v64
    v_exp_f32 v65, v65
    v_smfmac_f32_32x32x32_bf16 v[88:103], v[136:139], v[56:63], v114
    v_exp_f32 v66, v66
    v_exp_f32 v67, v67
    v_exp_f32 v68, v68
    v_exp_f32 v69, v69
    v_exp_f32 v70, v70
    v_exp_f32 v71, v71
    s_nop 1
    v_smfmac_f32_32x32x32_bf16 v[88:103], v[140:143], v[64:71], v114
    s_setprio 0
L_merge:
    s_lshl_b32 s52, s36, 12
    s_add_u32 s53, s52, 102400
    v_add_u32 v2, s53, v1
    s_xor_b32 s52, s52, 16384
    s_add_u32 s53, s52, 102400
    v_add_u32 v4, s53, v1
    v_mov_b32 v3, 157764
    v_subrev_u32 v9, 0x17800000, v84
    s_nop 2
    ds_write_b128 v2, v[88:91] offset:0
    ds_write_b128 v2, v[92:95] offset:1024
    ds_write_b128 v2, v[96:99] offset:2048
    ds_write_b32 v2, v100 offset:3072
    v_subrev_u32 v10, 0x17800000, v100
    v_max_u32 v9, v9, v10
    v_cmp_lt_u32 vcc, 0x50000000, v9
    s_nop 0
    s_cbranch_vccz L_gd_107
    ds_write_b32 v3, v3
L_gd_107:
    s_waitcnt lgkmcnt(0)
    s_barrier
    ds_read_b32 v9, v3
    ds_read_b32 v28, v4 offset:3072
    ds_read_b128 v[16:19], v4 offset:0
    ds_read_b128 v[20:23], v4 offset:1024
    ds_read_b128 v[24:27], v4 offset:2048
    s_waitcnt lgkmcnt(3)
    v_cmp_ne_u32 vcc, 0, v9
    v_add_f32 v28, v28, v84
    s_cbranch_vccz L_ok_106
    s_cmp_eq_u32 s91, 0
    s_cbranch_scc1 L_fallback
L_ok_106:
    v_rcp_f32 v28, v28
    s_waitcnt lgkmcnt(0)
    v_mov_b32 v29, v28
    v_pk_add_f32 v[16:17], v[16:17], v[72:73]
    v_pk_add_f32 v[18:19], v[18:19], v[74:75]
    v_pk_add_f32 v[20:21], v[20:21], v[76:77]
    v_pk_add_f32 v[22:23], v[22:23], v[78:79]
    v_pk_add_f32 v[24:25], v[24:25], v[80:81]
    v_pk_add_f32 v[26:27], v[26:27], v[82:83]
    v_pk_mul_f32 v[16:17], v[16:17], v[28:29]
    v_pk_mul_f32 v[18:19], v[18:19], v[28:29]
    v_pk_mul_f32 v[20:21], v[20:21], v[28:29]
    v_pk_mul_f32 v[22:23], v[22:23], v[28:29]
    v_pk_mul_f32 v[24:25], v[24:25], v[28:29]
    v_pk_mul_f32 v[26:27], v[26:27], v[28:29]
    v_cvt_pk_bf16_f32 v32, v16, v17
    v_cvt_pk_bf16_f32 v33, v18, v19
    v_cvt_pk_bf16_f32 v34, v20, v21
    v_cvt_pk_bf16_f32 v35, v22, v23
    v_cvt_pk_bf16_f32 v36, v24, v25
    v_cvt_pk_bf16_f32 v37, v26, v27
    buffer_store_dwordx4 v[32:35], v148, s[4:7], s70 offen sc1
    s_mov_b32 exec_hi, 0
    buffer_store_dwordx2 v[36:37], v149, s[4:7], s71 offen sc1
    s_mov_b64 exec, -1
    s_barrier
    s_cmp_lg_u32 s36, 7
    s_cbranch_scc1 L_ow_113
    s_lshl_b32 s53, s90, 5
    s_add_u32 s53, s53, s38
    s_lshl_b32 s53, s53, 5
    s_add_u32 s53, s53, s42
    s_lshl_b32 s53, s53, 2
    s_add_u32 s53, s53, 65544
    s_atomic_add s75, s[4:5], s53
L_ow_113:
    s_waitcnt vmcnt(2)
    s_cmp_lt_u32 s36, 4
    s_cbranch_scc1 L_ph_108
    s_mov_b32 s91, 1
    s_cmp_eq_u32 s42, 0
    s_cbranch_scc1 L_c0
    s_branch L_c0_ret
L_ph_108:
    s_lshl_b32 s52, s41, 2
    s_add_u32 s52, s52, s36
    s_mul_i32 s60, s52, 20480
    s_add_u32 s60, s60, s50
    v_and_b32 v2, 15, v0
    v_lshrrev_b32 v3, 4, v0
    v_lshlrev_b32 v14, 8, v3
    v_lshl_add_u32 v14, v2, 3, v14
    v_add_u32 v15, 51200, v1
    s_add_u32 s61, s60, 4096
    s_add_u32 s62, s60, 8192
    s_add_u32 s63, s60, 12288
    s_add_u32 s64, s60, 16384
    s_cmp_lg_u32 s42, 0
    s_cbranch_scc1 L_px_112
    v_and_b32 v4, 1, v0
    v_cmp_eq_u32 vcc, 1, v4
    s_nop 1
    v_cndmask_b32 v40, v176, v178, vcc
    v_cndmask_b32 v41, v177, v179, vcc
    v_cndmask_b32 v42, v180, v182, vcc
    v_cndmask_b32 v43, v181, v183, vcc
    v_cndmask_b32 v44, v184, v186, vcc
    v_cndmask_b32 v45, v185, v187, vcc
    v_cndmask_b32 v46, v188, v190, vcc
    v_cndmask_b32 v47, v189, v191, vcc
    v_cndmask_b32 v48, v192, v194, vcc
    v_cndmask_b32 v49, v193, v195, vcc
    v_lshlrev_b32 v3, 2, v3
    v_sub_u32 v2, v2, v3
    v_mov_b32 v5, 0x3f80
    v_mov_b32 v6, 0x3f800000
    v_cmp_eq_u32 vcc, 0, v2
    s_nop 1
    v_cndmask_b32 v8, 0, v5, vcc
    v_cmp_eq_u32 vcc, 1, v2
    s_nop 1
    v_cndmask_b32 v8, v8, v6, vcc
    v_cmp_eq_u32 vcc, 2, v2
    s_nop 1
    v_cndmask_b32 v9, 0, v5, vcc
    v_cmp_eq_u32 vcc, 3, v2
    s_nop 1
    v_cndmask_b32 v9, v9, v6, vcc
    s_nop 1
    v_mfma_f32_16x16x16_bf16 v[156:159], v[40:41], v[8:9], 0
    v_mfma_f32_16x16x16_bf16 v[160:163], v[42:43], v[8:9], 0
    v_mfma_f32_16x16x16_bf16 v[164:167], v[44:45], v[8:9], 0
    v_mfma_f32_16x16x16_bf16 v[168:171], v[46:47], v[8:9], 0
    v_mfma_f32_16x16x16_bf16 v[172:175], v[48:49], v[8:9], 0
    s_branch L_pj_109
L_px_112:
    s_and_b32 s52, s36, 1
    s_lshl_b32 s52, s52, 10
    s_lshl_b32 s53, s37, 7
    s_add_u32 s52, s52, s53
    s_lshr_b32 s53, s36, 1
    s_lshl_b32 s53, s53, 6
    s_add_u32 s52, s52, s53
    s_and_b32 s53, s41, 3
    s_lshl_b32 s53, s53, 3
    s_add_u32 s52, s52, s53
    s_mul_i32 s53, s36, 2816
    s_add_u32 s53, s53, 133120
    v_mul_u32_u24 v6, 176, v2
    v_add_u32 v6, s53, v6
    v_lshl_add_u32 v7, v3, 3, v6
    v_lshl_add_u32 v6, v3, 4, v6
    v_add_u32 v4, 0, v0
    v_mul_u32_u24 v5, 205, v4
    v_lshrrev_b32 v5, 11, v5
    v_mul_u32_u24 v13, 10, v5
    v_sub_u32 v4, v4, v13
    v_lshlrev_b32 v4, 4, v4
    v_mul_u32_u24 v13, 176, v5
    v_add3_u32 v8, v13, v4, s53
    v_lshrrev_b32 v13, 3, v5
    v_lshlrev_b32 v13, 5, v13
    v_and_b32 v5, 7, v5
    v_add3_u32 v5, v5, v13, s52
    v_mul_u32_u24 v5, 1280, v5
    v_add_u32 v11, v5, v4
    v_add_u32 v4, 64, v0
    v_mul_u32_u24 v5, 205, v4
    v_lshrrev_b32 v5, 11, v5
    v_mul_u32_u24 v13, 10, v5
    v_sub_u32 v4, v4, v13
    v_lshlrev_b32 v4, 4, v4
    v_mul_u32_u24 v13, 176, v5
    v_add3_u32 v9, v13, v4, s53
    v_lshrrev_b32 v13, 3, v5
    v_lshlrev_b32 v13, 5, v13
    v_and_b32 v5, 7, v5
    v_add3_u32 v5, v5, v13, s52
    v_mul_u32_u24 v5, 1280, v5
    v_add_u32 v12, v5, v4
    v_add_u32 v4, 128, v0
    v_mul_u32_u24 v5, 205, v4
    v_lshrrev_b32 v5, 11, v5
    v_mul_u32_u24 v13, 10, v5
    v_sub_u32 v4, v4, v13
    v_lshlrev_b32 v4, 4, v4
    v_mul_u32_u24 v13, 176, v5
    v_add3_u32 v10, v13, v4, s53
    v_lshrrev_b32 v13, 3, v5
    v_lshlrev_b32 v13, 5, v13
    v_and_b32 v5, 7, v5
    v_add3_u32 v5, v5, v13, s52
    v_mul_u32_u24 v5, 1280, v5
    v_add_u32 v2, v5, v4
    s_mul_i32 s56, s39, 160
L_pj_109:
    s_setprio 2
    s_mov_b32 s65, 0
    s_mov_b64 s[94:95], -1
    s_lshl_b32 s54, s37, 12
    s_lshl_b32 s53, s42, 2
    s_add_u32 s54, s54, s53
    s_add_u32 s54, s54, 65544
    v_lshlrev_b32 v5, 7, v0
    s_mov_b32 exec_lo, 0xffffffff
    s_mov_b32 exec_hi, 0
    s_mov_b32 s52, s44
L_poll_114:
    buffer_load_dword v4, v5, s[4:7], s54 offen sc1
    s_add_u32 s52, s52, 1
    s_cmp_ge_u32 s52, 65536
    s_cselect_b32 s44, 65536, s44
    s_waitcnt vmcnt(0)
    s_cbranch_scc1 L_pd_115
    v_cmp_gt_u32 vcc, 1, v4
    s_nop 0
    s_cbranch_vccnz L_poll_114
L_pd_115:
    s_mov_b64 exec, -1
L_proj:
    buffer_load_dwordx4 v[16:19], v1, s[4:7], s60 offen offset:0 sc1
    buffer_load_dwordx4 v[20:23], v1, s[4:7], s60 offen offset:1024 sc1
    buffer_load_dwordx4 v[24:27], v1, s[4:7], s60 offen offset:2048 sc1
    buffer_load_dwordx4 v[28:31], v1, s[4:7], s60 offen offset:3072 sc1
    buffer_load_dwordx4 v[32:35], v1, s[4:7], s61 offen offset:0 sc1
    buffer_load_dwordx4 v[36:39], v1, s[4:7], s61 offen offset:1024 sc1
    buffer_load_dwordx4 v[40:43], v1, s[4:7], s61 offen offset:2048 sc1
    buffer_load_dwordx4 v[44:47], v1, s[4:7], s61 offen offset:3072 sc1
    ds_read_b128 v[96:99], v1 offset:0
    ds_read_b128 v[100:103], v1 offset:1024
    ds_read_b128 v[104:107], v1 offset:2048
    ds_read_b128 v[108:111], v1 offset:3072
    ds_read_b128 v[112:115], v1 offset:4096
    ds_read_b128 v[116:119], v1 offset:5120
    ds_read_b128 v[120:123], v1 offset:6144
    ds_read_b128 v[124:127], v1 offset:7168
    ds_read_b128 v[128:131], v1 offset:8192
    ds_read_b128 v[132:135], v1 offset:9216
    s_cmp_lg_u32 s42, 0
    s_cbranch_scc1 L_pf_110
    s_waitcnt vmcnt(7) lgkmcnt(5)
    v_mfma_f32_16x16x32_bf16 v[176:179], v[16:19], v[96:99], v[156:159]
    ds_read_b128 v[136:139], v1 offset:10240
    buffer_load_dwordx4 v[48:51], v1, s[4:7], s62 offen offset:0 sc1
    v_mfma_f32_16x16x32_bf16 v[180:183], v[16:19], v[100:103], v[160:163]
    ds_read_b128 v[140:143], v1 offset:11264
    v_mfma_f32_16x16x32_bf16 v[184:187], v[16:19], v[104:107], v[164:167]
    ds_read_b128 v[144:147], v1 offset:12288
    v_mfma_f32_16x16x32_bf16 v[188:191], v[16:19], v[108:111], v[168:171]
    ds_read_b128 v[148:151], v1 offset:13312
    v_mfma_f32_16x16x32_bf16 v[192:195], v[16:19], v[112:115], v[172:175]
    ds_read_b128 v[152:155], v1 offset:14336
    s_waitcnt vmcnt(7) lgkmcnt(5)
    v_mfma_f32_16x16x32_bf16 v[176:179], v[20:23], v[116:119], v[176:179]
    ds_read_b128 v[96:99], v1 offset:15360
    buffer_load_dwordx4 v[52:55], v1, s[4:7], s62 offen offset:1024 sc1
    v_mfma_f32_16x16x32_bf16 v[180:183], v[20:23], v[120:123], v[180:183]
    ds_read_b128 v[100:103], v1 offset:16384
    v_mfma_f32_16x16x32_bf16 v[184:187], v[20:23], v[124:127], v[184:187]
    ds_read_b128 v[104:107], v1 offset:17408
    v_mfma_f32_16x16x32_bf16 v[188:191], v[20:23], v[128:131], v[188:191]
    ds_read_b128 v[108:111], v1 offset:18432
    v_mfma_f32_16x16x32_bf16 v[192:195], v[20:23], v[132:135], v[192:195]
    ds_read_b128 v[112:115], v1 offset:19456
    s_waitcnt vmcnt(7) lgkmcnt(5)
    v_mfma_f32_16x16x32_bf16 v[176:179], v[24:27], v[136:139], v[176:179]
    ds_read_b128 v[116:119], v1 offset:20480
    buffer_load_dwordx4 v[56:59], v1, s[4:7], s62 offen offset:2048 sc1
    v_mfma_f32_16x16x32_bf16 v[180:183], v[24:27], v[140:143], v[180:183]
    ds_read_b128 v[120:123], v1 offset:21504
    v_mfma_f32_16x16x32_bf16 v[184:187], v[24:27], v[144:147], v[184:187]
    ds_read_b128 v[124:127], v1 offset:22528
    v_mfma_f32_16x16x32_bf16 v[188:191], v[24:27], v[148:151], v[188:191]
    ds_read_b128 v[128:131], v1 offset:23552
    v_mfma_f32_16x16x32_bf16 v[192:195], v[24:27], v[152:155], v[192:195]
    ds_read_b128 v[132:135], v1 offset:24576
    s_waitcnt vmcnt(7) lgkmcnt(5)
    v_mfma_f32_16x16x32_bf16 v[176:179], v[28:31], v[96:99], v[176:179]
    ds_read_b128 v[136:139], v1 offset:25600
    buffer_load_dwordx4 v[60:63], v1, s[4:7], s62 offen offset:3072 sc1
    v_mfma_f32_16x16x32_bf16 v[180:183], v[28:31], v[100:103], v[180:183]
    ds_read_b128 v[140:143], v1 offset:26624
    v_mfma_f32_16x16x32_bf16 v[184:187], v[28:31], v[104:107], v[184:187]
    ds_read_b128 v[144:147], v1 offset:27648
    v_mfma_f32_16x16x32_bf16 v[188:191], v[28:31], v[108:111], v[188:191]
    ds_read_b128 v[148:151], v1 offset:28672
    v_mfma_f32_16x16x32_bf16 v[192:195], v[28:31], v[112:115], v[192:195]
    ds_read_b128 v[152:155], v1 offset:29696
    s_waitcnt vmcnt(7) lgkmcnt(5)
    v_mfma_f32_16x16x32_bf16 v[176:179], v[32:35], v[116:119], v[176:179]
    ds_read_b128 v[96:99], v1 offset:30720
    buffer_load_dwordx4 v[64:67], v1, s[4:7], s63 offen offset:0 sc1
    v_mfma_f32_16x16x32_bf16 v[180:183], v[32:35], v[120:123], v[180:183]
    ds_read_b128 v[100:103], v1 offset:31744
    v_mfma_f32_16x16x32_bf16 v[184:187], v[32:35], v[124:127], v[184:187]
    ds_read_b128 v[104:107], v1 offset:32768
    v_mfma_f32_16x16x32_bf16 v[188:191], v[32:35], v[128:131], v[188:191]
    ds_read_b128 v[108:111], v1 offset:33792
    v_mfma_f32_16x16x32_bf16 v[192:195], v[32:35], v[132:135], v[192:195]
    ds_read_b128 v[112:115], v1 offset:34816
    s_waitcnt vmcnt(7) lgkmcnt(5)
    v_mfma_f32_16x16x32_bf16 v[176:179], v[36:39], v[136:139], v[176:179]
    ds_read_b128 v[116:119], v1 offset:35840
    buffer_load_dwordx4 v[68:71], v1, s[4:7], s63 offen offset:1024 sc1
    v_mfma_f32_16x16x32_bf16 v[180:183], v[36:39], v[140:143], v[180:183]
    ds_read_b128 v[120:123], v1 offset:36864
    v_mfma_f32_16x16x32_bf16 v[184:187], v[36:39], v[144:147], v[184:187]
    ds_read_b128 v[124:127], v1 offset:37888
    v_mfma_f32_16x16x32_bf16 v[188:191], v[36:39], v[148:151], v[188:191]
    ds_read_b128 v[128:131], v1 offset:38912
    v_mfma_f32_16x16x32_bf16 v[192:195], v[36:39], v[152:155], v[192:195]
    ds_read_b128 v[132:135], v1 offset:39936
    s_waitcnt vmcnt(7) lgkmcnt(5)
    v_mfma_f32_16x16x32_bf16 v[176:179], v[40:43], v[96:99], v[176:179]
    ds_read_b128 v[136:139], v1 offset:40960
    buffer_load_dwordx4 v[72:75], v1, s[4:7], s63 offen offset:2048 sc1
    v_mfma_f32_16x16x32_bf16 v[180:183], v[40:43], v[100:103], v[180:183]
    ds_read_b128 v[140:143], v1 offset:41984
    v_mfma_f32_16x16x32_bf16 v[184:187], v[40:43], v[104:107], v[184:187]
    ds_read_b128 v[144:147], v1 offset:43008
    v_mfma_f32_16x16x32_bf16 v[188:191], v[40:43], v[108:111], v[188:191]
    ds_read_b128 v[148:151], v1 offset:44032
    v_mfma_f32_16x16x32_bf16 v[192:195], v[40:43], v[112:115], v[192:195]
    ds_read_b128 v[152:155], v1 offset:45056
    s_waitcnt vmcnt(7) lgkmcnt(5)
    v_mfma_f32_16x16x32_bf16 v[176:179], v[44:47], v[116:119], v[176:179]
    ds_read_b128 v[96:99], v1 offset:46080
    buffer_load_dwordx4 v[76:79], v1, s[4:7], s63 offen offset:3072 sc1
    v_mfma_f32_16x16x32_bf16 v[180:183], v[44:47], v[120:123], v[180:183]
    ds_read_b128 v[100:103], v1 offset:47104
    v_mfma_f32_16x16x32_bf16 v[184:187], v[44:47], v[124:127], v[184:187]
    ds_read_b128 v[104:107], v1 offset:48128
    v_mfma_f32_16x16x32_bf16 v[188:191], v[44:47], v[128:131], v[188:191]
    ds_read_b128 v[108:111], v1 offset:49152
    v_mfma_f32_16x16x32_bf16 v[192:195], v[44:47], v[132:135], v[192:195]
    ds_read_b128 v[112:115], v1 offset:50176
    v_maximum3_f32 v4, v176, v177, v178
    v_cmp_u_f32 vcc, v4, v179
    s_and_b64 vcc, vcc, s[94:95]
    s_cbranch_scc1 L_proj_early
    s_waitcnt vmcnt(7) lgkmcnt(5)
    v_mfma_f32_16x16x32_bf16 v[176:179], v[48:51], v[136:139], v[176:179]
    ds_read_b128 v[116:119], v15 offset:0
    buffer_load_dwordx2 v[80:81], v14, s[4:7], s64 offen offset:0 sc1
    v_mfma_f32_16x16x32_bf16 v[180:183], v[48:51], v[140:143], v[180:183]
    ds_read_b128 v[120:123], v15 offset:1024
    buffer_load_dwordx2 v[82:83], v14, s[4:7], s64 offen offset:128 sc1
    v_mfma_f32_16x16x32_bf16 v[184:187], v[48:51], v[144:147], v[184:187]
    ds_read_b128 v[124:127], v15 offset:2048
    v_mfma_f32_16x16x32_bf16 v[188:191], v[48:51], v[148:151], v[188:191]
    ds_read_b128 v[128:131], v15 offset:3072
    v_mfma_f32_16x16x32_bf16 v[192:195], v[48:51], v[152:155], v[192:195]
    ds_read_b128 v[132:135], v15 offset:4096
    s_waitcnt vmcnt(8) lgkmcnt(5)
    v_mfma_f32_16x16x32_bf16 v[176:179], v[52:55], v[96:99], v[176:179]
    ds_read_b128 v[136:139], v15 offset:5120
    buffer_load_dwordx2 v[84:85], v14, s[4:7], s64 offen offset:1024 sc1
    v_mfma_f32_16x16x32_bf16 v[180:183], v[52:55], v[100:103], v[180:183]
    ds_read_b128 v[140:143], v15 offset:6144
    buffer_load_dwordx2 v[86:87], v14, s[4:7], s64 offen offset:1152 sc1
    v_mfma_f32_16x16x32_bf16 v[184:187], v[52:55], v[104:107], v[184:187]
    ds_read_b128 v[144:147], v15 offset:7168
    v_mfma_f32_16x16x32_bf16 v[188:191], v[52:55], v[108:111], v[188:191]
    ds_read_b128 v[148:151], v15 offset:8192
    v_mfma_f32_16x16x32_bf16 v[192:195], v[52:55], v[112:115], v[192:195]
    ds_read_b128 v[152:155], v15 offset:9216
    s_waitcnt vmcnt(9) lgkmcnt(5)
    v_mfma_f32_16x16x32_bf16 v[176:179], v[56:59], v[116:119], v[176:179]
    ds_read_b128 v[96:99], v15 offset:10240
    buffer_load_dwordx2 v[88:89], v14, s[4:7], s64 offen offset:2048 sc1
    v_mfma_f32_16x16x32_bf16 v[180:183], v[56:59], v[120:123], v[180:183]
    ds_read_b128 v[100:103], v15 offset:11264
    buffer_load_dwordx2 v[90:91], v14, s[4:7], s64 offen offset:2176 sc1
    v_mfma_f32_16x16x32_bf16 v[184:187], v[56:59], v[124:127], v[184:187]
    ds_read_b128 v[104:107], v15 offset:12288
    v_mfma_f32_16x16x32_bf16 v[188:191], v[56:59], v[128:131], v[188:191]
    ds_read_b128 v[108:111], v15 offset:13312
    v_mfma_f32_16x16x32_bf16 v[192:195], v[56:59], v[132:135], v[192:195]
    ds_read_b128 v[112:115], v15 offset:14336
    s_waitcnt vmcnt(10) lgkmcnt(5)
    v_mfma_f32_16x16x32_bf16 v[176:179], v[60:63], v[136:139], v[176:179]
    ds_read_b128 v[116:119], v15 offset:15360
    buffer_load_dwordx2 v[92:93], v14, s[4:7], s64 offen offset:3072 sc1
    v_mfma_f32_16x16x32_bf16 v[180:183], v[60:63], v[140:143], v[180:183]
    ds_read_b128 v[120:123], v15 offset:16384
    buffer_load_dwordx2 v[94:95], v14, s[4:7], s64 offen offset:3200 sc1
    v_mfma_f32_16x16x32_bf16 v[184:187], v[60:63], v[144:147], v[184:187]
    ds_read_b128 v[124:127], v15 offset:17408
    v_mfma_f32_16x16x32_bf16 v[188:191], v[60:63], v[148:151], v[188:191]
    ds_read_b128 v[128:131], v15 offset:18432
    v_mfma_f32_16x16x32_bf16 v[192:195], v[60:63], v[152:155], v[192:195]
    ds_read_b128 v[132:135], v15 offset:19456
    s_waitcnt vmcnt(11) lgkmcnt(5)
    v_mfma_f32_16x16x32_bf16 v[176:179], v[64:67], v[96:99], v[176:179]
    ds_read_b128 v[136:139], v15 offset:20480
    v_mfma_f32_16x16x32_bf16 v[180:183], v[64:67], v[100:103], v[180:183]
    ds_read_b128 v[140:143], v15 offset:21504
    v_mfma_f32_16x16x32_bf16 v[184:187], v[64:67], v[104:107], v[184:187]
    ds_read_b128 v[144:147], v15 offset:22528
    v_mfma_f32_16x16x32_bf16 v[188:191], v[64:67], v[108:111], v[188:191]
    ds_read_b128 v[148:151], v15 offset:23552
    v_mfma_f32_16x16x32_bf16 v[192:195], v[64:67], v[112:115], v[192:195]
    ds_read_b128 v[152:155], v15 offset:24576
    s_waitcnt vmcnt(10) lgkmcnt(5)
    v_mfma_f32_16x16x32_bf16 v[176:179], v[68:71], v[116:119], v[176:179]
    ds_read_b128 v[96:99], v15 offset:25600
    v_mfma_f32_16x16x32_bf16 v[180:183], v[68:71], v[120:123], v[180:183]
    ds_read_b128 v[100:103], v15 offset:26624
    v_mfma_f32_16x16x32_bf16 v[184:187], v[68:71], v[124:127], v[184:187]
    ds_read_b128 v[104:107], v15 offset:27648
    v_mfma_f32_16x16x32_bf16 v[188:191], v[68:71], v[128:131], v[188:191]
    ds_read_b128 v[108:111], v15 offset:28672
    v_mfma_f32_16x16x32_bf16 v[192:195], v[68:71], v[132:135], v[192:195]
    ds_read_b128 v[112:115], v15 offset:29696
    s_waitcnt vmcnt(9) lgkmcnt(5)
    v_mfma_f32_16x16x32_bf16 v[176:179], v[72:75], v[136:139], v[176:179]
    ds_read_b128 v[116:119], v15 offset:30720
    v_mfma_f32_16x16x32_bf16 v[180:183], v[72:75], v[140:143], v[180:183]
    ds_read_b128 v[120:123], v15 offset:31744
    v_mfma_f32_16x16x32_bf16 v[184:187], v[72:75], v[144:147], v[184:187]
    ds_read_b128 v[124:127], v15 offset:32768
    v_mfma_f32_16x16x32_bf16 v[188:191], v[72:75], v[148:151], v[188:191]
    ds_read_b128 v[128:131], v15 offset:33792
    v_mfma_f32_16x16x32_bf16 v[192:195], v[72:75], v[152:155], v[192:195]
    ds_read_b128 v[132:135], v15 offset:34816
    s_waitcnt vmcnt(8) lgkmcnt(5)
    v_mfma_f32_16x16x32_bf16 v[176:179], v[76:79], v[96:99], v[176:179]
    ds_read_b128 v[136:139], v15 offset:35840
    v_mfma_f32_16x16x32_bf16 v[180:183], v[76:79], v[100:103], v[180:183]
    ds_read_b128 v[140:143], v15 offset:36864
    v_mfma_f32_16x16x32_bf16 v[184:187], v[76:79], v[104:107], v[184:187]
    ds_read_b128 v[144:147], v15 offset:37888
    v_mfma_f32_16x16x32_bf16 v[188:191], v[76:79], v[108:111], v[188:191]
    ds_read_b128 v[148:151], v15 offset:38912
    v_mfma_f32_16x16x32_bf16 v[192:195], v[76:79], v[112:115], v[192:195]
    ds_read_b128 v[152:155], v15 offset:39936
    s_waitcnt vmcnt(6) lgkmcnt(5)
    v_mfma_f32_16x16x32_bf16 v[176:179], v[80:83], v[116:119], v[176:179]
    ds_read_b128 v[96:99], v15 offset:40960
    v_mfma_f32_16x16x32_bf16 v[180:183], v[80:83], v[120:123], v[180:183]
    ds_read_b128 v[100:103], v15 offset:41984
    v_mfma_f32_16x16x32_bf16 v[184:187], v[80:83], v[124:127], v[184:187]
    ds_read_b128 v[104:107], v15 offset:43008
    v_mfma_f32_16x16x32_bf16 v[188:191], v[80:83], v[128:131], v[188:191]
    ds_read_b128 v[108:111], v15 offset:44032
    v_mfma_f32_16x16x32_bf16 v[192:195], v[80:83], v[132:135], v[192:195]
    ds_read_b128 v[112:115], v15 offset:45056
    s_waitcnt vmcnt(4) lgkmcnt(5)
    v_mfma_f32_16x16x32_bf16 v[176:179], v[84:87], v[136:139], v[176:179]
    ds_read_b128 v[116:119], v15 offset:46080
    v_mfma_f32_16x16x32_bf16 v[180:183], v[84:87], v[140:143], v[180:183]
    ds_read_b128 v[120:123], v15 offset:47104
    v_mfma_f32_16x16x32_bf16 v[184:187], v[84:87], v[144:147], v[184:187]
    ds_read_b128 v[124:127], v15 offset:48128
    v_mfma_f32_16x16x32_bf16 v[188:191], v[84:87], v[148:151], v[188:191]
    ds_read_b128 v[128:131], v15 offset:49152
    v_mfma_f32_16x16x32_bf16 v[192:195], v[84:87], v[152:155], v[192:195]
    ds_read_b128 v[132:135], v15 offset:50176
    s_waitcnt vmcnt(2) lgkmcnt(5)
    v_mfma_f32_16x16x32_bf16 v[176:179], v[88:91], v[96:99], v[176:179]
    v_mfma_f32_16x16x32_bf16 v[180:183], v[88:91], v[100:103], v[180:183]
    v_mfma_f32_16x16x32_bf16 v[184:187], v[88:91], v[104:107], v[184:187]
    v_mfma_f32_16x16x32_bf16 v[188:191], v[88:91], v[108:111], v[188:191]
    v_mfma_f32_16x16x32_bf16 v[192:195], v[88:91], v[112:115], v[192:195]
    s_waitcnt vmcnt(0) lgkmcnt(0)
    v_mfma_f32_16x16x32_bf16 v[176:179], v[92:95], v[116:119], v[176:179]
    v_mfma_f32_16x16x32_bf16 v[180:183], v[92:95], v[120:123], v[180:183]
    v_mfma_f32_16x16x32_bf16 v[184:187], v[92:95], v[124:127], v[184:187]
    v_mfma_f32_16x16x32_bf16 v[188:191], v[92:95], v[128:131], v[188:191]
    v_mfma_f32_16x16x32_bf16 v[192:195], v[92:95], v[132:135], v[192:195]
    s_nop 3
    v_maximum3_f32 v4, v176, v177, v178
    v_cmp_u_f32 vcc, v4, v179
    s_nop 0
    s_cbranch_vccnz L_proj_redo
L_proj_ok0:
    s_mov_b32 s42, 1
    s_mov_b32 s46, 2883584
    s_mov_b32 s47, 8142848
    s_mov_b32 s48, 114688
    s_mov_b32 s49, 24084480
    s_mov_b32 s50, 32473088
    s_branch L_epi_lo
L_c0_ret:
    s_cmp_lg_u32 s42, 0
    s_cbranch_scc1 L_fin
    s_mov_b32 s42, 1
    s_mov_b32 s46, 2883584
    s_mov_b32 s47, 8142848
    s_mov_b32 s48, 114688
    s_mov_b32 s49, 24084480
    s_mov_b32 s50, 32473088
    s_branch L_epi_hi
L_pf_110:
    s_waitcnt vmcnt(7) lgkmcnt(5)
    v_mfma_f32_16x16x32_bf16 v[156:159], v[96:99], v[16:19], v[176:179]
    ds_read_b128 v[136:139], v1 offset:10240
    buffer_load_dwordx4 v[48:51], v1, s[4:7], s62 offen offset:0 sc1
    v_mfma_f32_16x16x32_bf16 v[160:163], v[100:103], v[16:19], v[180:183]
    ds_read_b128 v[140:143], v1 offset:11264
    v_mfma_f32_16x16x32_bf16 v[164:167], v[104:107], v[16:19], v[184:187]
    ds_read_b128 v[144:147], v1 offset:12288
    v_mfma_f32_16x16x32_bf16 v[168:171], v[108:111], v[16:19], v[188:191]
    ds_read_b128 v[148:151], v1 offset:13312
    v_mfma_f32_16x16x32_bf16 v[172:175], v[112:115], v[16:19], v[192:195]
    ds_read_b128 v[152:155], v1 offset:14336
    s_waitcnt vmcnt(7) lgkmcnt(5)
    v_mfma_f32_16x16x32_bf16 v[156:159], v[116:119], v[20:23], v[156:159]
    ds_read_b128 v[96:99], v1 offset:15360
    buffer_load_dwordx4 v[52:55], v1, s[4:7], s62 offen offset:1024 sc1
    v_mfma_f32_16x16x32_bf16 v[160:163], v[120:123], v[20:23], v[160:163]
    ds_read_b128 v[100:103], v1 offset:16384
    v_mfma_f32_16x16x32_bf16 v[164:167], v[124:127], v[20:23], v[164:167]
    ds_read_b128 v[104:107], v1 offset:17408
    v_mfma_f32_16x16x32_bf16 v[168:171], v[128:131], v[20:23], v[168:171]
    ds_read_b128 v[108:111], v1 offset:18432
    v_mfma_f32_16x16x32_bf16 v[172:175], v[132:135], v[20:23], v[172:175]
    ds_read_b128 v[112:115], v1 offset:19456
    s_waitcnt vmcnt(7) lgkmcnt(5)
    v_mfma_f32_16x16x32_bf16 v[156:159], v[136:139], v[24:27], v[156:159]
    ds_read_b128 v[116:119], v1 offset:20480
    buffer_load_dwordx4 v[56:59], v1, s[4:7], s62 offen offset:2048 sc1
    v_mfma_f32_16x16x32_bf16 v[160:163], v[140:143], v[24:27], v[160:163]
    ds_read_b128 v[120:123], v1 offset:21504
    v_mfma_f32_16x16x32_bf16 v[164:167], v[144:147], v[24:27], v[164:167]
    ds_read_b128 v[124:127], v1 offset:22528
    v_mfma_f32_16x16x32_bf16 v[168:171], v[148:151], v[24:27], v[168:171]
    ds_read_b128 v[128:131], v1 offset:23552
    v_mfma_f32_16x16x32_bf16 v[172:175], v[152:155], v[24:27], v[172:175]
    ds_read_b128 v[132:135], v1 offset:24576
    s_waitcnt vmcnt(7) lgkmcnt(5)
    v_mfma_f32_16x16x32_bf16 v[156:159], v[96:99], v[28:31], v[156:159]
    ds_read_b128 v[136:139], v1 offset:25600
    buffer_load_dwordx4 v[60:63], v1, s[4:7], s62 offen offset:3072 sc1
    v_mfma_f32_16x16x32_bf16 v[160:163], v[100:103], v[28:31], v[160:163]
    ds_read_b128 v[140:143], v1 offset:26624
    v_mfma_f32_16x16x32_bf16 v[164:167], v[104:107], v[28:31], v[164:167]
    ds_read_b128 v[144:147], v1 offset:27648
    v_mfma_f32_16x16x32_bf16 v[168:171], v[108:111], v[28:31], v[168:171]
    ds_read_b128 v[148:151], v1 offset:28672
    v_mfma_f32_16x16x32_bf16 v[172:175], v[112:115], v[28:31], v[172:175]
    ds_read_b128 v[152:155], v1 offset:29696
    s_waitcnt vmcnt(7) lgkmcnt(5)
    v_mfma_f32_16x16x32_bf16 v[156:159], v[116:119], v[32:35], v[156:159]
    ds_read_b128 v[96:99], v1 offset:30720
    buffer_load_dwordx4 v[64:67], v1, s[4:7], s63 offen offset:0 sc1
    v_mfma_f32_16x16x32_bf16 v[160:163], v[120:123], v[32:35], v[160:163]
    ds_read_b128 v[100:103], v1 offset:31744
    v_mfma_f32_16x16x32_bf16 v[164:167], v[124:127], v[32:35], v[164:167]
    ds_read_b128 v[104:107], v1 offset:32768
    v_mfma_f32_16x16x32_bf16 v[168:171], v[128:131], v[32:35], v[168:171]
    ds_read_b128 v[108:111], v1 offset:33792
    v_mfma_f32_16x16x32_bf16 v[172:175], v[132:135], v[32:35], v[172:175]
    ds_read_b128 v[112:115], v1 offset:34816
    s_waitcnt vmcnt(7) lgkmcnt(5)
    v_mfma_f32_16x16x32_bf16 v[156:159], v[136:139], v[36:39], v[156:159]
    ds_read_b128 v[116:119], v1 offset:35840
    buffer_load_dwordx4 v[68:71], v1, s[4:7], s63 offen offset:1024 sc1
    v_mfma_f32_16x16x32_bf16 v[160:163], v[140:143], v[36:39], v[160:163]
    ds_read_b128 v[120:123], v1 offset:36864
    v_mfma_f32_16x16x32_bf16 v[164:167], v[144:147], v[36:39], v[164:167]
    ds_read_b128 v[124:127], v1 offset:37888
    v_mfma_f32_16x16x32_bf16 v[168:171], v[148:151], v[36:39], v[168:171]
    ds_read_b128 v[128:131], v1 offset:38912
    v_mfma_f32_16x16x32_bf16 v[172:175], v[152:155], v[36:39], v[172:175]
    ds_read_b128 v[132:135], v1 offset:39936
    s_waitcnt vmcnt(7) lgkmcnt(5)
    v_mfma_f32_16x16x32_bf16 v[156:159], v[96:99], v[40:43], v[156:159]
    ds_read_b128 v[136:139], v1 offset:40960
    buffer_load_dwordx4 v[72:75], v1, s[4:7], s63 offen offset:2048 sc1
    v_mfma_f32_16x16x32_bf16 v[160:163], v[100:103], v[40:43], v[160:163]
    ds_read_b128 v[140:143], v1 offset:41984
    v_mfma_f32_16x16x32_bf16 v[164:167], v[104:107], v[40:43], v[164:167]
    ds_read_b128 v[144:147], v1 offset:43008
    v_mfma_f32_16x16x32_bf16 v[168:171], v[108:111], v[40:43], v[168:171]
    ds_read_b128 v[148:151], v1 offset:44032
    v_mfma_f32_16x16x32_bf16 v[172:175], v[112:115], v[40:43], v[172:175]
    ds_read_b128 v[152:155], v1 offset:45056
    s_waitcnt vmcnt(7) lgkmcnt(5)
    v_mfma_f32_16x16x32_bf16 v[156:159], v[116:119], v[44:47], v[156:159]
    ds_read_b128 v[96:99], v1 offset:46080
    buffer_load_dwordx4 v[76:79], v1, s[4:7], s63 offen offset:3072 sc1
    v_mfma_f32_16x16x32_bf16 v[160:163], v[120:123], v[44:47], v[160:163]
    ds_read_b128 v[100:103], v1 offset:47104
    v_mfma_f32_16x16x32_bf16 v[164:167], v[124:127], v[44:47], v[164:167]
    ds_read_b128 v[104:107], v1 offset:48128
    v_mfma_f32_16x16x32_bf16 v[168:171], v[128:131], v[44:47], v[168:171]
    ds_read_b128 v[108:111], v1 offset:49152
    v_mfma_f32_16x16x32_bf16 v[172:175], v[132:135], v[44:47], v[172:175]
    ds_read_b128 v[112:115], v1 offset:50176
    v_cmp_u_f32 vcc, v156, v156
    s_and_b64 vcc, vcc, s[94:95]
    s_cbranch_scc1 L_proj_early
    s_waitcnt vmcnt(7) lgkmcnt(5)
    v_mfma_f32_16x16x32_bf16 v[156:159], v[136:139], v[48:51], v[156:159]
    ds_read_b128 v[116:119], v15 offset:0
    buffer_load_dwordx2 v[80:81], v14, s[4:7], s64 offen offset:0 sc1
    v_mfma_f32_16x16x32_bf16 v[160:163], v[140:143], v[48:51], v[160:163]
    ds_read_b128 v[120:123], v15 offset:1024
    buffer_load_dwordx2 v[82:83], v14, s[4:7], s64 offen offset:128 sc1
    v_mfma_f32_16x16x32_bf16 v[164:167], v[144:147], v[48:51], v[164:167]
    ds_read_b128 v[124:127], v15 offset:2048
    v_mfma_f32_16x16x32_bf16 v[168:171], v[148:151], v[48:51], v[168:171]
    ds_read_b128 v[128:131], v15 offset:3072
    v_mfma_f32_16x16x32_bf16 v[172:175], v[152:155], v[48:51], v[172:175]
    ds_read_b128 v[132:135], v15 offset:4096
    s_waitcnt vmcnt(8) lgkmcnt(5)
    v_mfma_f32_16x16x32_bf16 v[156:159], v[96:99], v[52:55], v[156:159]
    ds_read_b128 v[136:139], v15 offset:5120
    buffer_load_dwordx2 v[84:85], v14, s[4:7], s64 offen offset:1024 sc1
    v_mfma_f32_16x16x32_bf16 v[160:163], v[100:103], v[52:55], v[160:163]
    ds_read_b128 v[140:143], v15 offset:6144
    buffer_load_dwordx2 v[86:87], v14, s[4:7], s64 offen offset:1152 sc1
    v_mfma_f32_16x16x32_bf16 v[164:167], v[104:107], v[52:55], v[164:167]
    ds_read_b128 v[144:147], v15 offset:7168
    v_mfma_f32_16x16x32_bf16 v[168:171], v[108:111], v[52:55], v[168:171]
    ds_read_b128 v[148:151], v15 offset:8192
    v_mfma_f32_16x16x32_bf16 v[172:175], v[112:115], v[52:55], v[172:175]
    ds_read_b128 v[152:155], v15 offset:9216
    s_waitcnt vmcnt(9) lgkmcnt(5)
    v_mfma_f32_16x16x32_bf16 v[156:159], v[116:119], v[56:59], v[156:159]
    ds_read_b128 v[96:99], v15 offset:10240
    buffer_load_dwordx2 v[88:89], v14, s[4:7], s64 offen offset:2048 sc1
    v_mfma_f32_16x16x32_bf16 v[160:163], v[120:123], v[56:59], v[160:163]
    ds_read_b128 v[100:103], v15 offset:11264
    buffer_load_dwordx2 v[90:91], v14, s[4:7], s64 offen offset:2176 sc1
    v_mfma_f32_16x16x32_bf16 v[164:167], v[124:127], v[56:59], v[164:167]
    ds_read_b128 v[104:107], v15 offset:12288
    v_mfma_f32_16x16x32_bf16 v[168:171], v[128:131], v[56:59], v[168:171]
    ds_read_b128 v[108:111], v15 offset:13312
    v_mfma_f32_16x16x32_bf16 v[172:175], v[132:135], v[56:59], v[172:175]
    ds_read_b128 v[112:115], v15 offset:14336
    s_waitcnt vmcnt(10) lgkmcnt(5)
    v_mfma_f32_16x16x32_bf16 v[156:159], v[136:139], v[60:63], v[156:159]
    ds_read_b128 v[116:119], v15 offset:15360
    buffer_load_dwordx2 v[92:93], v14, s[4:7], s64 offen offset:3072 sc1
    v_mfma_f32_16x16x32_bf16 v[160:163], v[140:143], v[60:63], v[160:163]
    ds_read_b128 v[120:123], v15 offset:16384
    buffer_load_dwordx2 v[94:95], v14, s[4:7], s64 offen offset:3200 sc1
    v_mfma_f32_16x16x32_bf16 v[164:167], v[144:147], v[60:63], v[164:167]
    ds_read_b128 v[124:127], v15 offset:17408
    v_mfma_f32_16x16x32_bf16 v[168:171], v[148:151], v[60:63], v[168:171]
    ds_read_b128 v[128:131], v15 offset:18432
    v_mfma_f32_16x16x32_bf16 v[172:175], v[152:155], v[60:63], v[172:175]
    ds_read_b128 v[132:135], v15 offset:19456
    s_waitcnt vmcnt(11) lgkmcnt(5)
    v_mfma_f32_16x16x32_bf16 v[156:159], v[96:99], v[64:67], v[156:159]
    ds_read_b128 v[136:139], v15 offset:20480
    v_mfma_f32_16x16x32_bf16 v[160:163], v[100:103], v[64:67], v[160:163]
    ds_read_b128 v[140:143], v15 offset:21504
    v_mfma_f32_16x16x32_bf16 v[164:167], v[104:107], v[64:67], v[164:167]
    ds_read_b128 v[144:147], v15 offset:22528
    v_mfma_f32_16x16x32_bf16 v[168:171], v[108:111], v[64:67], v[168:171]
    ds_read_b128 v[148:151], v15 offset:23552
    v_mfma_f32_16x16x32_bf16 v[172:175], v[112:115], v[64:67], v[172:175]
    ds_read_b128 v[152:155], v15 offset:24576
    s_waitcnt vmcnt(10) lgkmcnt(5)
    v_mfma_f32_16x16x32_bf16 v[156:159], v[116:119], v[68:71], v[156:159]
    ds_read_b128 v[96:99], v15 offset:25600
    v_mfma_f32_16x16x32_bf16 v[160:163], v[120:123], v[68:71], v[160:163]
    ds_read_b128 v[100:103], v15 offset:26624
    v_mfma_f32_16x16x32_bf16 v[164:167], v[124:127], v[68:71], v[164:167]
    ds_read_b128 v[104:107], v15 offset:27648
    v_mfma_f32_16x16x32_bf16 v[168:171], v[128:131], v[68:71], v[168:171]
    ds_read_b128 v[108:111], v15 offset:28672
    v_mfma_f32_16x16x32_bf16 v[172:175], v[132:135], v[68:71], v[172:175]
    ds_read_b128 v[112:115], v15 offset:29696
    s_waitcnt vmcnt(9) lgkmcnt(5)
    v_mfma_f32_16x16x32_bf16 v[156:159], v[136:139], v[72:75], v[156:159]
    ds_read_b128 v[116:119], v15 offset:30720
    v_mfma_f32_16x16x32_bf16 v[160:163], v[140:143], v[72:75], v[160:163]
    ds_read_b128 v[120:123], v15 offset:31744
    v_mfma_f32_16x16x32_bf16 v[164:167], v[144:147], v[72:75], v[164:167]
    ds_read_b128 v[124:127], v15 offset:32768
    v_mfma_f32_16x16x32_bf16 v[168:171], v[148:151], v[72:75], v[168:171]
    ds_read_b128 v[128:131], v15 offset:33792
    v_mfma_f32_16x16x32_bf16 v[172:175], v[152:155], v[72:75], v[172:175]
    ds_read_b128 v[132:135], v15 offset:34816
    s_waitcnt vmcnt(8) lgkmcnt(5)
    v_mfma_f32_16x16x32_bf16 v[156:159], v[96:99], v[76:79], v[156:159]
    ds_read_b128 v[136:139], v15 offset:35840
    v_mfma_f32_16x16x32_bf16 v[160:163], v[100:103], v[76:79], v[160:163]
    ds_read_b128 v[140:143], v15 offset:36864
    v_mfma_f32_16x16x32_bf16 v[164:167], v[104:107], v[76:79], v[164:167]
    ds_read_b128 v[144:147], v15 offset:37888
    v_mfma_f32_16x16x32_bf16 v[168:171], v[108:111], v[76:79], v[168:171]
    ds_read_b128 v[148:151], v15 offset:38912
    v_mfma_f32_16x16x32_bf16 v[172:175], v[112:115], v[76:79], v[172:175]
    ds_read_b128 v[152:155], v15 offset:39936
    s_waitcnt vmcnt(6) lgkmcnt(5)
    v_mfma_f32_16x16x32_bf16 v[156:159], v[116:119], v[80:83], v[156:159]
    ds_read_b128 v[96:99], v15 offset:40960
    v_mfma_f32_16x16x32_bf16 v[160:163], v[120:123], v[80:83], v[160:163]
    ds_read_b128 v[100:103], v15 offset:41984
    v_mfma_f32_16x16x32_bf16 v[164:167], v[124:127], v[80:83], v[164:167]
    ds_read_b128 v[104:107], v15 offset:43008
    v_mfma_f32_16x16x32_bf16 v[168:171], v[128:131], v[80:83], v[168:171]
    ds_read_b128 v[108:111], v15 offset:44032
    v_mfma_f32_16x16x32_bf16 v[172:175], v[132:135], v[80:83], v[172:175]
    ds_read_b128 v[112:115], v15 offset:45056
    s_waitcnt vmcnt(4) lgkmcnt(5)
    v_mfma_f32_16x16x32_bf16 v[156:159], v[136:139], v[84:87], v[156:159]
    ds_read_b128 v[116:119], v15 offset:46080
    v_mfma_f32_16x16x32_bf16 v[160:163], v[140:143], v[84:87], v[160:163]
    ds_read_b128 v[120:123], v15 offset:47104
    v_mfma_f32_16x16x32_bf16 v[164:167], v[144:147], v[84:87], v[164:167]
    ds_read_b128 v[124:127], v15 offset:48128
    v_mfma_f32_16x16x32_bf16 v[168:171], v[148:151], v[84:87], v[168:171]
    ds_read_b128 v[128:131], v15 offset:49152
    v_mfma_f32_16x16x32_bf16 v[172:175], v[152:155], v[84:87], v[172:175]
    ds_read_b128 v[132:135], v15 offset:50176
    s_waitcnt vmcnt(2) lgkmcnt(5)
    v_mfma_f32_16x16x32_bf16 v[156:159], v[96:99], v[88:91], v[156:159]
    v_mfma_f32_16x16x32_bf16 v[160:163], v[100:103], v[88:91], v[160:163]
    v_mfma_f32_16x16x32_bf16 v[164:167], v[104:107], v[88:91], v[164:167]
    v_mfma_f32_16x16x32_bf16 v[168:171], v[108:111], v[88:91], v[168:171]
    v_mfma_f32_16x16x32_bf16 v[172:175], v[112:115], v[88:91], v[172:175]
    s_waitcnt vmcnt(0) lgkmcnt(0)
    v_mfma_f32_16x16x32_bf16 v[156:159], v[116:119], v[92:95], v[156:159]
    v_mfma_f32_16x16x32_bf16 v[160:163], v[120:123], v[92:95], v[160:163]
    v_mfma_f32_16x16x32_bf16 v[164:167], v[124:127], v[92:95], v[164:167]
    v_mfma_f32_16x16x32_bf16 v[168:171], v[128:131], v[92:95], v[168:171]
    v_mfma_f32_16x16x32_bf16 v[172:175], v[132:135], v[92:95], v[172:175]
    s_nop 3
    v_cmp_u_f32 vcc, v156, v156
    s_nop 0
    s_cbranch_vccnz L_proj_redo
L_proj_ok1:
    v_cvt_pk_bf16_f32 v16, v156, v157
    v_cvt_pk_bf16_f32 v17, v158, v159
    v_cvt_pk_bf16_f32 v18, v160, v161
    v_cvt_pk_bf16_f32 v19, v162, v163
    v_cvt_pk_bf16_f32 v20, v164, v165
    v_cvt_pk_bf16_f32 v21, v166, v167
    v_cvt_pk_bf16_f32 v22, v168, v169
    v_cvt_pk_bf16_f32 v23, v170, v171
    v_cvt_pk_bf16_f32 v24, v172, v173
    v_cvt_pk_bf16_f32 v25, v174, v175
    ds_write_b128 v6, v[16:19]
    ds_write_b128 v6, v[20:23] offset:64
    ds_write_b64 v7, v[24:25] offset:128
    ds_read_b128 v[28:31], v8
    ds_read_b128 v[32:35], v9
    s_mov_b32 exec_hi, 0
    ds_read_b128 v[36:39], v10
    s_mov_b64 exec, -1
    s_waitcnt lgkmcnt(2)
    buffer_store_dwordx4 v[28:31], v11, s[28:31], s56 offen
    s_waitcnt lgkmcnt(1)
    buffer_store_dwordx4 v[32:35], v12, s[28:31], s56 offen
    s_mov_b32 exec_hi, 0
    s_waitcnt lgkmcnt(0)
    buffer_store_dwordx4 v[36:39], v2, s[28:31], s56 offen
    s_mov_b64 exec, -1
L_fin:
    s_endpgm
L_col_redo:
    s_mov_b32 s53, 0x7f817f81
    s_mov_b64 s[82:83], 0
    v_cmp_eq_u32 vcc, s53, v200
    s_or_b64 s[82:83], s[82:83], vcc
    v_cmp_eq_u32 vcc, s53, v201
    s_or_b64 s[82:83], s[82:83], vcc
    v_cmp_eq_u32 vcc, s53, v202
    s_or_b64 s[82:83], s[82:83], vcc
    v_cmp_eq_u32 vcc, s53, v203
    s_or_b64 s[82:83], s[82:83], vcc
    v_cmp_eq_u32 vcc, s53, v204
    s_or_b64 s[82:83], s[82:83], vcc
    v_cmp_eq_u32 vcc, s53, v205
    s_or_b64 s[82:83], s[82:83], vcc
    v_cmp_eq_u32 vcc, s53, v206
    s_or_b64 s[82:83], s[82:83], vcc
    v_cmp_eq_u32 vcc, s53, v207
    s_or_b64 s[82:83], s[82:83], vcc
    v_cmp_eq_u32 vcc, s53, v208
    s_or_b64 s[82:83], s[82:83], vcc
    v_cmp_eq_u32 vcc, s53, v209
    s_or_b64 s[82:83], s[82:83], vcc
    v_cmp_eq_u32 vcc, s53, v210
    s_or_b64 s[82:83], s[82:83], vcc
    v_cmp_eq_u32 vcc, s53, v211
    s_or_b64 s[82:83], s[82:83], vcc
    v_cmp_eq_u32 vcc, s53, v212
    s_or_b64 s[82:83], s[82:83], vcc
    v_cmp_eq_u32 vcc, s53, v213
    s_or_b64 s[82:83], s[82:83], vcc
    v_cmp_eq_u32 vcc, s53, v214
    s_or_b64 s[82:83], s[82:83], vcc
    v_cmp_eq_u32 vcc, s53, v215
    s_or_b64 s[82:83], s[82:83], vcc
    v_cmp_eq_u32 vcc, s53, v216
    s_or_b64 s[82:83], s[82:83], vcc
    v_cmp_eq_u32 vcc, s53, v217
    s_or_b64 s[82:83], s[82:83], vcc
    v_cmp_eq_u32 vcc, s53, v218
    s_or_b64 s[82:83], s[82:83], vcc
    v_cmp_eq_u32 vcc, s53, v219
    s_or_b64 s[82:83], s[82:83], vcc
    v_cmp_eq_u32 vcc, s53, v220
    s_or_b64 s[82:83], s[82:83], vcc
    v_cmp_eq_u32 vcc, s53, v221
    s_or_b64 s[82:83], s[82:83], vcc
    v_cmp_eq_u32 vcc, s53, v222
    s_or_b64 s[82:83], s[82:83], vcc
    v_cmp_eq_u32 vcc, s53, v223
    s_or_b64 s[82:83], s[82:83], vcc
    v_cmp_eq_u32 vcc, s53, v224
    s_or_b64 s[82:83], s[82:83], vcc
    v_cmp_eq_u32 vcc, s53, v225
    s_or_b64 s[82:83], s[82:83], vcc
    v_cmp_eq_u32 vcc, s53, v226
    s_or_b64 s[82:83], s[82:83], vcc
    v_cmp_eq_u32 vcc, s53, v227
    s_or_b64 s[82:83], s[82:83], vcc
    v_cmp_eq_u32 vcc, s53, v228
    s_or_b64 s[82:83], s[82:83], vcc
    v_cmp_eq_u32 vcc, s53, v229
    s_or_b64 s[82:83], s[82:83], vcc
    v_cmp_eq_u32 vcc, s53, v230
    s_or_b64 s[82:83], s[82:83], vcc
    v_cmp_eq_u32 vcc, s53, v231
    s_or_b64 s[82:83], s[82:83], vcc
    s_cbranch_scc0 L_col_ok
    s_add_u32 s59, s59, 1
    s_cmp_lt_u32 s59, 65536
    s_cbranch_scc1 L_col
    s_branch L_col_ok
L_qkv_early:
    s_add_u32 s65, s65, 1
    s_cmp_lt_u32 s65, 4
    s_cselect_b64 s[94:95], -1, 0
    s_waitcnt vmcnt(0)
    s_branch L_qkv
L_x3_say:
    s_lshl_b32 s53, s90, 5
    s_add_u32 s53, s53, s38
    s_lshl_b32 s53, s53, 5
    s_add_u32 s53, s53, s42
    s_lshl_b32 s53, s53, 2
    s_add_u32 s53, s53, 65552
    v_mov_b32 v2, 1
    s_mov_b64 exec, 1
    buffer_store_dword v2, off, s[4:7], s53 sc1
    s_mov_b64 exec, -1
    s_branch L_x3_said
L_proj_early:
    s_add_u32 s65, s65, 1
    s_cmp_lt_u32 s65, 4
    s_cselect_b64 s[94:95], -1, 0
    s_waitcnt vmcnt(0) lgkmcnt(0)
    s_branch L_proj
L_proj_redo:
    s_mov_b32 s53, 0x7f817f81
    s_mov_b64 s[82:83], 0
    v_cmp_eq_u32 vcc, s53, v16
    s_or_b64 s[82:83], s[82:83], vcc
    v_cmp_eq_u32 vcc, s53, v17
    s_or_b64 s[82:83], s[82:83], vcc
    v_cmp_eq_u32 vcc, s53, v18
    s_or_b64 s[82:83], s[82:83], vcc
    v_cmp_eq_u32 vcc, s53, v19
    s_or_b64 s[82:83], s[82:83], vcc
    v_cmp_eq_u32 vcc, s53, v20
    s_or_b64 s[82:83], s[82:83], vcc
    v_cmp_eq_u32 vcc, s53, v21
    s_or_b64 s[82:83], s[82:83], vcc
    v_cmp_eq_u32 vcc, s53, v22
    s_or_b64 s[82:83], s[82:83], vcc
    v_cmp_eq_u32 vcc, s53, v23
    s_or_b64 s[82:83], s[82:83], vcc
    v_cmp_eq_u32 vcc, s53, v24
    s_or_b64 s[82:83], s[82:83], vcc
    v_cmp_eq_u32 vcc, s53, v25
    s_or_b64 s[82:83], s[82:83], vcc
    v_cmp_eq_u32 vcc, s53, v26
    s_or_b64 s[82:83], s[82:83], vcc
    v_cmp_eq_u32 vcc, s53, v27
    s_or_b64 s[82:83], s[82:83], vcc
    v_cmp_eq_u32 vcc, s53, v28
    s_or_b64 s[82:83], s[82:83], vcc
    v_cmp_eq_u32 vcc, s53, v29
    s_or_b64 s[82:83], s[82:83], vcc
    v_cmp_eq_u32 vcc, s53, v30
    s_or_b64 s[82:83], s[82:83], vcc
    v_cmp_eq_u32 vcc, s53, v31
    s_or_b64 s[82:83], s[82:83], vcc
    v_cmp_eq_u32 vcc, s53, v32
    s_or_b64 s[82:83], s[82:83], vcc
    v_cmp_eq_u32 vcc, s53, v33
    s_or_b64 s[82:83], s[82:83], vcc
    v_cmp_eq_u32 vcc, s53, v34
    s_or_b64 s[82:83], s[82:83], vcc
    v_cmp_eq_u32 vcc, s53, v35
    s_or_b64 s[82:83], s[82:83], vcc
    v_cmp_eq_u32 vcc, s53, v36
    s_or_b64 s[82:83], s[82:83], vcc
    v_cmp_eq_u32 vcc, s53, v37
    s_or_b64 s[82:83], s[82:83], vcc
    v_cmp_eq_u32 vcc, s53, v38
    s_or_b64 s[82:83], s[82:83], vcc
    v_cmp_eq_u32 vcc, s53, v39
    s_or_b64 s[82:83], s[82:83], vcc
    v_cmp_eq_u32 vcc, s53, v40
    s_or_b64 s[82:83], s[82:83], vcc
    v_cmp_eq_u32 vcc, s53, v41
    s_or_b64 s[82:83], s[82:83], vcc
    v_cmp_eq_u32 vcc, s53, v42
    s_or_b64 s[82:83], s[82:83], vcc
    v_cmp_eq_u32 vcc, s53, v43
    s_or_b64 s[82:83], s[82:83], vcc
    v_cmp_eq_u32 vcc, s53, v44
    s_or_b64 s[82:83], s[82:83], vcc
    v_cmp_eq_u32 vcc, s53, v45
    s_or_b64 s[82:83], s[82:83], vcc
    v_cmp_eq_u32 vcc, s53, v46
    s_or_b64 s[82:83], s[82:83], vcc
    v_cmp_eq_u32 vcc, s53, v47
    s_or_b64 s[82:83], s[82:83], vcc
    v_cmp_eq_u32 vcc, s53, v48
    s_or_b64 s[82:83], s[82:83], vcc
    v_cmp_eq_u32 vcc, s53, v49
    s_or_b64 s[82:83], s[82:83], vcc
    v_cmp_eq_u32 vcc, s53, v50
    s_or_b64 s[82:83], s[82:83], vcc
    v_cmp_eq_u32 vcc, s53, v51
    s_or_b64 s[82:83], s[82:83], vcc
    v_cmp_eq_u32 vcc, s53, v52
    s_or_b64 s[82:83], s[82:83], vcc
    v_cmp_eq_u32 vcc, s53, v53
    s_or_b64 s[82:83], s[82:83], vcc
    v_cmp_eq_u32 vcc, s53, v54
    s_or_b64 s[82:83], s[82:83], vcc
    v_cmp_eq_u32 vcc, s53, v55
    s_or_b64 s[82:83], s[82:83], vcc
    v_cmp_eq_u32 vcc, s53, v56
    s_or_b64 s[82:83], s[82:83], vcc
    v_cmp_eq_u32 vcc, s53, v57
    s_or_b64 s[82:83], s[82:83], vcc
    v_cmp_eq_u32 vcc, s53, v58
    s_or_b64 s[82:83], s[82:83], vcc
    v_cmp_eq_u32 vcc, s53, v59
    s_or_b64 s[82:83], s[82:83], vcc
    v_cmp_eq_u32 vcc, s53, v60
    s_or_b64 s[82:83], s[82:83], vcc
    v_cmp_eq_u32 vcc, s53, v61
    s_or_b64 s[82:83], s[82:83], vcc
    v_cmp_eq_u32 vcc, s53, v62
    s_or_b64 s[82:83], s[82:83], vcc
    v_cmp_eq_u32 vcc, s53, v63
    s_or_b64 s[82:83], s[82:83], vcc
    v_cmp_eq_u32 vcc, s53, v64
    s_or_b64 s[82:83], s[82:83], vcc
    v_cmp_eq_u32 vcc, s53, v65
    s_or_b64 s[82:83], s[82:83], vcc
    v_cmp_eq_u32 vcc, s53, v66
    s_or_b64 s[82:83], s[82:83], vcc
    v_cmp_eq_u32 vcc, s53, v67
    s_or_b64 s[82:83], s[82:83], vcc
    v_cmp_eq_u32 vcc, s53, v68
    s_or_b64 s[82:83], s[82:83], vcc
    v_cmp_eq_u32 vcc, s53, v69
    s_or_b64 s[82:83], s[82:83], vcc
    v_cmp_eq_u32 vcc, s53, v70
    s_or_b64 s[82:83], s[82:83], vcc
    v_cmp_eq_u32 vcc, s53, v71
    s_or_b64 s[82:83], s[82:83], vcc
    v_cmp_eq_u32 vcc, s53, v72
    s_or_b64 s[82:83], s[82:83], vcc
    v_cmp_eq_u32 vcc, s53, v73
    s_or_b64 s[82:83], s[82:83], vcc
    v_cmp_eq_u32 vcc, s53, v74
    s_or_b64 s[82:83], s[82:83], vcc
    v_cmp_eq_u32 vcc, s53, v75
    s_or_b64 s[82:83], s[82:83], vcc
    v_cmp_eq_u32 vcc, s53, v76
    s_or_b64 s[82:83], s[82:83], vcc
    v_cmp_eq_u32 vcc, s53, v77
    s_or_b64 s[82:83], s[82:83], vcc
    v_cmp_eq_u32 vcc, s53, v78
    s_or_b64 s[82:83], s[82:83], vcc
    v_cmp_eq_u32 vcc, s53, v79
    s_or_b64 s[82:83], s[82:83], vcc
    v_cmp_eq_u32 vcc, s53, v80
    s_or_b64 s[82:83], s[82:83], vcc
    v_cmp_eq_u32 vcc, s53, v81
    s_or_b64 s[82:83], s[82:83], vcc
    v_cmp_eq_u32 vcc, s53, v82
    s_or_b64 s[82:83], s[82:83], vcc
    v_cmp_eq_u32 vcc, s53, v83
    s_or_b64 s[82:83], s[82:83], vcc
    v_cmp_eq_u32 vcc, s53, v84
    s_or_b64 s[82:83], s[82:83], vcc
    v_cmp_eq_u32 vcc, s53, v85
    s_or_b64 s[82:83], s[82:83], vcc
    v_cmp_eq_u32 vcc, s53, v86
    s_or_b64 s[82:83], s[82:83], vcc
    v_cmp_eq_u32 vcc, s53, v87
    s_or_b64 s[82:83], s[82:83], vcc
    v_cmp_eq_u32 vcc, s53, v88
    s_or_b64 s[82:83], s[82:83], vcc
    v_cmp_eq_u32 vcc, s53, v89
    s_or_b64 s[82:83], s[82:83], vcc
    v_cmp_eq_u32 vcc, s53, v90
    s_or_b64 s[82:83], s[82:83], vcc
    v_cmp_eq_u32 vcc, s53, v91
    s_or_b64 s[82:83], s[82:83], vcc
    v_cmp_eq_u32 vcc, s53, v92
    s_or_b64 s[82:83], s[82:83], vcc
    v_cmp_eq_u32 vcc, s53, v93
    s_or_b64 s[82:83], s[82:83], vcc
    v_cmp_eq_u32 vcc, s53, v94
    s_or_b64 s[82:83], s[82:83], vcc
    v_cmp_eq_u32 vcc, s53, v95
    s_or_b64 s[82:83], s[82:83], vcc
    s_cbranch_scc0 L_pr_116
    s_add_u32 s65, s65, 1
    s_cmp_lt_u32 s65, 4096
    s_cbranch_scc1 L_proj
L_pr_116:
    s_cmp_eq_u32 s42, 0
    s_cbranch_scc1 L_proj_ok0
    s_branch L_proj_ok1
L_hot_end:
L_fallback:
    v_mov_b32 v136, 0xff800000
    v_mov_b32 v137, 0xff800000
    s_mov_b32 s51, 0
L_fb_117:
    s_add_u32 s56, s51, s90
    s_and_b32 s56, s56, 7
    s_mul_i32 s56, s56, 22528
    s_add_u32 s56, s56, s61
    s_mov_b32 m0, s68
    s_waitcnt lgkmcnt(0)
    s_barrier
    buffer_load_dwordx4 v1, s[4:7], s56 offen offset:0 sc1 lds
    buffer_load_dwordx4 v1, s[4:7], s56 offen offset:1024 sc1 lds
    buffer_load_dwordx4 v1, s[4:7], s56 offen offset:1792 sc1 lds
    s_waitcnt vmcnt(0)
    s_barrier
    ds_read_b64 v[124:125], v145 offset:0
    ds_read_b128 v[116:119], v144 offset:0
    ds_read_b64_tr_b16 v[128:129], v146 offset:0
    ds_read_b64_tr_b16 v[130:131], v146 offset:192
    ds_read_b64_tr_b16 v[132:133], v146 offset:768
    ds_read_b64_tr_b16 v[134:135], v146 offset:960
    s_waitcnt lgkmcnt(0)
    v_mfma_f32_32x32x4_2b_bf16 v[8:39], v[124:125], v[112:113], 0
    s_nop 15
    s_nop 1
    v_mfma_f32_32x32x16_bf16 v[8:23], v[116:119], v[104:107], v[8:23]
    v_mfma_f32_32x32x16_bf16 v[24:39], v[116:119], v[108:111], v[24:39]
    s_nop 10
    v_max3_f32 v136, v136, v8, v9
    v_max3_f32 v136, v136, v10, v11
    v_max3_f32 v136, v136, v12, v13
    v_max3_f32 v136, v136, v14, v15
    v_max3_f32 v136, v136, v16, v17
    v_max3_f32 v136, v136, v18, v19
    v_max3_f32 v136, v136, v20, v21
    v_max3_f32 v136, v136, v22, v23
    v_max3_f32 v137, v137, v24, v25
    v_max3_f32 v137, v137, v26, v27
    v_max3_f32 v137, v137, v28, v29
    v_max3_f32 v137, v137, v30, v31
    v_max3_f32 v137, v137, v32, v33
    v_max3_f32 v137, v137, v34, v35
    v_max3_f32 v137, v137, v36, v37
    v_max3_f32 v137, v137, v38, v39
    ds_read_b64 v[124:125], v145 offset:2816
    ds_read_b128 v[116:119], v144 offset:2816
    ds_read_b64_tr_b16 v[128:129], v146 offset:2816
    ds_read_b64_tr_b16 v[130:131], v146 offset:3008
    ds_read_b64_tr_b16 v[132:133], v146 offset:3584
    ds_read_b64_tr_b16 v[134:135], v146 offset:3776
    s_waitcnt lgkmcnt(0)
    v_mfma_f32_32x32x4_2b_bf16 v[8:39], v[124:125], v[112:113], 0
    s_nop 15
    s_nop 1
    v_mfma_f32_32x32x16_bf16 v[8:23], v[116:119], v[104:107], v[8:23]
    v_mfma_f32_32x32x16_bf16 v[24:39], v[116:119], v[108:111], v[24:39]
    s_nop 10
    v_max3_f32 v136, v136, v8, v9
    v_max3_f32 v136, v136, v10, v11
    v_max3_f32 v136, v136, v12, v13
    v_max3_f32 v136, v136, v14, v15
    v_max3_f32 v136, v136, v16, v17
    v_max3_f32 v136, v136, v18, v19
    v_max3_f32 v136, v136, v20, v21
    v_max3_f32 v136, v136, v22, v23
    v_max3_f32 v137, v137, v24, v25
    v_max3_f32 v137, v137, v26, v27
    v_max3_f32 v137, v137, v28, v29
    v_max3_f32 v137, v137, v30, v31
    v_max3_f32 v137, v137, v32, v33
    v_max3_f32 v137, v137, v34, v35
    v_max3_f32 v137, v137, v36, v37
    v_max3_f32 v137, v137, v38, v39
    ds_read_b64 v[124:125], v145 offset:5632
    ds_read_b128 v[116:119], v144 offset:5632
    ds_read_b64_tr_b16 v[128:129], v146 offset:5632
    ds_read_b64_tr_b16 v[130:131], v146 offset:5824
    ds_read_b64_tr_b16 v[132:133], v146 offset:6400
    ds_read_b64_tr_b16 v[134:135], v146 offset:6592
    s_waitcnt lgkmcnt(0)
    v_mfma_f32_32x32x4_2b_bf16 v[8:39], v[124:125], v[112:113], 0
    s_nop 15
    s_nop 1
    v_mfma_f32_32x32x16_bf16 v[8:23], v[116:119], v[104:107], v[8:23]
    v_mfma_f32_32x32x16_bf16 v[24:39], v[116:119], v[108:111], v[24:39]
    s_nop 10
    v_max3_f32 v136, v136, v8, v9
    v_max3_f32 v136, v136, v10, v11
    v_max3_f32 v136, v136, v12, v13
    v_max3_f32 v136, v136, v14, v15
    v_max3_f32 v136, v136, v16, v17
    v_max3_f32 v136, v136, v18, v19
    v_max3_f32 v136, v136, v20, v21
    v_max3_f32 v136, v136, v22, v23
    v_max3_f32 v137, v137, v24, v25
    v_max3_f32 v137, v137, v26, v27
    v_max3_f32 v137, v137, v28, v29
    v_max3_f32 v137, v137, v30, v31
    v_max3_f32 v137, v137, v32, v33
    v_max3_f32 v137, v137, v34, v35
    v_max3_f32 v137, v137, v36, v37
    v_max3_f32 v137, v137, v38, v39
    ds_read_b64 v[124:125], v145 offset:8448
    ds_read_b128 v[116:119], v144 offset:8448
    ds_read_b64_tr_b16 v[128:129], v146 offset:8448
    ds_read_b64_tr_b16 v[130:131], v146 offset:8640
    ds_read_b64_tr_b16 v[132:133], v146 offset:9216
    ds_read_b64_tr_b16 v[134:135], v146 offset:9408
    s_waitcnt lgkmcnt(0)
    v_mfma_f32_32x32x4_2b_bf16 v[8:39], v[124:125], v[112:113], 0
    s_nop 15
    s_nop 1
    v_mfma_f32_32x32x16_bf16 v[8:23], v[116:119], v[104:107], v[8:23]
    v_mfma_f32_32x32x16_bf16 v[24:39], v[116:119], v[108:111], v[24:39]
    s_nop 10
    v_max3_f32 v136, v136, v8, v9
    v_max3_f32 v136, v136, v10, v11
    v_max3_f32 v136, v136, v12, v13
    v_max3_f32 v136, v136, v14, v15
    v_max3_f32 v136, v136, v16, v17
    v_max3_f32 v136, v136, v18, v19
    v_max3_f32 v136, v136, v20, v21
    v_max3_f32 v136, v136, v22, v23
    v_max3_f32 v137, v137, v24, v25
    v_max3_f32 v137, v137, v26, v27
    v_max3_f32 v137, v137, v28, v29
    v_max3_f32 v137, v137, v30, v31
    v_max3_f32 v137, v137, v32, v33
    v_max3_f32 v137, v137, v34, v35
    v_max3_f32 v137, v137, v36, v37
    v_max3_f32 v137, v137, v38, v39
    s_add_u32 s51, s51, 1
    s_cmp_lt_u32 s51, 8
    s_cbranch_scc1 L_fb_117
    v_mov_b32 v138, v136
    s_nop 1
    v_permlane32_swap_b32 v136, v138
    v_max_f32 v136, v136, v138
    v_mov_b32 v138, v137
    s_nop 1
    v_permlane32_swap_b32 v137, v138
    v_max_f32 v137, v137, v138
    s_lshl_b32 s52, s36, 9
    s_add_u32 s52, s52, 147456
    v_lshl_add_u32 v140, v0, 3, s52
    v_xor_b32 v141, 2048, v140
    ds_write_b64 v140, v[136:137]
    s_waitcnt lgkmcnt(0)
    s_barrier
    ds_read_b64 v[138:139], v141
    s_waitcnt lgkmcnt(0)
    v_max_f32 v136, v136, v139
    v_max_f32 v137, v137, v138
    v_sub_f32 v40, 0, v136
    v_sub_f32 v41, 0, v136
    v_sub_f32 v42, 0, v136
    v_sub_f32 v43, 0, v136
    v_sub_f32 v44, 0, v136
    v_sub_f32 v45, 0, v136
    v_sub_f32 v46, 0, v136
    v_sub_f32 v47, 0, v136
    v_sub_f32 v48, 0, v136
    v_sub_f32 v49, 0, v136
    v_sub_f32 v50, 0, v136
    v_sub_f32 v51, 0, v136
    v_sub_f32 v52, 0, v136
    v_sub_f32 v53, 0, v136
    v_sub_f32 v54, 0, v136
    v_sub_f32 v55, 0, v136
    v_sub_f32 v56, 0, v137
    v_sub_f32 v57, 0, v137
    v_sub_f32 v58, 0, v137
    v_sub_f32 v59, 0, v137
    v_sub_f32 v60, 0, v137
    v_sub_f32 v61, 0, v137
    v_sub_f32 v62, 0, v137
    v_sub_f32 v63, 0, v137
    v_sub_f32 v64, 0, v137
    v_sub_f32 v65, 0, v137
    v_sub_f32 v66, 0, v137
    v_sub_f32 v67, 0, v137
    v_sub_f32 v68, 0, v137
    v_sub_f32 v69, 0, v137
    v_sub_f32 v70, 0, v137
    v_sub_f32 v71, 0, v137
    v_mov_b32 v72, 0
    v_mov_b32 v73, 0
    v_mov_b32 v74, 0
    v_mov_b32 v75, 0
    v_mov_b32 v76, 0
    v_mov_b32 v77, 0
    v_mov_b32 v78, 0
    v_mov_b32 v79, 0
    v_mov_b32 v80, 0
    v_mov_b32 v81, 0
    v_mov_b32 v82, 0
    v_mov_b32 v83, 0
    v_mov_b32 v84, 0
    v_mov_b32 v85, 0
    v_mov_b32 v86, 0
    v_mov_b32 v87, 0
    v_mov_b32 v88, 0
    v_mov_b32 v89, 0
    v_mov_b32 v90, 0
    v_mov_b32 v91, 0
    v_mov_b32 v92, 0
    v_mov_b32 v93, 0
    v_mov_b32 v94, 0
    v_mov_b32 v95, 0
    v_mov_b32 v96, 0
    v_mov_b32 v97, 0
    v_mov_b32 v98, 0
    v_mov_b32 v99, 0
    v_mov_b32 v100, 0
    v_mov_b32 v101, 0
    v_mov_b32 v102, 0
    v_mov_b32 v103, 0
    s_mov_b32 s51, 0
L_fb_118:
    s_add_u32 s56, s51, s90
    s_and_b32 s56, s56, 7
    s_mul_i32 s56, s56, 22528
    s_add_u32 s56, s56, s61
    s_mov_b32 m0, s68
    s_waitcnt lgkmcnt(0)
    s_barrier
    buffer_load_dwordx4 v1, s[4:7], s56 offen offset:0 sc1 lds
    buffer_load_dwordx4 v1, s[4:7], s56 offen offset:1024 sc1 lds
    buffer_load_dwordx4 v1, s[4:7], s56 offen offset:1792 sc1 lds
    s_waitcnt vmcnt(0)
    s_barrier
    ds_read_b64 v[124:125], v145 offset:0
    ds_read_b128 v[116:119], v144 offset:0
    ds_read_b64_tr_b16 v[128:129], v146 offset:0
    ds_read_b64_tr_b16 v[130:131], v146 offset:192
    ds_read_b64_tr_b16 v[132:133], v146 offset:768
    ds_read_b64_tr_b16 v[134:135], v146 offset:960
    s_waitcnt lgkmcnt(0)
    v_mfma_f32_32x32x4_2b_bf16 v[8:39], v[124:125], v[112:113], v[40:71]
    s_nop 15
    s_nop 1
    v_mfma_f32_32x32x16_bf16 v[8:23], v[116:119], v[104:107], v[8:23]
    v_mfma_f32_32x32x16_bf16 v[24:39], v[116:119], v[108:111], v[24:39]
    s_nop 10
    v_exp_f32 v8, v8
    v_exp_f32 v9, v9
    v_exp_f32 v10, v10
    v_exp_f32 v11, v11
    v_exp_f32 v12, v12
    v_exp_f32 v13, v13
    v_exp_f32 v14, v14
    v_exp_f32 v15, v15
    v_exp_f32 v16, v16
    v_exp_f32 v17, v17
    v_exp_f32 v18, v18
    v_exp_f32 v19, v19
    v_exp_f32 v20, v20
    v_exp_f32 v21, v21
    v_exp_f32 v22, v22
    v_exp_f32 v23, v23
    v_exp_f32 v24, v24
    v_exp_f32 v25, v25
    v_exp_f32 v26, v26
    v_exp_f32 v27, v27
    v_exp_f32 v28, v28
    v_exp_f32 v29, v29
    v_exp_f32 v30, v30
    v_exp_f32 v31, v31
    v_exp_f32 v32, v32
    v_exp_f32 v33, v33
    v_exp_f32 v34, v34
    v_exp_f32 v35, v35
    v_exp_f32 v36, v36
    v_exp_f32 v37, v37
    v_exp_f32 v38, v38
    v_exp_f32 v39, v39
    v_smfmac_f32_32x32x32_bf16 v[72:87], v[128:131], v[8:15], v114
    v_smfmac_f32_32x32x32_bf16 v[72:87], v[132:135], v[16:23], v114
    v_smfmac_f32_32x32x32_bf16 v[88:103], v[128:131], v[24:31], v114
    v_smfmac_f32_32x32x32_bf16 v[88:103], v[132:135], v[32:39], v114
    ds_read_b64 v[124:125], v145 offset:2816
    ds_read_b128 v[116:119], v144 offset:2816
    ds_read_b64_tr_b16 v[128:129], v146 offset:2816
    ds_read_b64_tr_b16 v[130:131], v146 offset:3008
    ds_read_b64_tr_b16 v[132:133], v146 offset:3584
    ds_read_b64_tr_b16 v[134:135], v146 offset:3776
    s_waitcnt lgkmcnt(0)
    v_mfma_f32_32x32x4_2b_bf16 v[8:39], v[124:125], v[112:113], v[40:71]
    s_nop 15
    s_nop 1
    v_mfma_f32_32x32x16_bf16 v[8:23], v[116:119], v[104:107], v[8:23]
    v_mfma_f32_32x32x16_bf16 v[24:39], v[116:119], v[108:111], v[24:39]
    s_nop 10
    v_exp_f32 v8, v8
    v_exp_f32 v9, v9
    v_exp_f32 v10, v10
    v_exp_f32 v11, v11
    v_exp_f32 v12, v12
    v_exp_f32 v13, v13
    v_exp_f32 v14, v14
    v_exp_f32 v15, v15
    v_exp_f32 v16, v16
    v_exp_f32 v17, v17
    v_exp_f32 v18, v18
    v_exp_f32 v19, v19
    v_exp_f32 v20, v20
    v_exp_f32 v21, v21
    v_exp_f32 v22, v22
    v_exp_f32 v23, v23
    v_exp_f32 v24, v24
    v_exp_f32 v25, v25
    v_exp_f32 v26, v26
    v_exp_f32 v27, v27
    v_exp_f32 v28, v28
    v_exp_f32 v29, v29
    v_exp_f32 v30, v30
    v_exp_f32 v31, v31
    v_exp_f32 v32, v32
    v_exp_f32 v33, v33
    v_exp_f32 v34, v34
    v_exp_f32 v35, v35
    v_exp_f32 v36, v36
    v_exp_f32 v37, v37
    v_exp_f32 v38, v38
    v_exp_f32 v39, v39
    v_smfmac_f32_32x32x32_bf16 v[72:87], v[128:131], v[8:15], v114
    v_smfmac_f32_32x32x32_bf16 v[72:87], v[132:135], v[16:23], v114
    v_smfmac_f32_32x32x32_bf16 v[88:103], v[128:131], v[24:31], v114
    v_smfmac_f32_32x32x32_bf16 v[88:103], v[132:135], v[32:39], v114
    ds_read_b64 v[124:125], v145 offset:5632
    ds_read_b128 v[116:119], v144 offset:5632
    ds_read_b64_tr_b16 v[128:129], v146 offset:5632
    ds_read_b64_tr_b16 v[130:131], v146 offset:5824
    ds_read_b64_tr_b16 v[132:133], v146 offset:6400
    ds_read_b64_tr_b16 v[134:135], v146 offset:6592
    s_waitcnt lgkmcnt(0)
    v_mfma_f32_32x32x4_2b_bf16 v[8:39], v[124:125], v[112:113], v[40:71]
    s_nop 15
    s_nop 1
    v_mfma_f32_32x32x16_bf16 v[8:23], v[116:119], v[104:107], v[8:23]
    v_mfma_f32_32x32x16_bf16 v[24:39], v[116:119], v[108:111], v[24:39]
    s_nop 10
    v_exp_f32 v8, v8
    v_exp_f32 v9, v9
    v_exp_f32 v10, v10
    v_exp_f32 v11, v11
    v_exp_f32 v12, v12
    v_exp_f32 v13, v13
    v_exp_f32 v14, v14
    v_exp_f32 v15, v15
    v_exp_f32 v16, v16
    v_exp_f32 v17, v17
    v_exp_f32 v18, v18
    v_exp_f32 v19, v19
    v_exp_f32 v20, v20
    v_exp_f32 v21, v21
    v_exp_f32 v22, v22
    v_exp_f32 v23, v23
    v_exp_f32 v24, v24
    v_exp_f32 v25, v25
    v_exp_f32 v26, v26
    v_exp_f32 v27, v27
    v_exp_f32 v28, v28
    v_exp_f32 v29, v29
    v_exp_f32 v30, v30
    v_exp_f32 v31, v31
    v_exp_f32 v32, v32
    v_exp_f32 v33, v33
    v_exp_f32 v34, v34
    v_exp_f32 v35, v35
    v_exp_f32 v36, v36
    v_exp_f32 v37, v37
    v_exp_f32 v38, v38
    v_exp_f32 v39, v39
    v_smfmac_f32_32x32x32_bf16 v[72:87], v[128:131], v[8:15], v114
    v_smfmac_f32_32x32x32_bf16 v[72:87], v[132:135], v[16:23], v114
    v_smfmac_f32_32x32x32_bf16 v[88:103], v[128:131], v[24:31], v114
    v_smfmac_f32_32x32x32_bf16 v[88:103], v[132:135], v[32:39], v114
    ds_read_b64 v[124:125], v145 offset:8448
    ds_read_b128 v[116:119], v144 offset:8448
    ds_read_b64_tr_b16 v[128:129], v146 offset:8448
    ds_read_b64_tr_b16 v[130:131], v146 offset:8640
    ds_read_b64_tr_b16 v[132:133], v146 offset:9216
    ds_read_b64_tr_b16 v[134:135], v146 offset:9408
    s_waitcnt lgkmcnt(0)
    v_mfma_f32_32x32x4_2b_bf16 v[8:39], v[124:125], v[112:113], v[40:71]
    s_nop 15
    s_nop 1
    v_mfma_f32_32x32x16_bf16 v[8:23], v[116:119], v[104:107], v[8:23]
    v_mfma_f32_32x32x16_bf16 v[24:39], v[116:119], v[108:111], v[24:39]
    s_nop 10
    v_exp_f32 v8, v8
    v_exp_f32 v9, v9
    v_exp_f32 v10, v10
    v_exp_f32 v11, v11
    v_exp_f32 v12, v12
    v_exp_f32 v13, v13
    v_exp_f32 v14, v14
    v_exp_f32 v15, v15
    v_exp_f32 v16, v16
    v_exp_f32 v17, v17
    v_exp_f32 v18, v18
    v_exp_f32 v19, v19
    v_exp_f32 v20, v20
    v_exp_f32 v21, v21
    v_exp_f32 v22, v22
    v_exp_f32 v23, v23
    v_exp_f32 v24, v24
    v_exp_f32 v25, v25
    v_exp_f32 v26, v26
    v_exp_f32 v27, v27
    v_exp_f32 v28, v28
    v_exp_f32 v29, v29
    v_exp_f32 v30, v30
    v_exp_f32 v31, v31
    v_exp_f32 v32, v32
    v_exp_f32 v33, v33
    v_exp_f32 v34, v34
    v_exp_f32 v35, v35
    v_exp_f32 v36, v36
    v_exp_f32 v37, v37
    v_exp_f32 v38, v38
    v_exp_f32 v39, v39
    v_smfmac_f32_32x32x32_bf16 v[72:87], v[128:131], v[8:15], v114
    v_smfmac_f32_32x32x32_bf16 v[72:87], v[132:135], v[16:23], v114
    v_smfmac_f32_32x32x32_bf16 v[88:103], v[128:131], v[24:31], v114
    v_smfmac_f32_32x32x32_bf16 v[88:103], v[132:135], v[32:39], v114
    s_add_u32 s51, s51, 1
    s_cmp_lt_u32 s51, 8
    s_cbranch_scc1 L_fb_118
    s_mov_b32 s91, 1
    s_barrier
    s_branch L_merge
L_big_put:
    s_lshl_b32 s52, s42, 3
    s_add_u32 s52, s52, s39
    s_lshl_b32 s52, s52, 5
    s_add_u32 s52, s52, s41
    s_lshl_b32 s52, s52, 8
    s_add_u32 s52, s52, 40337408
    v_lshlrev_b32 v193, 2, v0
    buffer_store_dword v7, v193, s[4:7], s52 offen sc1
    s_lshl_b32 s52, 16, s39
    s_or_b32 s52, s52, 1
    v_mov_b32 v193, s52
    v_mov_b32 v192, 0
    s_waitcnt vmcnt(0)
    v_cndmask_b32 v195, v195, v193, vcc
    v_cndmask_b32 v7, v7, v192, vcc
    s_branch L_big_ret
L_big_get:
    s_lshl_b32 s53, s42, 16
    s_lshl_b32 s52, s36, 11
    s_add_u32 s53, s53, s52
    s_add_u32 s53, s53, 40337408
    v_lshlrev_b32 v19, 3, v0
    s_add_u32 s52, s53, 0
    buffer_load_dwordx2 v[32:33], v19, s[4:7], s52 offen offset:0 sc1
    s_add_u32 s52, s53, 8192
    buffer_load_dwordx2 v[34:35], v19, s[4:7], s52 offen offset:0 sc1
    s_add_u32 s52, s53, 16384
    buffer_load_dwordx2 v[36:37], v19, s[4:7], s52 offen offset:0 sc1
    s_add_u32 s52, s53, 24576
    buffer_load_dwordx2 v[38:39], v19, s[4:7], s52 offen offset:0 sc1
    s_add_u32 s52, s53, 32768
    buffer_load_dwordx2 v[40:41], v19, s[4:7], s52 offen offset:0 sc1
    s_add_u32 s52, s53, 40960
    buffer_load_dwordx2 v[42:43], v19, s[4:7], s52 offen offset:0 sc1
    s_add_u32 s52, s53, 49152
    buffer_load_dwordx2 v[44:45], v19, s[4:7], s52 offen offset:0 sc1
    s_add_u32 s52, s53, 57344
    buffer_load_dwordx2 v[46:47], v19, s[4:7], s52 offen offset:0 sc1
    v_and_b32 v6, 0xfffff000, v112
    v_cvt_f32_u32 v6, v6
    v_cvt_f32_u32 v7, v113
    v_mul_f32 v6, 0x2e800000, v6
    v_fmamk_f32 v4, v7, 0x3e800000, v6
    v_and_b32 v6, 0xfffff000, v114
    v_cvt_f32_u32 v6, v6
    v_cvt_f32_u32 v7, v115
    v_mul_f32 v6, 0x2e800000, v6
    v_fmamk_f32 v5, v7, 0x3e800000, v6
    s_waitcnt vmcnt(0)
    v_bfe_i32 v6, v112, 4, 1
    v_and_b32 v6, v6, v32
    v_add_f32 v4, v4, v6
    v_bfe_i32 v6, v114, 4, 1
    v_and_b32 v6, v6, v33
    v_add_f32 v5, v5, v6
    v_bfe_i32 v6, v112, 5, 1
    v_and_b32 v6, v6, v34
    v_add_f32 v4, v4, v6
    v_bfe_i32 v6, v114, 5, 1
    v_and_b32 v6, v6, v35
    v_add_f32 v5, v5, v6
    v_bfe_i32 v6, v112, 6, 1
    v_and_b32 v6, v6, v36
    v_add_f32 v4, v4, v6
    v_bfe_i32 v6, v114, 6, 1
    v_and_b32 v6, v6, v37
    v_add_f32 v5, v5, v6
    v_bfe_i32 v6, v112, 7, 1
    v_and_b32 v6, v6, v38
    v_add_f32 v4, v4, v6
    v_bfe_i32 v6, v114, 7, 1
    v_and_b32 v6, v6, v39
    v_add_f32 v5, v5, v6
    v_bfe_i32 v6, v112, 8, 1
    v_and_b32 v6, v6, v40
    v_add_f32 v4, v4, v6
    v_bfe_i32 v6, v114, 8, 1
    v_and_b32 v6, v6, v41
    v_add_f32 v5, v5, v6
    v_bfe_i32 v6, v112, 9, 1
    v_and_b32 v6, v6, v42
    v_add_f32 v4, v4, v6
    v_bfe_i32 v6, v114, 9, 1
    v_and_b32 v6, v6, v43
    v_add_f32 v5, v5, v6
    v_bfe_i32 v6, v112, 10, 1
    v_and_b32 v6, v6, v44
    v_add_f32 v4, v4, v6
    v_bfe_i32 v6, v114, 10, 1
    v_and_b32 v6, v6, v45
    v_add_f32 v5, v5, v6
    v_bfe_i32 v6, v112, 11, 1
    v_and_b32 v6, v6, v46
    v_add_f32 v4, v4, v6
    v_bfe_i32 v6, v114, 11, 1
    v_and_b32 v6, v6, v47
    v_add_f32 v5, v5, v6
    v_fmamk_f32 v4, v4, 0x3acccccd, v8
    v_fmamk_f32 v5, v5, 0x3acccccd, v8
    v_rsq_f32 v4, v4
    v_rsq_f32 v5, v5
    s_nop 0
    v_cvt_pk_bf16_f32 v10, v4, v5
    v_cvt_pk_bf16_f32 v11, v4, -v5
    ds_write2st64_b32 v9, v10, v11 offset0:0 offset1:16
    s_add_u32 s52, s53, 0
    buffer_load_dwordx2 v[32:33], v19, s[4:7], s52 offen offset:512 sc1
    s_add_u32 s52, s53, 8192
    buffer_load_dwordx2 v[34:35], v19, s[4:7], s52 offen offset:512 sc1
    s_add_u32 s52, s53, 16384
    buffer_load_dwordx2 v[36:37], v19, s[4:7], s52 offen offset:512 sc1
    s_add_u32 s52, s53, 24576
    buffer_load_dwordx2 v[38:39], v19, s[4:7], s52 offen offset:512 sc1
    s_add_u32 s52, s53, 32768
    buffer_load_dwordx2 v[40:41], v19, s[4:7], s52 offen offset:512 sc1
    s_add_u32 s52, s53, 40960
    buffer_load_dwordx2 v[42:43], v19, s[4:7], s52 offen offset:512 sc1
    s_add_u32 s52, s53, 49152
    buffer_load_dwordx2 v[44:45], v19, s[4:7], s52 offen offset:512 sc1
    s_add_u32 s52, s53, 57344
    buffer_load_dwordx2 v[46:47], v19, s[4:7], s52 offen offset:512 sc1
    v_and_b32 v6, 0xfffff000, v116
    v_cvt_f32_u32 v6, v6
    v_cvt_f32_u32 v7, v117
    v_mul_f32 v6, 0x2e800000, v6
    v_fmamk_f32 v4, v7, 0x3e800000, v6
    v_and_b32 v6, 0xfffff000, v118
    v_cvt_f32_u32 v6, v6
    v_cvt_f32_u32 v7, v119
    v_mul_f32 v6, 0x2e800000, v6
    v_fmamk_f32 v5, v7, 0x3e800000, v6
    s_waitcnt vmcnt(0)
    v_bfe_i32 v6, v116, 4, 1
    v_and_b32 v6, v6, v32
    v_add_f32 v4, v4, v6
    v_bfe_i32 v6, v118, 4, 1
    v_and_b32 v6, v6, v33
    v_add_f32 v5, v5, v6
    v_bfe_i32 v6, v116, 5, 1
    v_and_b32 v6, v6, v34
    v_add_f32 v4, v4, v6
    v_bfe_i32 v6, v118, 5, 1
    v_and_b32 v6, v6, v35
    v_add_f32 v5, v5, v6
    v_bfe_i32 v6, v116, 6, 1
    v_and_b32 v6, v6, v36
    v_add_f32 v4, v4, v6
    v_bfe_i32 v6, v118, 6, 1
    v_and_b32 v6, v6, v37
    v_add_f32 v5, v5, v6
    v_bfe_i32 v6, v116, 7, 1
    v_and_b32 v6, v6, v38
    v_add_f32 v4, v4, v6
    v_bfe_i32 v6, v118, 7, 1
    v_and_b32 v6, v6, v39
    v_add_f32 v5, v5, v6
    v_bfe_i32 v6, v116, 8, 1
    v_and_b32 v6, v6, v40
    v_add_f32 v4, v4, v6
    v_bfe_i32 v6, v118, 8, 1
    v_and_b32 v6, v6, v41
    v_add_f32 v5, v5, v6
    v_bfe_i32 v6, v116, 9, 1
    v_and_b32 v6, v6, v42
    v_add_f32 v4, v4, v6
    v_bfe_i32 v6, v118, 9, 1
    v_and_b32 v6, v6, v43
    v_add_f32 v5, v5, v6
    v_bfe_i32 v6, v116, 10, 1
    v_and_b32 v6, v6, v44
    v_add_f32 v4, v4, v6
    v_bfe_i32 v6, v118, 10, 1
    v_and_b32 v6, v6, v45
    v_add_f32 v5, v5, v6
    v_bfe_i32 v6, v116, 11, 1
    v_and_b32 v6, v6, v46
    v_add_f32 v4, v4, v6
    v_bfe_i32 v6, v118, 11, 1
    v_and_b32 v6, v6, v47
    v_add_f32 v5, v5, v6
    v_fmamk_f32 v4, v4, 0x3acccccd, v8
    v_fmamk_f32 v5, v5, 0x3acccccd, v8
    v_rsq_f32 v4, v4
    v_rsq_f32 v5, v5
    s_nop 0
    v_cvt_pk_bf16_f32 v10, v4, v5
    v_cvt_pk_bf16_f32 v11, v4, -v5
    ds_write2st64_b32 v9, v10, v11 offset0:1 offset1:17
    s_add_u32 s52, s53, 0
    buffer_load_dwordx2 v[32:33], v19, s[4:7], s52 offen offset:1024 sc1
    s_add_u32 s52, s53, 8192
    buffer_load_dwordx2 v[34:35], v19, s[4:7], s52 offen offset:1024 sc1
    s_add_u32 s52, s53, 16384
    buffer_load_dwordx2 v[36:37], v19, s[4:7], s52 offen offset:1024 sc1
    s_add_u32 s52, s53, 24576
    buffer_load_dwordx2 v[38:39], v19, s[4:7], s52 offen offset:1024 sc1
    s_add_u32 s52, s53, 32768
    buffer_load_dwordx2 v[40:41], v19, s[4:7], s52 offen offset:1024 sc1
    s_add_u32 s52, s53, 40960
    buffer_load_dwordx2 v[42:43], v19, s[4:7], s52 offen offset:1024 sc1
    s_add_u32 s52, s53, 49152
    buffer_load_dwordx2 v[44:45], v19, s[4:7], s52 offen offset:1024 sc1
    s_add_u32 s52, s53, 57344
    buffer_load_dwordx2 v[46:47], v19, s[4:7], s52 offen offset:1024 sc1
    v_and_b32 v6, 0xfffff000, v120
    v_cvt_f32_u32 v6, v6
    v_cvt_f32_u32 v7, v121
    v_mul_f32 v6, 0x2e800000, v6
    v_fmamk_f32 v4, v7, 0x3e800000, v6
    v_and_b32 v6, 0xfffff000, v122
    v_cvt_f32_u32 v6, v6
    v_cvt_f32_u32 v7, v123
    v_mul_f32 v6, 0x2e800000, v6
    v_fmamk_f32 v5, v7, 0x3e800000, v6
    s_waitcnt vmcnt(0)
    v_bfe_i32 v6, v120, 4, 1
    v_and_b32 v6, v6, v32
    v_add_f32 v4, v4, v6
    v_bfe_i32 v6, v122, 4, 1
    v_and_b32 v6, v6, v33
    v_add_f32 v5, v5, v6
    v_bfe_i32 v6, v120, 5, 1
    v_and_b32 v6, v6, v34
    v_add_f32 v4, v4, v6
    v_bfe_i32 v6, v122, 5, 1
    v_and_b32 v6, v6, v35
    v_add_f32 v5, v5, v6
    v_bfe_i32 v6, v120, 6, 1
    v_and_b32 v6, v6, v36
    v_add_f32 v4, v4, v6
    v_bfe_i32 v6, v122, 6, 1
    v_and_b32 v6, v6, v37
    v_add_f32 v5, v5, v6
    v_bfe_i32 v6, v120, 7, 1
    v_and_b32 v6, v6, v38
    v_add_f32 v4, v4, v6
    v_bfe_i32 v6, v122, 7, 1
    v_and_b32 v6, v6, v39
    v_add_f32 v5, v5, v6
    v_bfe_i32 v6, v120, 8, 1
    v_and_b32 v6, v6, v40
    v_add_f32 v4, v4, v6
    v_bfe_i32 v6, v122, 8, 1
    v_and_b32 v6, v6, v41
    v_add_f32 v5, v5, v6
    v_bfe_i32 v6, v120, 9, 1
    v_and_b32 v6, v6, v42
    v_add_f32 v4, v4, v6
    v_bfe_i32 v6, v122, 9, 1
    v_and_b32 v6, v6, v43
    v_add_f32 v5, v5, v6
    v_bfe_i32 v6, v120, 10, 1
    v_and_b32 v6, v6, v44
    v_add_f32 v4, v4, v6
    v_bfe_i32 v6, v122, 10, 1
    v_and_b32 v6, v6, v45
    v_add_f32 v5, v5, v6
    v_bfe_i32 v6, v120, 11, 1
    v_and_b32 v6, v6, v46
    v_add_f32 v4, v4, v6
    v_bfe_i32 v6, v122, 11, 1
    v_and_b32 v6, v6, v47
    v_add_f32 v5, v5, v6
    v_fmamk_f32 v4, v4, 0x3acccccd, v8
    v_fmamk_f32 v5, v5, 0x3acccccd, v8
    v_rsq_f32 v4, v4
    v_rsq_f32 v5, v5
    s_nop 0
    v_cvt_pk_bf16_f32 v10, v4, v5
    v_cvt_pk_bf16_f32 v11, v4, -v5
    ds_write2st64_b32 v9, v10, v11 offset0:2 offset1:18
    s_add_u32 s52, s53, 0
    buffer_load_dwordx2 v[32:33], v19, s[4:7], s52 offen offset:1536 sc1
    s_add_u32 s52, s53, 8192
    buffer_load_dwordx2 v[34:35], v19, s[4:7], s52 offen offset:1536 sc1
    s_add_u32 s52, s53, 16384
    buffer_load_dwordx2 v[36:37], v19, s[4:7], s52 offen offset:1536 sc1
    s_add_u32 s52, s53, 24576
    buffer_load_dwordx2 v[38:39], v19, s[4:7], s52 offen offset:1536 sc1
    s_add_u32 s52, s53, 32768
    buffer_load_dwordx2 v[40:41], v19, s[4:7], s52 offen offset:1536 sc1
    s_add_u32 s52, s53, 40960
    buffer_load_dwordx2 v[42:43], v19, s[4:7], s52 offen offset:1536 sc1
    s_add_u32 s52, s53, 49152
    buffer_load_dwordx2 v[44:45], v19, s[4:7], s52 offen offset:1536 sc1
    s_add_u32 s52, s53, 57344
    buffer_load_dwordx2 v[46:47], v19, s[4:7], s52 offen offset:1536 sc1
    v_and_b32 v6, 0xfffff000, v124
    v_cvt_f32_u32 v6, v6
    v_cvt_f32_u32 v7, v125
    v_mul_f32 v6, 0x2e800000, v6
    v_fmamk_f32 v4, v7, 0x3e800000, v6
    v_and_b32 v6, 0xfffff000, v126
    v_cvt_f32_u32 v6, v6
    v_cvt_f32_u32 v7, v127
    v_mul_f32 v6, 0x2e800000, v6
    v_fmamk_f32 v5, v7, 0x3e800000, v6
    s_waitcnt vmcnt(0)
    v_bfe_i32 v6, v124, 4, 1
    v_and_b32 v6, v6, v32
    v_add_f32 v4, v4, v6
    v_bfe_i32 v6, v126, 4, 1
    v_and_b32 v6, v6, v33
    v_add_f32 v5, v5, v6
    v_bfe_i32 v6, v124, 5, 1
    v_and_b32 v6, v6, v34
    v_add_f32 v4, v4, v6
    v_bfe_i32 v6, v126, 5, 1
    v_and_b32 v6, v6, v35
    v_add_f32 v5, v5, v6
    v_bfe_i32 v6, v124, 6, 1
    v_and_b32 v6, v6, v36
    v_add_f32 v4, v4, v6
    v_bfe_i32 v6, v126, 6, 1
    v_and_b32 v6, v6, v37
    v_add_f32 v5, v5, v6
    v_bfe_i32 v6, v124, 7, 1
    v_and_b32 v6, v6, v38
    v_add_f32 v4, v4, v6
    v_bfe_i32 v6, v126, 7, 1
    v_and_b32 v6, v6, v39
    v_add_f32 v5, v5, v6
    v_bfe_i32 v6, v124, 8, 1
    v_and_b32 v6, v6, v40
    v_add_f32 v4, v4, v6
    v_bfe_i32 v6, v126, 8, 1
    v_and_b32 v6, v6, v41
    v_add_f32 v5, v5, v6
    v_bfe_i32 v6, v124, 9, 1
    v_and_b32 v6, v6, v42
    v_add_f32 v4, v4, v6
    v_bfe_i32 v6, v126, 9, 1
    v_and_b32 v6, v6, v43
    v_add_f32 v5, v5, v6
    v_bfe_i32 v6, v124, 10, 1
    v_and_b32 v6, v6, v44
    v_add_f32 v4, v4, v6
    v_bfe_i32 v6, v126, 10, 1
    v_and_b32 v6, v6, v45
    v_add_f32 v5, v5, v6
    v_bfe_i32 v6, v124, 11, 1
    v_and_b32 v6, v6, v46
    v_add_f32 v4, v4, v6
    v_bfe_i32 v6, v126, 11, 1
    v_and_b32 v6, v6, v47
    v_add_f32 v5, v5, v6
    v_fmamk_f32 v4, v4, 0x3acccccd, v8
    v_fmamk_f32 v5, v5, 0x3acccccd, v8
    v_rsq_f32 v4, v4
    v_rsq_f32 v5, v5
    s_nop 0
    v_cvt_pk_bf16_f32 v10, v4, v5
    v_cvt_pk_bf16_f32 v11, v4, -v5
    ds_write2st64_b32 v9, v10, v11 offset0:3 offset1:19
    s_branch L_big_done
L_qkv_redo:
    s_mov_b32 s53, 0x7f817f81
    s_mov_b64 s[82:83], 0
    v_cmp_eq_u32 vcc, s53, v92
    s_or_b64 s[82:83], s[82:83], vcc
    v_cmp_eq_u32 vcc, s53, v93
    s_or_b64 s[82:83], s[82:83], vcc
    v_cmp_eq_u32 vcc, s53, v94
    s_or_b64 s[82:83], s[82:83], vcc
    v_cmp_eq_u32 vcc, s53, v95
    s_or_b64 s[82:83], s[82:83], vcc
    v_cmp_eq_u32 vcc, s53, v96
    s_or_b64 s[82:83], s[82:83], vcc
    v_cmp_eq_u32 vcc, s53, v97
    s_or_b64 s[82:83], s[82:83], vcc
    v_cmp_eq_u32 vcc, s53, v98
    s_or_b64 s[82:83], s[82:83], vcc
    v_cmp_eq_u32 vcc, s53, v99
    s_or_b64 s[82:83], s[82:83], vcc
    v_cmp_eq_u32 vcc, s53, v100
    s_or_b64 s[82:83], s[82:83], vcc
    v_cmp_eq_u32 vcc, s53, v101
    s_or_b64 s[82:83], s[82:83], vcc
    v_cmp_eq_u32 vcc, s53, v102
    s_or_b64 s[82:83], s[82:83], vcc
    v_cmp_eq_u32 vcc, s53, v103
    s_or_b64 s[82:83], s[82:83], vcc
    v_cmp_eq_u32 vcc, s53, v104
    s_or_b64 s[82:83], s[82:83], vcc
    v_cmp_eq_u32 vcc, s53, v105
    s_or_b64 s[82:83], s[82:83], vcc
    v_cmp_eq_u32 vcc, s53, v106
    s_or_b64 s[82:83], s[82:83], vcc
    v_cmp_eq_u32 vcc, s53, v107
    s_or_b64 s[82:83], s[82:83], vcc
    v_cmp_eq_u32 vcc, s53, v108
    s_or_b64 s[82:83], s[82:83], vcc
    v_cmp_eq_u32 vcc, s53, v109
    s_or_b64 s[82:83], s[82:83], vcc
    v_cmp_eq_u32 vcc, s53, v110
    s_or_b64 s[82:83], s[82:83], vcc
    v_cmp_eq_u32 vcc, s53, v111
    s_or_b64 s[82:83], s[82:83], vcc
    v_cmp_eq_u32 vcc, s53, v112
    s_or_b64 s[82:83], s[82:83], vcc
    v_cmp_eq_u32 vcc, s53, v113
    s_or_b64 s[82:83], s[82:83], vcc
    v_cmp_eq_u32 vcc, s53, v114
    s_or_b64 s[82:83], s[82:83], vcc
    v_cmp_eq_u32 vcc, s53, v115
    s_or_b64 s[82:83], s[82:83], vcc
    v_cmp_eq_u32 vcc, s53, v116
    s_or_b64 s[82:83], s[82:83], vcc
    v_cmp_eq_u32 vcc, s53, v117
    s_or_b64 s[82:83], s[82:83], vcc
    v_cmp_eq_u32 vcc, s53, v118
    s_or_b64 s[82:83], s[82:83], vcc
    v_cmp_eq_u32 vcc, s53, v119
    s_or_b64 s[82:83], s[82:83], vcc
    v_cmp_eq_u32 vcc, s53, v120
    s_or_b64 s[82:83], s[82:83], vcc
    v_cmp_eq_u32 vcc, s53, v121
    s_or_b64 s[82:83], s[82:83], vcc
    v_cmp_eq_u32 vcc, s53, v122
    s_or_b64 s[82:83], s[82:83], vcc
    v_cmp_eq_u32 vcc, s53, v123
    s_or_b64 s[82:83], s[82:83], vcc
    v_cmp_eq_u32 vcc, s53, v124
    s_or_b64 s[82:83], s[82:83], vcc
    v_cmp_eq_u32 vcc, s53, v125
    s_or_b64 s[82:83], s[82:83], vcc
    v_cmp_eq_u32 vcc, s53, v126
    s_or_b64 s[82:83], s[82:83], vcc
    v_cmp_eq_u32 vcc, s53, v127
    s_or_b64 s[82:83], s[82:83], vcc
    v_cmp_eq_u32 vcc, s53, v128
    s_or_b64 s[82:83], s[82:83], vcc
    v_cmp_eq_u32 vcc, s53, v129
    s_or_b64 s[82:83], s[82:83], vcc
    v_cmp_eq_u32 vcc, s53, v130
    s_or_b64 s[82:83], s[82:83], vcc
    v_cmp_eq_u32 vcc, s53, v131
    s_or_b64 s[82:83], s[82:83], vcc
    v_cmp_eq_u32 vcc, s53, v132
    s_or_b64 s[82:83], s[82:83], vcc
    v_cmp_eq_u32 vcc, s53, v133
    s_or_b64 s[82:83], s[82:83], vcc
    v_cmp_eq_u32 vcc, s53, v134
    s_or_b64 s[82:83], s[82:83], vcc
    v_cmp_eq_u32 vcc, s53, v135
    s_or_b64 s[82:83], s[82:83], vcc
    v_cmp_eq_u32 vcc, s53, v136
    s_or_b64 s[82:83], s[82:83], vcc
    v_cmp_eq_u32 vcc, s53, v137
    s_or_b64 s[82:83], s[82:83], vcc
    v_cmp_eq_u32 vcc, s53, v138
    s_or_b64 s[82:83], s[82:83], vcc
    v_cmp_eq_u32 vcc, s53, v139
    s_or_b64 s[82:83], s[82:83], vcc
    v_cmp_eq_u32 vcc, s53, v140
    s_or_b64 s[82:83], s[82:83], vcc
    v_cmp_eq_u32 vcc, s53, v141
    s_or_b64 s[82:83], s[82:83], vcc
    v_cmp_eq_u32 vcc, s53, v142
    s_or_b64 s[82:83], s[82:83], vcc
    v_cmp_eq_u32 vcc, s53, v143
    s_or_b64 s[82:83], s[82:83], vcc
    v_cmp_eq_u32 vcc, s53, v144
    s_or_b64 s[82:83], s[82:83], vcc
    v_cmp_eq_u32 vcc, s53, v145
    s_or_b64 s[82:83], s[82:83], vcc
    v_cmp_eq_u32 vcc, s53, v146
    s_or_b64 s[82:83], s[82:83], vcc
    v_cmp_eq_u32 vcc, s53, v147
    s_or_b64 s[82:83], s[82:83], vcc
    v_cmp_eq_u32 vcc, s53, v148
    s_or_b64 s[82:83], s[82:83], vcc
    v_cmp_eq_u32 vcc, s53, v149
    s_or_b64 s[82:83], s[82:83], vcc
    v_cmp_eq_u32 vcc, s53, v150
    s_or_b64 s[82:83], s[82:83], vcc
    v_cmp_eq_u32 vcc, s53, v151
    s_or_b64 s[82:83], s[82:83], vcc
    v_cmp_eq_u32 vcc, s53, v152
    s_or_b64 s[82:83], s[82:83], vcc
    v_cmp_eq_u32 vcc, s53, v153
    s_or_b64 s[82:83], s[82:83], vcc
    v_cmp_eq_u32 vcc, s53, v154
    s_or_b64 s[82:83], s[82:83], vcc
    v_cmp_eq_u32 vcc, s53, v155
    s_or_b64 s[82:83], s[82:83], vcc
    v_cmp_eq_u32 vcc, s53, v156
    s_or_b64 s[82:83], s[82:83], vcc
    v_cmp_eq_u32 vcc, s53, v157
    s_or_b64 s[82:83], s[82:83], vcc
    v_cmp_eq_u32 vcc, s53, v158
    s_or_b64 s[82:83], s[82:83], vcc
    v_cmp_eq_u32 vcc, s53, v159
    s_or_b64 s[82:83], s[82:83], vcc
    v_cmp_eq_u32 vcc, s53, v160
    s_or_b64 s[82:83], s[82:83], vcc
    v_cmp_eq_u32 vcc, s53, v161
    s_or_b64 s[82:83], s[82:83], vcc
    v_cmp_eq_u32 vcc, s53, v162
    s_or_b64 s[82:83], s[82:83], vcc
    v_cmp_eq_u32 vcc, s53, v163
    s_or_b64 s[82:83], s[82:83], vcc
    v_cmp_eq_u32 vcc, s53, v164
    s_or_b64 s[82:83], s[82:83], vcc
    v_cmp_eq_u32 vcc, s53, v165
    s_or_b64 s[82:83], s[82:83], vcc
    v_cmp_eq_u32 vcc, s53, v166
    s_or_b64 s[82:83], s[82:83], vcc
    v_cmp_eq_u32 vcc, s53, v167
    s_or_b64 s[82:83], s[82:83], vcc
    v_cmp_eq_u32 vcc, s53, v168
    s_or_b64 s[82:83], s[82:83], vcc
    v_cmp_eq_u32 vcc, s53, v169
    s_or_b64 s[82:83], s[82:83], vcc
    v_cmp_eq_u32 vcc, s53, v170
    s_or_b64 s[82:83], s[82:83], vcc
    v_cmp_eq_u32 vcc, s53, v171
    s_or_b64 s[82:83], s[82:83], vcc
    v_cmp_eq_u32 vcc, s53, v172
    s_or_b64 s[82:83], s[82:83], vcc
    v_cmp_eq_u32 vcc, s53, v173
    s_or_b64 s[82:83], s[82:83], vcc
    v_cmp_eq_u32 vcc, s53, v174
    s_or_b64 s[82:83], s[82:83], vcc
    v_cmp_eq_u32 vcc, s53, v175
    s_or_b64 s[82:83], s[82:83], vcc
    v_cmp_eq_u32 vcc, s53, v176
    s_or_b64 s[82:83], s[82:83], vcc
    v_cmp_eq_u32 vcc, s53, v177
    s_or_b64 s[82:83], s[82:83], vcc
    v_cmp_eq_u32 vcc, s53, v178
    s_or_b64 s[82:83], s[82:83], vcc
    v_cmp_eq_u32 vcc, s53, v179
    s_or_b64 s[82:83], s[82:83], vcc
    v_cmp_eq_u32 vcc, s53, v180
    s_or_b64 s[82:83], s[82:83], vcc
    v_cmp_eq_u32 vcc, s53, v181
    s_or_b64 s[82:83], s[82:83], vcc
    v_cmp_eq_u32 vcc, s53, v182
    s_or_b64 s[82:83], s[82:83], vcc
    v_cmp_eq_u32 vcc, s53, v183
    s_or_b64 s[82:83], s[82:83], vcc
    v_cmp_eq_u32 vcc, s53, v184
    s_or_b64 s[82:83], s[82:83], vcc
    v_cmp_eq_u32 vcc, s53, v185
    s_or_b64 s[82:83], s[82:83], vcc
    v_cmp_eq_u32 vcc, s53, v186
    s_or_b64 s[82:83], s[82:83], vcc
    v_cmp_eq_u32 vcc, s53, v187
    s_or_b64 s[82:83], s[82:83], vcc
    v_cmp_eq_u32 vcc, s53, v188
    s_or_b64 s[82:83], s[82:83], vcc
    v_cmp_eq_u32 vcc, s53, v189
    s_or_b64 s[82:83], s[82:83], vcc
    v_cmp_eq_u32 vcc, s53, v190
    s_or_b64 s[82:83], s[82:83], vcc
    v_cmp_eq_u32 vcc, s53, v191
    s_or_b64 s[82:83], s[82:83], vcc
    v_cmp_eq_u32 vcc, s53, v192
    s_or_b64 s[82:83], s[82:83], vcc
    v_cmp_eq_u32 vcc, s53, v193
    s_or_b64 s[82:83], s[82:83], vcc
    v_cmp_eq_u32 vcc, s53, v194
    s_or_b64 s[82:83], s[82:83], vcc
    v_cmp_eq_u32 vcc, s53, v195
    s_or_b64 s[82:83], s[82:83], vcc
    v_cmp_eq_u32 vcc, s53, v196
    s_or_b64 s[82:83], s[82:83], vcc
    v_cmp_eq_u32 vcc, s53, v197
    s_or_b64 s[82:83], s[82:83], vcc
    v_cmp_eq_u32 vcc, s53, v198
    s_or_b64 s[82:83], s[82:83], vcc
    v_cmp_eq_u32 vcc, s53, v199
    s_or_b64 s[82:83], s[82:83], vcc
    v_cmp_eq_u32 vcc, s53, v200
    s_or_b64 s[82:83], s[82:83], vcc
    v_cmp_eq_u32 vcc, s53, v201
    s_or_b64 s[82:83], s[82:83], vcc
    v_cmp_eq_u32 vcc, s53, v202
    s_or_b64 s[82:83], s[82:83], vcc
    v_cmp_eq_u32 vcc, s53, v203
    s_or_b64 s[82:83], s[82:83], vcc
    v_cmp_eq_u32 vcc, s53, v204
    s_or_b64 s[82:83], s[82:83], vcc
    v_cmp_eq_u32 vcc, s53, v205
    s_or_b64 s[82:83], s[82:83], vcc
    v_cmp_eq_u32 vcc, s53, v206
    s_or_b64 s[82:83], s[82:83], vcc
    v_cmp_eq_u32 vcc, s53, v207
    s_or_b64 s[82:83], s[82:83], vcc
    v_cmp_eq_u32 vcc, s53, v208
    s_or_b64 s[82:83], s[82:83], vcc
    v_cmp_eq_u32 vcc, s53, v209
    s_or_b64 s[82:83], s[82:83], vcc
    v_cmp_eq_u32 vcc, s53, v210
    s_or_b64 s[82:83], s[82:83], vcc
    v_cmp_eq_u32 vcc, s53, v211
    s_or_b64 s[82:83], s[82:83], vcc
    v_cmp_eq_u32 vcc, s53, v212
    s_or_b64 s[82:83], s[82:83], vcc
    v_cmp_eq_u32 vcc, s53, v213
    s_or_b64 s[82:83], s[82:83], vcc
    v_cmp_eq_u32 vcc, s53, v214
    s_or_b64 s[82:83], s[82:83], vcc
    v_cmp_eq_u32 vcc, s53, v215
    s_or_b64 s[82:83], s[82:83], vcc
    v_cmp_eq_u32 vcc, s53, v216
    s_or_b64 s[82:83], s[82:83], vcc
    v_cmp_eq_u32 vcc, s53, v217
    s_or_b64 s[82:83], s[82:83], vcc
    v_cmp_eq_u32 vcc, s53, v218
    s_or_b64 s[82:83], s[82:83], vcc
    v_cmp_eq_u32 vcc, s53, v219
    s_or_b64 s[82:83], s[82:83], vcc
    v_cmp_eq_u32 vcc, s53, v220
    s_or_b64 s[82:83], s[82:83], vcc
    v_cmp_eq_u32 vcc, s53, v221
    s_or_b64 s[82:83], s[82:83], vcc
    v_cmp_eq_u32 vcc, s53, v222
    s_or_b64 s[82:83], s[82:83], vcc
    v_cmp_eq_u32 vcc, s53, v223
    s_or_b64 s[82:83], s[82:83], vcc
    v_cmp_eq_u32 vcc, s53, v224
    s_or_b64 s[82:83], s[82:83], vcc
    v_cmp_eq_u32 vcc, s53, v225
    s_or_b64 s[82:83], s[82:83], vcc
    v_cmp_eq_u32 vcc, s53, v226
    s_or_b64 s[82:83], s[82:83], vcc
    v_cmp_eq_u32 vcc, s53, v227
    s_or_b64 s[82:83], s[82:83], vcc
    v_cmp_eq_u32 vcc, s53, v228
    s_or_b64 s[82:83], s[82:83], vcc
    v_cmp_eq_u32 vcc, s53, v229
    s_or_b64 s[82:83], s[82:83], vcc
    v_cmp_eq_u32 vcc, s53, v230
    s_or_b64 s[82:83], s[82:83], vcc
    v_cmp_eq_u32 vcc, s53, v231
    s_or_b64 s[82:83], s[82:83], vcc
    v_cmp_eq_u32 vcc, s53, v232
    s_or_b64 s[82:83], s[82:83], vcc
    v_cmp_eq_u32 vcc, s53, v233
    s_or_b64 s[82:83], s[82:83], vcc
    v_cmp_eq_u32 vcc, s53, v234
    s_or_b64 s[82:83], s[82:83], vcc
    v_cmp_eq_u32 vcc, s53, v235
    s_or_b64 s[82:83], s[82:83], vcc
    v_cmp_eq_u32 vcc, s53, v236
    s_or_b64 s[82:83], s[82:83], vcc
    v_cmp_eq_u32 vcc, s53, v237
    s_or_b64 s[82:83], s[82:83], vcc
    v_cmp_eq_u32 vcc, s53, v238
    s_or_b64 s[82:83], s[82:83], vcc
    v_cmp_eq_u32 vcc, s53, v239
    s_or_b64 s[82:83], s[82:83], vcc
    v_cmp_eq_u32 vcc, s53, v240
    s_or_b64 s[82:83], s[82:83], vcc
    v_cmp_eq_u32 vcc, s53, v241
    s_or_b64 s[82:83], s[82:83], vcc
    v_cmp_eq_u32 vcc, s53, v242
    s_or_b64 s[82:83], s[82:83], vcc
    v_cmp_eq_u32 vcc, s53, v243
    s_or_b64 s[82:83], s[82:83], vcc
    v_cmp_eq_u32 vcc, s53, v244
    s_or_b64 s[82:83], s[82:83], vcc
    v_cmp_eq_u32 vcc, s53, v245
    s_or_b64 s[82:83], s[82:83], vcc
    v_cmp_eq_u32 vcc, s53, v246
    s_or_b64 s[82:83], s[82:83], vcc
    v_cmp_eq_u32 vcc, s53, v247
    s_or_b64 s[82:83], s[82:83], vcc
    v_cmp_eq_u32 vcc, s53, v248
    s_or_b64 s[82:83], s[82:83], vcc
    v_cmp_eq_u32 vcc, s53, v249
    s_or_b64 s[82:83], s[82:83], vcc
    v_cmp_eq_u32 vcc, s53, v250
    s_or_b64 s[82:83], s[82:83], vcc
    v_cmp_eq_u32 vcc, s53, v251
    s_or_b64 s[82:83], s[82:83], vcc
    s_cbranch_scc0 L_qkv_ok
    s_add_u32 s65, s65, 1
    s_cmp_ge_u32 s65, 4096
    s_cbranch_scc1 L_qkv_ok
    s_waitcnt vmcnt(0)
    s_branch L_qkv
L_stat_redo:
    s_mov_b32 s54, 0
L_sr_119:
    s_add_u32 s52, s62, 0
    buffer_load_dwordx4 v[212:215], v7, s[4:7], s52 offen sc1
    s_add_u32 s52, s62, 4096
    buffer_load_dwordx4 v[216:219], v7, s[4:7], s52 offen sc1
    s_add_u32 s52, s62, 8192
    buffer_load_dwordx4 v[220:223], v7, s[4:7], s52 offen sc1
    s_add_u32 s52, s62, 12288
    buffer_load_dwordx4 v[224:227], v7, s[4:7], s52 offen sc1
    s_add_u32 s52, s62, 16384
    buffer_load_dwordx4 v[228:231], v7, s[4:7], s52 offen sc1
    s_add_u32 s52, s62, 20480
    buffer_load_dwordx4 v[232:235], v7, s[4:7], s52 offen sc1
    s_add_u32 s52, s62, 24576
    buffer_load_dwordx4 v[236:239], v7, s[4:7], s52 offen sc1
    s_add_u32 s52, s62, 28672
    buffer_load_dwordx4 v[240:243], v7, s[4:7], s52 offen sc1
    s_add_u32 s52, s62, 32768
    buffer_load_dwordx4 v[244:247], v7, s[4:7], s52 offen sc1
    s_add_u32 s52, s62, 36864
    buffer_load_dwordx4 v[248:251], v7, s[4:7], s52 offen sc1
    s_waitcnt vmcnt(0)
    s_add_u32 s54, s54, 1
    s_cmp_ge_u32 s54, 65536
    s_cbranch_scc1 L_sr_120
    s_mov_b32 s53, 0x7f817f81
    s_mov_b64 s[82:83], 0
    v_cmp_eq_u32 vcc, s53, v212
    s_or_b64 s[82:83], s[82:83], vcc
    v_cmp_eq_u32 vcc, s53, v213
    s_or_b64 s[82:83], s[82:83], vcc
    v_cmp_eq_u32 vcc, s53, v214
    s_or_b64 s[82:83], s[82:83], vcc
    v_cmp_eq_u32 vcc, s53, v215
    s_or_b64 s[82:83], s[82:83], vcc
    v_cmp_eq_u32 vcc, s53, v216
    s_or_b64 s[82:83], s[82:83], vcc
    v_cmp_eq_u32 vcc, s53, v217
    s_or_b64 s[82:83], s[82:83], vcc
    v_cmp_eq_u32 vcc, s53, v218
    s_or_b64 s[82:83], s[82:83], vcc
    v_cmp_eq_u32 vcc, s53, v219
    s_or_b64 s[82:83], s[82:83], vcc
    v_cmp_eq_u32 vcc, s53, v220
    s_or_b64 s[82:83], s[82:83], vcc
    v_cmp_eq_u32 vcc, s53, v221
    s_or_b64 s[82:83], s[82:83], vcc
    v_cmp_eq_u32 vcc, s53, v222
    s_or_b64 s[82:83], s[82:83], vcc
    v_cmp_eq_u32 vcc, s53, v223
    s_or_b64 s[82:83], s[82:83], vcc
    v_cmp_eq_u32 vcc, s53, v224
    s_or_b64 s[82:83], s[82:83], vcc
    v_cmp_eq_u32 vcc, s53, v225
    s_or_b64 s[82:83], s[82:83], vcc
    v_cmp_eq_u32 vcc, s53, v226
    s_or_b64 s[82:83], s[82:83], vcc
    v_cmp_eq_u32 vcc, s53, v227
    s_or_b64 s[82:83], s[82:83], vcc
    v_cmp_eq_u32 vcc, s53, v228
    s_or_b64 s[82:83], s[82:83], vcc
    v_cmp_eq_u32 vcc, s53, v229
    s_or_b64 s[82:83], s[82:83], vcc
    v_cmp_eq_u32 vcc, s53, v230
    s_or_b64 s[82:83], s[82:83], vcc
    v_cmp_eq_u32 vcc, s53, v231
    s_or_b64 s[82:83], s[82:83], vcc
    v_cmp_eq_u32 vcc, s53, v232
    s_or_b64 s[82:83], s[82:83], vcc
    v_cmp_eq_u32 vcc, s53, v233
    s_or_b64 s[82:83], s[82:83], vcc
    v_cmp_eq_u32 vcc, s53, v234
    s_or_b64 s[82:83], s[82:83], vcc
    v_cmp_eq_u32 vcc, s53, v235
    s_or_b64 s[82:83], s[82:83], vcc
    v_cmp_eq_u32 vcc, s53, v236
    s_or_b64 s[82:83], s[82:83], vcc
    v_cmp_eq_u32 vcc, s53, v237
    s_or_b64 s[82:83], s[82:83], vcc
    v_cmp_eq_u32 vcc, s53, v238
    s_or_b64 s[82:83], s[82:83], vcc
    v_cmp_eq_u32 vcc, s53, v239
    s_or_b64 s[82:83], s[82:83], vcc
    v_cmp_eq_u32 vcc, s53, v240
    s_or_b64 s[82:83], s[82:83], vcc
    v_cmp_eq_u32 vcc, s53, v241
    s_or_b64 s[82:83], s[82:83], vcc
    v_cmp_eq_u32 vcc, s53, v242
    s_or_b64 s[82:83], s[82:83], vcc
    v_cmp_eq_u32 vcc, s53, v243
    s_or_b64 s[82:83], s[82:83], vcc
    v_cmp_eq_u32 vcc, s53, v244
    s_or_b64 s[82:83], s[82:83], vcc
    v_cmp_eq_u32 vcc, s53, v245
    s_or_b64 s[82:83], s[82:83], vcc
    v_cmp_eq_u32 vcc, s53, v246
    s_or_b64 s[82:83], s[82:83], vcc
    v_cmp_eq_u32 vcc, s53, v247
    s_or_b64 s[82:83], s[82:83], vcc
    v_cmp_eq_u32 vcc, s53, v248
    s_or_b64 s[82:83], s[82:83], vcc
    v_cmp_eq_u32 vcc, s53, v249
    s_or_b64 s[82:83], s[82:83], vcc
    v_cmp_eq_u32 vcc, s53, v250
    s_or_b64 s[82:83], s[82:83], vcc
    v_cmp_eq_u32 vcc, s53, v251
    s_or_b64 s[82:83], s[82:83], vcc
    s_cbranch_scc1 L_sr_119
L_sr_120:
    v_and_b32 v249, v90, v249
    v_and_b32 v251, v90, v251
    v_dot2_f32_bf16 v40, v212, v212, 0
    v_dot2_f32_bf16 v41, v213, v213, 0
    v_dot2_f32_bf16 v42, v214, v214, 0
    v_dot2_f32_bf16 v43, v215, v215, 0
    v_dot2_f32_bf16 v40, v216, v216, v40
    v_dot2_f32_bf16 v41, v217, v217, v41
    v_dot2_f32_bf16 v42, v218, v218, v42
    v_dot2_f32_bf16 v43, v219, v219, v43
    v_dot2_f32_bf16 v40, v220, v220, v40
    v_dot2_f32_bf16 v41, v221, v221, v41
    v_dot2_f32_bf16 v42, v222, v222, v42
    v_dot2_f32_bf16 v43, v223, v223, v43
    v_dot2_f32_bf16 v40, v224, v224, v40
    v_dot2_f32_bf16 v41, v225, v225, v41
    v_dot2_f32_bf16 v42, v226, v226, v42
    v_dot2_f32_bf16 v43, v227, v227, v43
    v_dot2_f32_bf16 v40, v228, v228, v40
    v_dot2_f32_bf16 v41, v229, v229, v41
    v_dot2_f32_bf16 v42, v230, v230, v42
    v_dot2_f32_bf16 v43, v231, v231, v43
    v_dot2_f32_bf16 v40, v232, v232, v40
    v_dot2_f32_bf16 v41, v233, v233, v41
    v_dot2_f32_bf16 v42, v234, v234, v42
    v_dot2_f32_bf16 v43, v235, v235, v43
    v_dot2_f32_bf16 v40, v236, v236, v40
    v_dot2_f32_bf16 v41, v237, v237, v41
    v_dot2_f32_bf16 v42, v238, v238, v42
    v_dot2_f32_bf16 v43, v239, v239, v43
    v_dot2_f32_bf16 v40, v240, v240, v40
    v_dot2_f32_bf16 v41, v241, v241, v41
    v_dot2_f32_bf16 v42, v242, v242, v42
    v_dot2_f32_bf16 v43, v243, v243, v43
    v_dot2_f32_bf16 v40, v244, v244, v40
    v_dot2_f32_bf16 v41, v245, v245, v41
    v_dot2_f32_bf16 v42, v246, v246, v42
    v_dot2_f32_bf16 v43, v247, v247, v43
    v_dot2_f32_bf16 v40, v248, v248, v40
    v_dot2_f32_bf16 v41, v249, v249, v41
    v_dot2_f32_bf16 v42, v250, v250, v42
    v_dot2_f32_bf16 v43, v251, v251, v43
    s_nop 0
    v_add_f32 v40, v40, v41
    s_nop 0
    v_add_f32 v41, v42, v43
    s_branch L_stat_ok
L_x3_wait:
    s_lshl_b32 s54, s37, 12
    s_lshl_b32 s53, s42, 2
    s_add_u32 s54, s54, s53
    s_add_u32 s54, s54, 65552
    v_lshlrev_b32 v5, 7, v0
    s_mov_b32 exec_lo, 0xffffffff
    s_mov_b32 exec_hi, 0
    s_mov_b32 s52, s44
L_poll_121:
    buffer_load_dword v4, v5, s[4:7], s54 offen sc1
    s_add_u32 s52, s52, 1
    s_cmp_ge_u32 s52, 65536
    s_cselect_b32 s44, 65536, s44
    s_waitcnt vmcnt(0)
    s_cbranch_scc1 L_pd_122
    v_cmp_gt_u32 vcc, 1, v4
    s_nop 0
    s_cbranch_vccnz L_poll_121
L_pd_122:
    s_mov_b64 exec, -1
    s_mov_b64 vcc, 0
    s_branch L_x3_ok
L_end:
    s_endpgm
.section .rodata,"a"
.p2align 6
.amdhsa_kernel interleave_layers__spectral_gfnet__mha_block__prompt_kernel
  .amdhsa_next_free_vgpr 256
  .amdhsa_next_free_sgpr 100
  .amdhsa_accum_offset 256
  .amdhsa_group_segment_fixed_size 0
  .amdhsa_kernarg_size 72
  .amdhsa_user_sgpr_count 2
  .amdhsa_user_sgpr_kernarg_segment_ptr 1
  .amdhsa_system_sgpr_workgroup_id_x 1
.end_amdhsa_kernel
```
